```python
import torch

def _softmax(x, axis=-1):
    return torch.softmax(x, dim=axis)
def _gelu(x):
    return torch.nn.functional.gelu(x, approximate="tanh")
def _silu(x):
    return torch.nn.functional.silu(x)
def _sigmoid(x):
    return torch.sigmoid(x)
def _layernorm(x, axis=-1, eps=1e-5):
    m = x.mean(dim=axis, keepdim=True)
    v = x.var(dim=axis, keepdim=True, unbiased=False)
    return (x - m) / torch.sqrt(v + eps)
def _scatter_add(tgt, idx, src, axis=0):
    return tgt.clone().index_add_(axis, idx, src)
def _segment_sum(src, seg, n):
    out = torch.zeros((n,) + src.shape[1:], dtype=src.dtype)
    return out.index_add_(0, seg, src)
def _pad(x, pw):
    flat = tuple(v for pair in reversed(pw) for v in pair)
    return torch.nn.functional.pad(x, flat)

kernel_name = 'sequential_preLN__spectral_gfnet__mixer_s_mlp__prompt'

def setup_inputs():

    _w = (lambda a: (lambda t: t.to(torch.bfloat16) if t.is_floating_point() else t)(torch.as_tensor(a)))
    def _A_setup():
        B, S, D = 1, 2048, 640
        Df = D // 2 + 1
        return {
            "x": _w((lambda *s: torch.randn(*s, dtype=torch.bfloat16) * 0.05)(B, S, D)),
            "w_r": _w((lambda *s: torch.randn(*s, dtype=torch.bfloat16) * 0.4)(S, Df) * 0.02),
            "w_i": _w((lambda *s: torch.randn(*s, dtype=torch.bfloat16) * 0.4)(S, Df) * 0.02),
        }
    _A_in = _A_setup()

    def _B_setup():
        B, S, D, F = 1, 2048, 640, 1728
        return {
            "x":  _w((lambda *s: torch.randn(*s, dtype=torch.bfloat16) * 0.05)(B, S, D)),
            "w1": _w((lambda *s: torch.randn(*s, dtype=torch.bfloat16) * 0.8)(D, D) * (D ** -0.5)),
            "w2": _w((lambda *s: torch.randn(*s, dtype=torch.bfloat16) * 0.8)(D, D) * (D ** -0.5)),
            "w3": _w((lambda *s: torch.randn(*s, dtype=torch.bfloat16) * 0.8)(D, F) * (D ** -0.5)),
            "w4": _w((lambda *s: torch.randn(*s, dtype=torch.bfloat16) * 0.8)(F, D) * (F ** -0.5)),
        }
    _B_in = _B_setup()

    return {
        "A_x": _A_in["x"],
        "A_w_r": _A_in["w_r"],
        "A_w_i": _A_in["w_i"],
        "B_x": _B_in["x"],
        "B_w1": _B_in["w1"],
        "B_w2": _B_in["w2"],
        "B_w3": _B_in["w3"],
        "B_w4": _B_in["w4"],
    }

def reference(A_x, A_w_r, A_w_i, B_x, B_w1, B_w2, B_w3, B_w4):
    def _A_ref(x, w_r, w_i):
        B, S, D = x.shape
        X = (lambda x, axes=(-2,-1): torch.fft.rfft2(x.float(), dim=axes))(x, axes=(-2, -1))
        W = w_r + 1j * w_i
        X = X * W
        y = (lambda x, s, axes=(-2,-1): torch.fft.irfft2(x, s=s, dim=axes).to(torch.bfloat16))(X, (S, D), axes=(-2, -1))
        return y

    def _B_ref(x, w1, w2, w3, w4):
        B, S, D = x.shape
        h = _gelu(_layernorm(x, axis=-1) @ w1)
        c = D // 4
        g0 = _pad(h[:, :, 0*c:1*c], ((0, 0), (1, 0), (0, 0)))[:, :S, :]
        g1 = _pad(h[:, :, 1*c:2*c], ((0, 0), (0, 1), (0, 0)))[:, 1:, :]
        g2 = _pad(h[:, :, 2*c:3*c], ((0, 0), (2, 0), (0, 0)))[:, :S, :]
        g3 = _pad(h[:, :, 3*c:   ], ((0, 0), (0, 2), (0, 0)))[:, 2:, :]
        hs = torch.concatenate([g0, g1, g2, g3], axis=-1) @ w2
        x1 = x + hs
        h2 = _gelu(_layernorm(x1, axis=-1) @ w3) @ w4
        return x1 + h2

    x = A_x
    h = x + _A_ref(_layernorm(x, axis=-1), A_w_r, A_w_i)
    h2 = h + _B_ref(_layernorm(h, axis=-1), B_w1, B_w2, B_w3, B_w4)
    return h2
```

```asm
; @launch kernel=k1_kernel grid=(424,1,1) block=(256,1,1) lds=18432
; @launch kernel=k2_kernel grid=(506,1,1) block=(256,1,1) lds=33280
; @launch kernel=kf_kernel grid=(256,1,1) block=(512,1,1) lds=163840
.amdgcn_target "amdgcn-amd-amdhsa--gfx950"
.text
.globl k1_kernel
.p2align 8
.type k1_kernel,@function
k1_kernel:
  s_cmp_ge_u32 s2, 424
  s_cbranch_scc1 k1_end
  s_load_dwordx4 s[4:7], s[0:1], 0
  s_load_dwordx2 s[8:9], s[0:1], 16
  s_load_dwordx2 s[10:11], s[0:1], 80
  s_cmp_ge_u32 s2, 8
  s_cbranch_scc1 k1_go
  s_getpc_b64 s[40:41]
k1_kernel_pc1:
  s_add_u32 s40, s40, k1_go-k1_kernel_pc1
  s_addc_u32 s41, s41, 0
  v_lshlrev_b32 v4, 7, v0
  v_min_u32 v4, code_end-k1_go-4, v4
  global_load_dword v5, v4, s[40:41]
  v_add_u32 v4, 32768, v4
  v_min_u32 v4, code_end-k1_go-4, v4
  global_load_dword v5, v4, s[40:41]
k1_go:
  v_lshrrev_b32 v3, 6, v0
  v_and_b32 v1, 63, v0
  v_readfirstlane_b32 s3, v3
  v_and_b32 v2, 15, v0
  v_lshrrev_b32 v3, 4, v1
  s_cmp_ge_u32 s2, 256
  s_cbranch_scc1 k1_prep
  s_lshr_b32 s12, s2, 3
  s_and_b32 s12, s12, 3
  s_and_b32 s13, s2, 7
  s_lshr_b32 s14, s2, 5
  s_lshl_b32 s14, s14, 3
  s_or_b32 s13, s13, s14
  s_lshr_b32 s14, s13, 5
  s_lshl_b32 s14, s14, 2
  s_add_u32 s12, s12, s14
  s_and_b32 s13, s13, 31
  s_lshl_b32 s14, s12, 3
  s_lshl_b32 s15, s3, 1
  s_add_u32 s14, s14, s15
  s_lshl_b32 s14, s14, 5
  s_add_u32 s14, s14, s13
  s_mul_i32 s14, s14, 1280
  s_add_u32 s15, s14, 40960
  v_mul_u32_u24 v6, 320, v3
  v_lshl_add_u32 v6, v2, 2, v6
  s_waitcnt lgkmcnt(0)
  s_mov_b32 s16, s4
  s_mov_b32 s17, s5
  s_mov_b32 s18, 0x280000
  s_mov_b32 s19, 0x00020000
  buffer_load_dword v7, v6, s[16:19], s14 offen offset:0
  buffer_load_dword v8, v6, s[16:19], s14 offen offset:64
  buffer_load_dword v9, v6, s[16:19], s14 offen offset:128
  buffer_load_dword v10, v6, s[16:19], s14 offen offset:192
  buffer_load_dword v11, v6, s[16:19], s14 offen offset:256
  buffer_load_dword v12, v6, s[16:19], s15 offen offset:0
  buffer_load_dword v13, v6, s[16:19], s15 offen offset:64
  buffer_load_dword v14, v6, s[16:19], s15 offen offset:128
  buffer_load_dword v15, v6, s[16:19], s15 offen offset:192
  buffer_load_dword v16, v6, s[16:19], s15 offen offset:256
  s_mov_b32 s20, s10
  s_mov_b32 s21, s11
  s_mov_b32 s22, 0x2c0000
  s_mov_b32 s23, 0x00020000
  v_cvt_f32_u32 v17, v2
  v_cvt_f32_u32 v18, v3
  v_mul_f32 v19, 0x3d4ccccd, v17
  v_mul_f32 v40, v18, v19
  v_mul_f32 v40, 0x40a00000, v40
  v_mov_b32 v38, v40
  v_fmac_f32 v38, 0x00000000, v19
  v_cos_f32 v28, v38
  v_sin_f32 v33, v38
  v_mov_b32 v38, v40
  v_fmac_f32 v38, 0x3f800000, v19
  v_cos_f32 v29, v38
  v_sin_f32 v34, v38
  v_mov_b32 v38, v40
  v_fmac_f32 v38, 0x40000000, v19
  v_cos_f32 v30, v38
  v_sin_f32 v35, v38
  v_mov_b32 v38, v40
  v_fmac_f32 v38, 0x40400000, v19
  v_cos_f32 v31, v38
  v_sin_f32 v36, v38
  v_mov_b32 v38, v40
  v_fmac_f32 v38, 0x40800000, v19
  v_cos_f32 v32, v38
  v_sin_f32 v37, v38
  v_cvt_pk_bf16_f32 v20, v28, v29
  v_cvt_pk_bf16_f32 v21, v30, v31
  v_cvt_pk_bf16_f32 v22, v32, 0
  v_mov_b32 v23, 0
  v_cvt_pk_bf16_f32 v24, -v33, -v34
  v_cvt_pk_bf16_f32 v25, -v35, -v36
  v_cvt_pk_bf16_f32 v26, -v37, 0
  v_mov_b32 v27, 0
  v_mul_f32 v19, 0x3acccccd, v17
  v_mul_f32 v40, v18, v19
  v_mul_f32 v40, 0x41000000, v40
  v_mov_b32 v38, v40
  v_fmac_f32 v38, 0x00000000, v19
  v_cos_f32 v42, v38
  v_sin_f32 v50, v38
  v_mov_b32 v38, v40
  v_fmac_f32 v38, 0x40000000, v19
  v_cos_f32 v43, v38
  v_sin_f32 v51, v38
  v_mov_b32 v38, v40
  v_fmac_f32 v38, 0x40800000, v19
  v_cos_f32 v44, v38
  v_sin_f32 v52, v38
  v_mov_b32 v38, v40
  v_fmac_f32 v38, 0x40c00000, v19
  v_cos_f32 v45, v38
  v_sin_f32 v53, v38
  v_mov_b32 v38, v40
  v_fmac_f32 v38, 0x3f800000, v19
  v_cos_f32 v46, v38
  v_sin_f32 v54, v38
  v_mov_b32 v38, v40
  v_fmac_f32 v38, 0x40400000, v19
  v_cos_f32 v47, v38
  v_sin_f32 v55, v38
  v_mov_b32 v38, v40
  v_fmac_f32 v38, 0x40a00000, v19
  v_cos_f32 v48, v38
  v_sin_f32 v56, v38
  v_mov_b32 v38, v40
  v_fmac_f32 v38, 0x40e00000, v19
  v_cos_f32 v49, v38
  v_sin_f32 v57, v38
  v_mul_f32 v40, 0x3d000000, v17
  v_mul_f32 v19, v18, v40
  v_mul_f32 v19, 0x41000000, v19
  v_mov_b32 v76, v19
  v_fmac_f32 v76, 0x00000000, v40
  v_cos_f32 v72, v76
  v_sin_f32 v74, v76
  v_mov_b32 v77, v19
  v_fmac_f32 v77, 0x3f800000, v40
  v_cos_f32 v73, v77
  v_sin_f32 v75, v77
  v_cvt_pk_bf16_f32 v28, v72, v73
  v_cvt_pk_bf16_f32 v36, v74, v75
  v_xor_b32 v32, 0x80000000, v28
  v_xor_b32 v60, 0x80000000, v36
  v_xor_b32 v64, 0x80008000, v36
  v_xor_b32 v68, 0x8000, v36
  v_mov_b32 v76, v19
  v_fmac_f32 v76, 0x40000000, v40
  v_cos_f32 v72, v76
  v_sin_f32 v74, v76
  v_mov_b32 v77, v19
  v_fmac_f32 v77, 0x40400000, v40
  v_cos_f32 v73, v77
  v_sin_f32 v75, v77
  v_cvt_pk_bf16_f32 v29, v72, v73
  v_cvt_pk_bf16_f32 v37, v74, v75
  v_xor_b32 v33, 0x80000000, v29
  v_xor_b32 v61, 0x80000000, v37
  v_xor_b32 v65, 0x80008000, v37
  v_xor_b32 v69, 0x8000, v37
  v_mov_b32 v76, v19
  v_fmac_f32 v76, 0x40800000, v40
  v_cos_f32 v72, v76
  v_sin_f32 v74, v76
  v_mov_b32 v77, v19
  v_fmac_f32 v77, 0x40a00000, v40
  v_cos_f32 v73, v77
  v_sin_f32 v75, v77
  v_cvt_pk_bf16_f32 v30, v72, v73
  v_cvt_pk_bf16_f32 v38, v74, v75
  v_xor_b32 v34, 0x80000000, v30
  v_xor_b32 v62, 0x80000000, v38
  v_xor_b32 v66, 0x80008000, v38
  v_xor_b32 v70, 0x8000, v38
  v_mov_b32 v76, v19
  v_fmac_f32 v76, 0x40c00000, v40
  v_cos_f32 v72, v76
  v_sin_f32 v74, v76
  v_mov_b32 v77, v19
  v_fmac_f32 v77, 0x40e00000, v40
  v_cos_f32 v73, v77
  v_sin_f32 v75, v77
  v_cvt_pk_bf16_f32 v31, v72, v73
  v_cvt_pk_bf16_f32 v39, v74, v75
  v_xor_b32 v35, 0x80000000, v31
  v_xor_b32 v63, 0x80000000, v39
  v_xor_b32 v67, 0x80008000, v39
  v_xor_b32 v71, 0x8000, v39
  s_mul_i32 s24, s3, 4608
  v_mul_u32_u24 v19, 272, v2
  v_lshl_add_u32 v19, v3, 5, v19
  v_add_u32 v19, s24, v19
  v_and_b32 v40, 1, v0
  v_lshrrev_b32 v41, 1, v1
  v_lshlrev_b32 v6, 4, v40
  v_mul_u32_u24 v40, 9216, v40
  v_lshl_add_u32 v40, v41, 3, v40
  s_mul_i32 s24, s3, 272
  v_add_u32 v40, s24, v40
  v_lshl_add_u32 v41, v41, 13, v6
  s_lshl_b32 s25, s3, 18
  s_lshl_b32 s24, s13, 8
  s_add_u32 s25, s25, s24
  s_lshl_b32 s24, s12, 5
  s_add_u32 s25, s25, s24
  s_waitcnt vmcnt(9)
  v_lshlrev_b32 v72, 16, v7
  v_and_b32 v73, 0xffff0000, v7
  s_waitcnt vmcnt(8)
  v_lshlrev_b32 v74, 16, v8
  v_and_b32 v75, 0xffff0000, v8
  s_waitcnt vmcnt(7)
  v_lshlrev_b32 v76, 16, v9
  v_and_b32 v77, 0xffff0000, v9
  s_waitcnt vmcnt(6)
  v_lshlrev_b32 v78, 16, v10
  v_and_b32 v79, 0xffff0000, v10
  s_waitcnt vmcnt(5)
  v_lshlrev_b32 v80, 16, v11
  v_and_b32 v81, 0xffff0000, v11
  v_pk_add_f32 v[92:93], v[72:73], v[74:75]
  v_pk_mul_f32 v[94:95], v[72:73], v[72:73]
  v_pk_fma_f32 v[94:95], v[74:75], v[74:75], v[94:95]
  v_pk_add_f32 v[92:93], v[92:93], v[76:77]
  v_pk_fma_f32 v[94:95], v[76:77], v[76:77], v[94:95]
  v_pk_add_f32 v[92:93], v[92:93], v[78:79]
  v_pk_fma_f32 v[94:95], v[78:79], v[78:79], v[94:95]
  v_pk_add_f32 v[92:93], v[92:93], v[80:81]
  v_pk_fma_f32 v[94:95], v[80:81], v[80:81], v[94:95]
  v_add_f32 v92, v92, v93
  v_add_f32 v94, v94, v95
  s_waitcnt vmcnt(4)
  v_lshlrev_b32 v82, 16, v12
  v_and_b32 v83, 0xffff0000, v12
  s_waitcnt vmcnt(3)
  v_lshlrev_b32 v84, 16, v13
  v_and_b32 v85, 0xffff0000, v13
  s_waitcnt vmcnt(2)
  v_lshlrev_b32 v86, 16, v14
  v_and_b32 v87, 0xffff0000, v14
  s_waitcnt vmcnt(1)
  v_lshlrev_b32 v88, 16, v15
  v_and_b32 v89, 0xffff0000, v15
  s_waitcnt vmcnt(0)
  v_lshlrev_b32 v90, 16, v16
  v_and_b32 v91, 0xffff0000, v16
  v_pk_add_f32 v[96:97], v[82:83], v[84:85]
  v_pk_mul_f32 v[98:99], v[82:83], v[82:83]
  v_pk_fma_f32 v[98:99], v[84:85], v[84:85], v[98:99]
  v_pk_add_f32 v[96:97], v[96:97], v[86:87]
  v_pk_fma_f32 v[98:99], v[86:87], v[86:87], v[98:99]
  v_pk_add_f32 v[96:97], v[96:97], v[88:89]
  v_pk_fma_f32 v[98:99], v[88:89], v[88:89], v[98:99]
  v_pk_add_f32 v[96:97], v[96:97], v[90:91]
  v_pk_fma_f32 v[98:99], v[90:91], v[90:91], v[98:99]
  v_add_f32 v96, v96, v97
  v_add_f32 v98, v98, v99
  v_permlane32_swap_b32 v92, v94
  s_nop 0
  v_permlane32_swap_b32 v96, v98
  v_add_f32 v92, v92, v94
  v_add_f32 v96, v96, v98
  s_nop 1
  v_permlane16_swap_b32 v92, v96
  v_add_f32 v92, v92, v96
  s_nop 1
  v_add_f32_dpp v92, v92, v92 row_ror:8 row_mask:0xf bank_mask:0xf
  s_nop 1
  v_add_f32_dpp v92, v92, v92 row_ror:4 row_mask:0xf bank_mask:0xf
  s_nop 1
  v_add_f32_dpp v92, v92, v92 row_ror:2 row_mask:0xf bank_mask:0xf
  s_nop 1
  v_add_f32_dpp v92, v92, v92 row_ror:1 row_mask:0xf bank_mask:0xf
  v_mov_b32 v93, v92
  s_nop 1
  v_permlane32_swap_b32 v92, v93
  v_mul_f32 v92, 0x3acccccd, v92
  v_mul_f32 v93, 0x3acccccd, v93
  v_fma_f32 v93, -v92, v92, v93
  v_max_f32 v93, 0, v93
  v_cvt_pk_bf16_f32 v94, v92, v93
  v_lshlrev_b32 v92, 16, v94
  v_and_b32 v93, 0xffff0000, v94
  v_add_f32 v93, 0x3727c5ac, v93
  v_cvt_pk_bf16_f32 v93, v93, v93
  v_lshlrev_b32 v93, 16, v93
  v_sqrt_f32 v93, v93
  s_nop 0
  v_cvt_pk_bf16_f32 v93, v93, v93
  v_lshlrev_b32 v93, 16, v93
  v_rcp_f32 v93, v93
  s_nop 0
  v_mul_f32 v92, v92, v93
  v_readlane_b32 s28, v93, 0
  v_readlane_b32 s29, v92, 0
  v_readlane_b32 s30, v93, 16
  v_readlane_b32 s31, v92, 16
  v_mov_b32 v96, s29
  v_fma_f32 v72, v72, s28, -v96
  v_fma_f32 v73, v73, s28, -v96
  v_fma_f32 v74, v74, s28, -v96
  v_fma_f32 v75, v75, s28, -v96
  v_fma_f32 v76, v76, s28, -v96
  v_fma_f32 v77, v77, s28, -v96
  v_fma_f32 v78, v78, s28, -v96
  v_fma_f32 v79, v79, s28, -v96
  v_fma_f32 v80, v80, s28, -v96
  v_fma_f32 v81, v81, s28, -v96
  v_cvt_pk_bf16_f32 v100, v72, v74
  v_cvt_pk_bf16_f32 v101, v76, v78
  v_cvt_pk_bf16_f32 v102, v80, 0
  v_mov_b32 v103, 0
  v_cvt_pk_bf16_f32 v104, v73, v75
  v_cvt_pk_bf16_f32 v105, v77, v79
  v_cvt_pk_bf16_f32 v106, v81, 0
  v_mov_b32 v107, 0
  v_mov_b32 v96, s31
  v_fma_f32 v82, v82, s30, -v96
  v_fma_f32 v83, v83, s30, -v96
  v_fma_f32 v84, v84, s30, -v96
  v_fma_f32 v85, v85, s30, -v96
  v_fma_f32 v86, v86, s30, -v96
  v_fma_f32 v87, v87, s30, -v96
  v_fma_f32 v88, v88, s30, -v96
  v_fma_f32 v89, v89, s30, -v96
  v_fma_f32 v90, v90, s30, -v96
  v_fma_f32 v91, v91, s30, -v96
  v_cvt_pk_bf16_f32 v108, v82, v84
  v_cvt_pk_bf16_f32 v109, v86, v88
  v_cvt_pk_bf16_f32 v110, v90, 0
  v_mov_b32 v111, 0
  v_cvt_pk_bf16_f32 v112, v83, v85
  v_cvt_pk_bf16_f32 v113, v87, v89
  v_cvt_pk_bf16_f32 v114, v91, 0
  v_mov_b32 v115, 0
  v_mfma_f32_16x16x32_bf16 v[8:11], v[100:103], v[20:23], 0
  v_mfma_f32_16x16x32_bf16 v[80:83], v[100:103], v[24:27], 0
  v_mfma_f32_16x16x32_bf16 v[12:15], v[104:107], v[20:23], 0
  v_mfma_f32_16x16x32_bf16 v[84:87], v[104:107], v[24:27], 0
  v_mfma_f32_16x16x32_bf16 v[72:75], v[108:111], v[20:23], 0
  v_mfma_f32_16x16x32_bf16 v[88:91], v[108:111], v[24:27], 0
  v_mfma_f32_16x16x32_bf16 v[76:79], v[112:115], v[20:23], 0
  v_mfma_f32_16x16x32_bf16 v[92:95], v[112:115], v[24:27], 0
  s_nop 0
  v_pk_mul_f32 v[116:117], v[8:9], v[42:43]
  v_pk_mul_f32 v[124:125], v[80:81], v[42:43]
  v_pk_fma_f32 v[116:117], v[80:81], v[50:51], v[116:117]
  v_pk_fma_f32 v[124:125], v[8:9], v[50:51], v[124:125] neg_lo:[1,0,0] neg_hi:[1,0,0]
  v_pk_mul_f32 v[118:119], v[10:11], v[44:45]
  v_pk_mul_f32 v[126:127], v[82:83], v[44:45]
  v_pk_fma_f32 v[118:119], v[82:83], v[52:53], v[118:119]
  v_pk_fma_f32 v[126:127], v[10:11], v[52:53], v[126:127] neg_lo:[1,0,0] neg_hi:[1,0,0]
  v_pk_mul_f32 v[120:121], v[12:13], v[46:47]
  v_pk_mul_f32 v[128:129], v[84:85], v[46:47]
  v_pk_fma_f32 v[120:121], v[84:85], v[54:55], v[120:121]
  v_pk_fma_f32 v[128:129], v[12:13], v[54:55], v[128:129] neg_lo:[1,0,0] neg_hi:[1,0,0]
  v_pk_mul_f32 v[122:123], v[14:15], v[48:49]
  v_pk_mul_f32 v[130:131], v[86:87], v[48:49]
  v_pk_fma_f32 v[122:123], v[86:87], v[56:57], v[122:123]
  v_pk_fma_f32 v[130:131], v[14:15], v[56:57], v[130:131] neg_lo:[1,0,0] neg_hi:[1,0,0]
  v_cvt_pk_bf16_f32 v100, v116, v120
  v_cvt_pk_bf16_f32 v104, v124, v128
  v_cvt_pk_bf16_f32 v101, v117, v121
  v_cvt_pk_bf16_f32 v105, v125, v129
  v_cvt_pk_bf16_f32 v102, v118, v122
  v_cvt_pk_bf16_f32 v106, v126, v130
  v_cvt_pk_bf16_f32 v103, v119, v123
  v_cvt_pk_bf16_f32 v107, v127, v131
  s_nop 0
  v_mfma_f32_16x16x32_bf16 v[8:11], v[28:31], v[100:103], 0
  v_mfma_f32_16x16x32_bf16 v[80:83], v[28:31], v[104:107], 0
  v_mfma_f32_16x16x32_bf16 v[12:15], v[32:35], v[100:103], 0
  v_mfma_f32_16x16x32_bf16 v[84:87], v[32:35], v[104:107], 0
  v_mfma_f32_16x16x32_bf16 v[8:11], v[36:39], v[104:107], v[8:11]
  v_mfma_f32_16x16x32_bf16 v[80:83], v[64:67], v[100:103], v[80:83]
  v_mfma_f32_16x16x32_bf16 v[12:15], v[60:63], v[104:107], v[12:15]
  v_mfma_f32_16x16x32_bf16 v[84:87], v[68:71], v[100:103], v[84:87]
  v_pk_mul_f32 v[116:117], v[72:73], v[42:43]
  v_pk_mul_f32 v[124:125], v[88:89], v[42:43]
  v_pk_fma_f32 v[116:117], v[88:89], v[50:51], v[116:117]
  v_pk_fma_f32 v[124:125], v[72:73], v[50:51], v[124:125] neg_lo:[1,0,0] neg_hi:[1,0,0]
  v_pk_mul_f32 v[118:119], v[74:75], v[44:45]
  v_pk_mul_f32 v[126:127], v[90:91], v[44:45]
  v_pk_fma_f32 v[118:119], v[90:91], v[52:53], v[118:119]
  v_pk_fma_f32 v[126:127], v[74:75], v[52:53], v[126:127] neg_lo:[1,0,0] neg_hi:[1,0,0]
  v_pk_mul_f32 v[120:121], v[76:77], v[46:47]
  v_pk_mul_f32 v[128:129], v[92:93], v[46:47]
  v_pk_fma_f32 v[120:121], v[92:93], v[54:55], v[120:121]
  v_pk_fma_f32 v[128:129], v[76:77], v[54:55], v[128:129] neg_lo:[1,0,0] neg_hi:[1,0,0]
  v_pk_mul_f32 v[122:123], v[78:79], v[48:49]
  v_pk_mul_f32 v[130:131], v[94:95], v[48:49]
  v_pk_fma_f32 v[122:123], v[94:95], v[56:57], v[122:123]
  v_pk_fma_f32 v[130:131], v[78:79], v[56:57], v[130:131] neg_lo:[1,0,0] neg_hi:[1,0,0]
  v_cvt_pk_bf16_f32 v108, v116, v120
  v_cvt_pk_bf16_f32 v112, v124, v128
  v_cvt_pk_bf16_f32 v109, v117, v121
  v_cvt_pk_bf16_f32 v113, v125, v129
  v_cvt_pk_bf16_f32 v110, v118, v122
  v_cvt_pk_bf16_f32 v114, v126, v130
  v_cvt_pk_bf16_f32 v111, v119, v123
  v_cvt_pk_bf16_f32 v115, v127, v131
  s_nop 0
  v_mfma_f32_16x16x32_bf16 v[72:75], v[28:31], v[108:111], 0
  v_mfma_f32_16x16x32_bf16 v[88:91], v[28:31], v[112:115], 0
  v_mfma_f32_16x16x32_bf16 v[76:79], v[32:35], v[108:111], 0
  v_mfma_f32_16x16x32_bf16 v[92:95], v[32:35], v[112:115], 0
  v_mfma_f32_16x16x32_bf16 v[72:75], v[36:39], v[112:115], v[72:75]
  v_mfma_f32_16x16x32_bf16 v[88:91], v[64:67], v[108:111], v[88:91]
  v_mfma_f32_16x16x32_bf16 v[76:79], v[60:63], v[112:115], v[76:79]
  v_mfma_f32_16x16x32_bf16 v[92:95], v[68:71], v[108:111], v[92:95]
  v_cvt_pk_bf16_f32 v116, v8, v80
  s_nop 4
  v_cvt_pk_bf16_f32 v117, v72, v88
  v_cvt_pk_bf16_f32 v118, v9, v81
  v_cvt_pk_bf16_f32 v119, v73, v89
  v_cvt_pk_bf16_f32 v120, v10, v82
  v_cvt_pk_bf16_f32 v121, v74, v90
  v_cvt_pk_bf16_f32 v122, v11, v83
  v_cvt_pk_bf16_f32 v123, v75, v91
  ds_write_b128 v19, v[116:119] offset:0
  ds_write_b128 v19, v[120:123] offset:16
  v_cvt_pk_bf16_f32 v124, v12, v84
  v_cvt_pk_bf16_f32 v125, v76, v92
  v_cvt_pk_bf16_f32 v126, v13, v85
  v_cvt_pk_bf16_f32 v127, v77, v93
  v_cvt_pk_bf16_f32 v128, v14, v86
  v_cvt_pk_bf16_f32 v129, v78, v94
  v_cvt_pk_bf16_f32 v130, v15, v87
  v_cvt_pk_bf16_f32 v131, v79, v95
  ds_write_b128 v19, v[124:127] offset:128
  ds_write_b128 v19, v[128:131] offset:144
  s_waitcnt lgkmcnt(0)
  s_barrier
  v_mov_b32 v19, v40
  ds_read2st64_b64 v[132:135], v19 offset0:0 offset1:9
  v_add_u32 v19, 1088, v40
  ds_read2st64_b64 v[136:139], v19 offset0:0 offset1:9
  v_add_u32 v19, 2176, v40
  ds_read2st64_b64 v[140:143], v19 offset0:0 offset1:9
  s_waitcnt lgkmcnt(2)
  buffer_store_dwordx4 v[132:135], v41, s[20:23], s25 offen
  s_add_u32 s25, s25, 1048576
  s_waitcnt lgkmcnt(1)
  buffer_store_dwordx4 v[136:139], v41, s[20:23], s25 offen
  s_add_u32 s25, s25, 1048576
  s_waitcnt lgkmcnt(0)
  buffer_store_dwordx4 v[140:143], v41, s[20:23], s25 offen
  s_endpgm
k1_prep:
  s_nop 1
  s_cmp_ge_u32 s3, 2
  s_cbranch_scc1 k1_end
  s_sub_u32 s12, s2, 256
  s_and_b32 s13, s12, 1
  s_mul_i32 s13, s13, 2
  s_add_u32 s3, s3, s13
  s_lshl_b32 s13, s13, 6
  v_add_u32 v15, s13, v0
  s_lshr_b32 s12, s12, 1
  s_lshl_b32 s12, s12, 5
  v_lshrrev_b32 v7, 3, v15
  v_add_u32 v7, s12, v7
  v_and_b32 v6, 7, v15
  v_mul_u32_u24 v8, 6394, v7
  v_lshrrev_b32 v8, 18, v8
  v_mul_u32_u24 v9, 41, v8
  v_sub_u32 v9, v7, v9
  v_lshl_add_u32 v10, v6, 8, v8
  s_movk_i32 s30, 642
  v_lshlrev_b32 v14, 4, v9
  v_mul_u32_u24 v11, s30, v10
  v_and_b32 v11, -4, v11
  v_add_u32 v11, v11, v14
  v_add_u32 v10, 192, v10
  v_and_b32 v10, 2047, v10
  v_mul_u32_u24 v12, s30, v10
  v_and_b32 v12, -4, v12
  v_add_u32 v12, v12, v14
  s_mov_b32 s28, 41088
  s_mov_b32 s29, 82176
  s_waitcnt lgkmcnt(0)
  s_mov_b32 s16, s6
  s_mov_b32 s17, s7
  s_mov_b32 s18, 0x141000
  s_mov_b32 s19, 0x00020000
  s_mov_b32 s20, s8
  s_mov_b32 s21, s9
  s_mov_b32 s22, 0x141000
  s_mov_b32 s23, 0x00020000
  buffer_load_dwordx4 v[16:19], v11, s[16:19], 0 offen
  buffer_load_dwordx4 v[32:35], v11, s[20:23], 0 offen
  buffer_load_dwordx4 v[20:23], v11, s[16:19], s28 offen
  buffer_load_dwordx4 v[36:39], v11, s[20:23], s28 offen
  buffer_load_dwordx4 v[24:27], v11, s[16:19], s29 offen
  buffer_load_dwordx4 v[40:43], v11, s[20:23], s29 offen
  buffer_load_dwordx4 v[28:31], v12, s[16:19], 0 offen
  buffer_load_dwordx4 v[44:47], v12, s[20:23], 0 offen
  s_add_u32 s24, s10, 0x3b00000
  s_addc_u32 s25, s11, 0
  s_mov_b32 s26, 0x44000
  s_mov_b32 s27, 0x00020000
  v_mov_b32 v48, 0
  v_mov_b32 v49, 0
  v_mov_b32 v50, 0
  v_mov_b32 v51, 0
  v_lshlrev_b32 v13, 4, v15
  s_lshl_b32 s31, s12, 7
  v_add_u32 v13, s31, v13
  buffer_store_dwordx4 v[48:51], v13, s[24:27], 0 offen
  s_add_u32 s24, s10, 0x3200000
  s_addc_u32 s25, s11, 0
  s_mov_b32 s26, 0x230000
  s_mov_b32 s27, 0x00020000
  s_lshr_b32 s31, s12, 3
  s_add_u32 s31, s31, s3
  s_mul_i32 s31, s31, 7168
  s_add_u32 s31, s31, 1726464
  v_lshl_add_u32 v14, v1, 4, s31
  buffer_store_dwordx4 v[48:51], v14, s[24:27], 0 offen
  s_add_u32 s24, s10, 0x400000
  s_addc_u32 s25, s11, 0
  s_mov_b32 s26, 0x29e500
  s_mov_b32 s27, 0x00020000
  v_and_b32 v14, 1, v8
  v_xor_b32 v14, 1, v14
  v_lshl_add_u32 v14, v9, 3, v14
  v_mul_u32_u24 v13, 8320, v14
  v_lshl_add_u32 v13, v8, 7, v13
  v_lshl_add_u32 v13, v6, 4, v13
  v_bfrev_b32 v14, 1
  v_cmp_gt_u32 vcc, 65, v8
  s_nop 1
  v_cndmask_b32 v13, v14, v13, vcc
  s_mov_b32 s33, 0x05040100
  s_mov_b32 s34, 0x07060302
  s_mov_b32 s28, 0
  s_waitcnt vmcnt(8)
  v_perm_b32 v48, v32, v16, s33
  s_waitcnt vmcnt(6)
  v_perm_b32 v49, v36, v20, s33
  s_waitcnt vmcnt(4)
  v_perm_b32 v50, v40, v24, s33
  s_waitcnt vmcnt(2)
  v_perm_b32 v51, v44, v28, s33
  buffer_store_dwordx4 v[48:51], v13, s[24:27], s28 offen sc1
  s_add_u32 s28, s28, 8320
  v_perm_b32 v52, v32, v16, s34
  v_perm_b32 v53, v36, v20, s34
  v_perm_b32 v54, v40, v24, s34
  v_perm_b32 v55, v44, v28, s34
  buffer_store_dwordx4 v[52:55], v13, s[24:27], s28 offen sc1
  s_add_u32 s28, s28, 8320
  v_perm_b32 v56, v33, v17, s33
  v_perm_b32 v57, v37, v21, s33
  v_perm_b32 v58, v41, v25, s33
  v_perm_b32 v59, v45, v29, s33
  buffer_store_dwordx4 v[56:59], v13, s[24:27], s28 offen sc1
  s_add_u32 s28, s28, 8320
  v_perm_b32 v60, v33, v17, s34
  v_perm_b32 v61, v37, v21, s34
  v_perm_b32 v62, v41, v25, s34
  v_perm_b32 v63, v45, v29, s34
  buffer_store_dwordx4 v[60:63], v13, s[24:27], s28 offen sc1
  s_add_u32 s28, s28, 8320
  v_perm_b32 v64, v34, v18, s33
  v_perm_b32 v65, v38, v22, s33
  v_perm_b32 v66, v42, v26, s33
  v_perm_b32 v67, v46, v30, s33
  buffer_store_dwordx4 v[64:67], v13, s[24:27], s28 offen sc1
  s_add_u32 s28, s28, 8320
  v_perm_b32 v68, v34, v18, s34
  v_perm_b32 v69, v38, v22, s34
  v_perm_b32 v70, v42, v26, s34
  v_perm_b32 v71, v46, v30, s34
  buffer_store_dwordx4 v[68:71], v13, s[24:27], s28 offen sc1
  s_add_u32 s28, s28, 8320
  v_perm_b32 v72, v35, v19, s33
  v_perm_b32 v73, v39, v23, s33
  v_perm_b32 v74, v43, v27, s33
  v_perm_b32 v75, v47, v31, s33
  buffer_store_dwordx4 v[72:75], v13, s[24:27], s28 offen sc1
  s_add_u32 s28, s28, 8320
  v_perm_b32 v76, v35, v19, s34
  v_perm_b32 v77, v39, v23, s34
  v_perm_b32 v78, v43, v27, s34
  v_perm_b32 v79, v47, v31, s34
  buffer_store_dwordx4 v[76:79], v13, s[24:27], s28 offen sc1
k1_end:
  s_endpgm
.globl k2_kernel
.p2align 8
.type k2_kernel,@function
k2_kernel:
  s_cmp_ge_u32 s2, 506
  s_cbranch_scc1 k2_end
  s_load_dwordx2 s[14:15], s[0:1], 80
  v_lshrrev_b32 v3, 6, v0
  v_and_b32 v1, 63, v0
  v_readfirstlane_b32 s3, v3
  v_and_b32 v2, 15, v0
  v_lshrrev_b32 v3, 4, v1
  s_cmp_ge_u32 s2, 321
  s_cbranch_scc1 k2_prep
  s_lshr_b32 s12, s2, 3
  s_and_b32 s13, s12, 3
  s_lshr_b32 s12, s12, 2
  s_lshl_b32 s12, s12, 3
  s_and_b32 s24, s2, 7
  s_add_u32 s12, s12, s24
  s_lshl_b32 s12, s12, 2
  s_add_u32 s12, s12, s13
  s_add_u32 s13, s12, 32
  s_sub_u32 s24, s12, 304
  s_cmp_lt_u32 s12, 304
  s_cselect_b32 s12, s13, s24
  s_lshl_b32 s13, s12, 13
  v_lshlrev_b32 v4, 8, v2
  v_lshl_add_u32 v4, v3, 4, v4
  v_lshlrev_b32 v5, 7, v2
  v_lshl_add_u32 v5, v3, 4, v5
  s_add_u32 s25, s13, 4096
  v_cvt_f32_u32 v6, v2
  v_cvt_f32_u32 v7, v3
  s_lshl_b32 s30, s3, 4
  v_add_u32 v8, s30, v2
  v_cvt_f32_u32 v8, v8
  v_mul_f32 v9, 0x3c800000, v8
  v_mul_f32 v10, v7, v9
  v_mul_f32 v10, 4.0, v10
  v_and_b32 v11, 1, v2
  v_mul_u32_u24 v11, 0x8000, v11
  v_lshl_or_b32 v11, v11, 16, v11
  v_mov_b32 v46, v10
  v_fmac_f32 v46, 0x00000000, v9
  v_cos_f32 v44, v46
  v_sin_f32 v45, v46
  s_nop 0
  v_cvt_pk_bf16_f32 v12, v44, v45
  v_cvt_pk_bf16_f32 v28, -v45, v44
  v_xor_b32 v20, v11, v12
  v_xor_b32 v36, v11, v28
  v_mov_b32 v46, v10
  v_fmac_f32 v46, 0x3f800000, v9
  v_cos_f32 v44, v46
  v_sin_f32 v45, v46
  s_nop 0
  v_cvt_pk_bf16_f32 v13, v44, v45
  v_cvt_pk_bf16_f32 v29, -v45, v44
  v_xor_b32 v21, v11, v13
  v_xor_b32 v37, v11, v29
  v_mov_b32 v46, v10
  v_fmac_f32 v46, 0x40000000, v9
  v_cos_f32 v44, v46
  v_sin_f32 v45, v46
  s_nop 0
  v_cvt_pk_bf16_f32 v14, v44, v45
  v_cvt_pk_bf16_f32 v30, -v45, v44
  v_xor_b32 v22, v11, v14
  v_xor_b32 v38, v11, v30
  v_mov_b32 v46, v10
  v_fmac_f32 v46, 0x40400000, v9
  v_cos_f32 v44, v46
  v_sin_f32 v45, v46
  s_nop 0
  v_cvt_pk_bf16_f32 v15, v44, v45
  v_cvt_pk_bf16_f32 v31, -v45, v44
  v_xor_b32 v23, v11, v15
  v_xor_b32 v39, v11, v31
  v_mov_b32 v46, v10
  v_fmac_f32 v46, 0x41800000, v9
  v_cos_f32 v44, v46
  v_sin_f32 v45, v46
  s_nop 0
  v_cvt_pk_bf16_f32 v16, v44, v45
  v_cvt_pk_bf16_f32 v32, -v45, v44
  v_xor_b32 v24, v11, v16
  v_xor_b32 v40, v11, v32
  v_mov_b32 v46, v10
  v_fmac_f32 v46, 0x41880000, v9
  v_cos_f32 v44, v46
  v_sin_f32 v45, v46
  s_nop 0
  v_cvt_pk_bf16_f32 v17, v44, v45
  v_cvt_pk_bf16_f32 v33, -v45, v44
  v_xor_b32 v25, v11, v17
  v_xor_b32 v41, v11, v33
  v_mov_b32 v46, v10
  v_fmac_f32 v46, 0x41900000, v9
  v_cos_f32 v44, v46
  v_sin_f32 v45, v46
  s_nop 0
  v_cvt_pk_bf16_f32 v18, v44, v45
  v_cvt_pk_bf16_f32 v34, -v45, v44
  v_xor_b32 v26, v11, v18
  v_xor_b32 v42, v11, v34
  v_mov_b32 v46, v10
  v_fmac_f32 v46, 0x41980000, v9
  v_cos_f32 v44, v46
  v_sin_f32 v45, v46
  s_nop 0
  v_cvt_pk_bf16_f32 v19, v44, v45
  v_cvt_pk_bf16_f32 v35, -v45, v44
  v_xor_b32 v27, v11, v19
  v_xor_b32 v43, v11, v35
  s_waitcnt lgkmcnt(0)
  s_mov_b32 s16, s14
  s_mov_b32 s17, s15
  s_mov_b32 s18, 0x2c0000
  s_mov_b32 s19, 0x00020000
  v_and_b32 v4, 7, v1
  v_lshlrev_b32 v4, 8, v4
  v_lshrrev_b32 v80, 3, v1
  v_lshl_add_u32 v4, v80, 4, v4
  s_lshr_b32 s31, s3, 1
  s_lshl_b32 s31, s31, 12
  s_and_b32 s33, s3, 1
  s_lshl_b32 s33, s33, 7
  s_add_u32 s31, s31, s33
  s_add_u32 s31, s31, s13
  s_mul_i32 s33, s3, 2304
  s_add_u32 s33, s33, 8192
  s_mov_b32 m0, s33
  s_nop 0
  buffer_load_dwordx4 v4, s[16:19], s31 offen lds
  s_add_u32 s33, s33, 1152
  s_add_u32 s31, s31, 2048
  s_mov_b32 m0, s33
  s_nop 0
  buffer_load_dwordx4 v4, s[16:19], s31 offen lds
  v_lshrrev_b32 v80, 3, v2
  v_mul_u32_u24 v80, 1152, v80
  v_and_b32 v112, 7, v2
  v_lshl_add_u32 v112, v112, 4, v80
  v_lshl_add_u32 v112, v3, 7, v112
  s_add_u32 s20, s14, 0x400000
  s_addc_u32 s21, s15, 0
  s_mov_b32 s22, 0x29e500
  s_mov_b32 s23, 0x00020000
  s_and_b32 s27, s12, 31
  s_mul_i32 s27, s27, 20
  s_lshr_b32 s24, s12, 5
  s_add_u32 s27, s27, s24
  s_add_u32 s24, s27, 1
  s_sub_u32 s26, 641, s27
  s_lshl_b32 s28, s3, 11
  s_sub_u32 s29, 6272, s28
  v_sub_u32 v116, 1968, v5
  s_cmp_gt_u32 s27, 320
  s_cselect_b32 s24, s26, s24
  s_cselect_b32 s28, s29, s28
  s_cselect_b64 vcc, -1, 0
  s_mul_i32 s24, s24, 8320
  s_add_u32 s24, s24, s28
  v_cndmask_b32 v5, v5, v116, vcc
  v_lshlrev_b32 v116, 4, v1
  s_lshl_b32 s33, s3, 11
  s_add_u32 s33, s33, 17408
  v_add_u32 v5, s33, v5
  s_mov_b32 m0, s33
  s_add_u32 s31, s24, 1024
  buffer_load_dwordx4 v116, s[20:23], s24 offen lds
  s_add_u32 s33, s33, 1024
  s_mov_b32 m0, s33
  s_nop 0
  buffer_load_dwordx4 v116, s[20:23], s31 offen lds
  s_add_u32 s16, s14, 0x800000
  s_addc_u32 s17, s15, 0
  s_mov_b32 s18, 0x2c0000
  s_mov_b32 s19, 0x00020000
  v_mul_f32 v9, 0x3a000000, v8
  v_mul_f32 v10, v7, v9
  v_mul_f32 v10, 4.0, v10
  v_mov_b32 v46, v10
  v_fmac_f32 v46, 0x00000000, v9
  v_cos_f32 v48, v46
  v_sin_f32 v56, v46
  v_mov_b32 v46, v10
  v_fmac_f32 v46, 0x3f800000, v9
  v_cos_f32 v49, v46
  v_sin_f32 v57, v46
  v_mov_b32 v46, v10
  v_fmac_f32 v46, 0x40000000, v9
  v_cos_f32 v50, v46
  v_sin_f32 v58, v46
  v_mov_b32 v46, v10
  v_fmac_f32 v46, 0x40400000, v9
  v_cos_f32 v51, v46
  v_sin_f32 v59, v46
  v_mov_b32 v46, v10
  v_fmac_f32 v46, 0x41800000, v9
  v_cos_f32 v52, v46
  v_sin_f32 v60, v46
  v_mov_b32 v46, v10
  v_fmac_f32 v46, 0x41880000, v9
  v_cos_f32 v53, v46
  v_sin_f32 v61, v46
  v_mov_b32 v46, v10
  v_fmac_f32 v46, 0x41900000, v9
  v_cos_f32 v54, v46
  v_sin_f32 v62, v46
  v_mov_b32 v46, v10
  v_fmac_f32 v46, 0x41980000, v9
  v_cos_f32 v55, v46
  v_sin_f32 v63, v46
  v_mul_f32 v114, 0x3d000000, v6
  v_mul_f32 v113, v7, v114
  v_mul_f32 v113, 0x40800000, v113
  v_mov_b32 v152, v113
  v_fmac_f32 v152, 0x00000000, v114
  v_cos_f32 v148, v152
  v_sin_f32 v150, v152
  v_mov_b32 v153, v113
  v_fmac_f32 v153, 0x3f800000, v114
  v_cos_f32 v149, v153
  v_sin_f32 v151, v153
  v_cvt_pk_bf16_f32 v124, v148, v149
  v_cvt_pk_bf16_f32 v132, v150, v151
  v_xor_b32 v128, 0x80000000, v124
  v_xor_b32 v136, 0x80000000, v132
  v_xor_b32 v140, 0x80008000, v132
  v_xor_b32 v144, 0x8000, v132
  v_mov_b32 v152, v113
  v_fmac_f32 v152, 0x40000000, v114
  v_cos_f32 v148, v152
  v_sin_f32 v150, v152
  v_mov_b32 v153, v113
  v_fmac_f32 v153, 0x40400000, v114
  v_cos_f32 v149, v153
  v_sin_f32 v151, v153
  v_cvt_pk_bf16_f32 v125, v148, v149
  v_cvt_pk_bf16_f32 v133, v150, v151
  v_xor_b32 v129, 0x80000000, v125
  v_xor_b32 v137, 0x80000000, v133
  v_xor_b32 v141, 0x80008000, v133
  v_xor_b32 v145, 0x8000, v133
  v_mov_b32 v152, v113
  v_fmac_f32 v152, 0x41800000, v114
  v_cos_f32 v148, v152
  v_sin_f32 v150, v152
  v_mov_b32 v153, v113
  v_fmac_f32 v153, 0x41880000, v114
  v_cos_f32 v149, v153
  v_sin_f32 v151, v153
  v_cvt_pk_bf16_f32 v126, v148, v149
  v_cvt_pk_bf16_f32 v134, v150, v151
  v_xor_b32 v130, 0x80000000, v126
  v_xor_b32 v138, 0x80000000, v134
  v_xor_b32 v142, 0x80008000, v134
  v_xor_b32 v146, 0x8000, v134
  v_mov_b32 v152, v113
  v_fmac_f32 v152, 0x41900000, v114
  v_cos_f32 v148, v152
  v_sin_f32 v150, v152
  v_mov_b32 v153, v113
  v_fmac_f32 v153, 0x41980000, v114
  v_cos_f32 v149, v153
  v_sin_f32 v151, v153
  v_cvt_pk_bf16_f32 v127, v148, v149
  v_cvt_pk_bf16_f32 v135, v150, v151
  v_xor_b32 v131, 0x80000000, v127
  v_xor_b32 v139, 0x80000000, v135
  v_xor_b32 v143, 0x80008000, v135
  v_xor_b32 v147, 0x8000, v135
  s_and_b32 s24, s12, 0xffffffef
  s_cmp_eq_u32 s24, 0
  s_cselect_b32 s26, 0.5, 1.0
  s_lshl_b32 s24, s3, 4
  v_lshl_add_u32 v8, v3, 2, s24
  v_cvt_f32_u32 v8, v8
  v_add_f32 v9, 0x00000000, v6
  v_mul_f32 v9, 0x3a000000, v9
  v_mul_f32 v10, v8, v9
  v_mov_b32 v46, v10
  v_fmac_f32 v46, 0x00000000, v9
  v_cos_f32 v64, v46
  v_sin_f32 v72, v46
  v_mov_b32 v46, v10
  v_fmac_f32 v46, 0x3f800000, v9
  v_cos_f32 v65, v46
  v_sin_f32 v73, v46
  v_mov_b32 v46, v10
  v_fmac_f32 v46, 0x40000000, v9
  v_cos_f32 v66, v46
  v_sin_f32 v74, v46
  v_mov_b32 v46, v10
  v_fmac_f32 v46, 0x40400000, v9
  v_cos_f32 v67, v46
  v_sin_f32 v75, v46
  v_add_f32 v9, 0x41800000, v6
  v_mul_f32 v9, 0x3a000000, v9
  v_mul_f32 v10, v8, v9
  v_mov_b32 v46, v10
  v_fmac_f32 v46, 0x00000000, v9
  v_cos_f32 v68, v46
  v_sin_f32 v76, v46
  v_mov_b32 v46, v10
  v_fmac_f32 v46, 0x3f800000, v9
  v_cos_f32 v69, v46
  v_sin_f32 v77, v46
  v_mov_b32 v46, v10
  v_fmac_f32 v46, 0x40000000, v9
  v_cos_f32 v70, v46
  v_sin_f32 v78, v46
  v_mov_b32 v46, v10
  v_fmac_f32 v46, 0x40400000, v9
  v_cos_f32 v71, v46
  v_sin_f32 v79, v46
  v_mul_f32 v64, s26, v64
  v_mul_f32 v72, s26, v72
  v_mul_f32 v65, s26, v65
  v_mul_f32 v73, s26, v73
  v_mul_f32 v66, s26, v66
  v_mul_f32 v74, s26, v74
  v_mul_f32 v67, s26, v67
  v_mul_f32 v75, s26, v75
  v_mul_f32 v68, s26, v68
  v_mul_f32 v76, s26, v76
  v_mul_f32 v69, s26, v69
  v_mul_f32 v77, s26, v77
  v_mul_f32 v70, s26, v70
  v_mul_f32 v78, s26, v78
  v_mul_f32 v71, s26, v71
  v_mul_f32 v79, s26, v79
  s_waitcnt vmcnt(2)
  s_barrier
  ds_read_b128 v[80:83], v112 offset:8192
  ds_read_b128 v[96:99], v112 offset:12800
  ds_read_b128 v[84:87], v112 offset:8704
  ds_read_b128 v[100:103], v112 offset:13312
  ds_read_b128 v[88:91], v112 offset:10496
  ds_read_b128 v[104:107], v112 offset:15104
  ds_read_b128 v[92:95], v112 offset:11008
  ds_read_b128 v[108:111], v112 offset:15616
  s_waitcnt lgkmcnt(7)
  v_mfma_f32_16x16x32_bf16 v[148:151], v[80:83], v[12:15], 0
  v_mfma_f32_16x16x32_bf16 v[156:159], v[80:83], v[28:31], 0
  s_waitcnt lgkmcnt(6)
  v_mfma_f32_16x16x32_bf16 v[152:155], v[96:99], v[12:15], 0
  v_mfma_f32_16x16x32_bf16 v[160:163], v[96:99], v[28:31], 0
  s_waitcnt lgkmcnt(5)
  v_mfma_f32_16x16x32_bf16 v[148:151], v[84:87], v[16:19], v[148:151]
  v_mfma_f32_16x16x32_bf16 v[156:159], v[84:87], v[32:35], v[156:159]
  s_waitcnt lgkmcnt(4)
  v_mfma_f32_16x16x32_bf16 v[152:155], v[100:103], v[16:19], v[152:155]
  v_mfma_f32_16x16x32_bf16 v[160:163], v[100:103], v[32:35], v[160:163]
  s_waitcnt lgkmcnt(3)
  v_mfma_f32_16x16x32_bf16 v[148:151], v[88:91], v[20:23], v[148:151]
  v_mfma_f32_16x16x32_bf16 v[156:159], v[88:91], v[36:39], v[156:159]
  s_waitcnt lgkmcnt(2)
  v_mfma_f32_16x16x32_bf16 v[152:155], v[104:107], v[20:23], v[152:155]
  v_mfma_f32_16x16x32_bf16 v[160:163], v[104:107], v[36:39], v[160:163]
  s_waitcnt lgkmcnt(1)
  v_mfma_f32_16x16x32_bf16 v[148:151], v[92:95], v[24:27], v[148:151]
  v_mfma_f32_16x16x32_bf16 v[156:159], v[92:95], v[40:43], v[156:159]
  s_waitcnt lgkmcnt(0)
  v_mfma_f32_16x16x32_bf16 v[152:155], v[108:111], v[24:27], v[152:155]
  v_mfma_f32_16x16x32_bf16 v[160:163], v[108:111], v[40:43], v[160:163]
  s_nop 3
  v_pk_mul_f32 v[80:81], v[148:149], v[48:49]
  v_pk_mul_f32 v[88:89], v[156:157], v[48:49]
  v_pk_fma_f32 v[80:81], v[156:157], v[56:57], v[80:81]
  v_pk_fma_f32 v[88:89], v[148:149], v[56:57], v[88:89] neg_lo:[1,0,0] neg_hi:[1,0,0]
  v_pk_mul_f32 v[82:83], v[150:151], v[50:51]
  v_pk_mul_f32 v[90:91], v[158:159], v[50:51]
  v_pk_fma_f32 v[82:83], v[158:159], v[58:59], v[82:83]
  v_pk_fma_f32 v[90:91], v[150:151], v[58:59], v[90:91] neg_lo:[1,0,0] neg_hi:[1,0,0]
  v_pk_mul_f32 v[84:85], v[152:153], v[52:53]
  v_pk_mul_f32 v[92:93], v[160:161], v[52:53]
  v_pk_fma_f32 v[84:85], v[160:161], v[60:61], v[84:85]
  v_pk_fma_f32 v[92:93], v[152:153], v[60:61], v[92:93] neg_lo:[1,0,0] neg_hi:[1,0,0]
  v_pk_mul_f32 v[86:87], v[154:155], v[54:55]
  v_pk_mul_f32 v[94:95], v[162:163], v[54:55]
  v_pk_fma_f32 v[86:87], v[162:163], v[62:63], v[86:87]
  v_pk_fma_f32 v[94:95], v[154:155], v[62:63], v[94:95] neg_lo:[1,0,0] neg_hi:[1,0,0]
  v_cvt_pk_bf16_f32 v96, v80, v81
  v_cvt_pk_bf16_f32 v100, v88, v89
  v_cvt_pk_bf16_f32 v97, v82, v83
  v_cvt_pk_bf16_f32 v101, v90, v91
  v_cvt_pk_bf16_f32 v98, v84, v85
  v_cvt_pk_bf16_f32 v102, v92, v93
  v_cvt_pk_bf16_f32 v99, v86, v87
  v_cvt_pk_bf16_f32 v103, v94, v95
  s_waitcnt vmcnt(0)
  ds_read_b128 v[116:119], v5 offset:0
  ds_read_b128 v[120:123], v5 offset:64
  v_mfma_f32_16x16x32_bf16 v[148:151], v[124:127], v[96:99], 0
  v_mfma_f32_16x16x32_bf16 v[156:159], v[124:127], v[100:103], 0
  v_mfma_f32_16x16x32_bf16 v[152:155], v[128:131], v[96:99], 0
  v_mfma_f32_16x16x32_bf16 v[160:163], v[128:131], v[100:103], 0
  v_mfma_f32_16x16x32_bf16 v[148:151], v[132:135], v[100:103], v[148:151]
  v_mfma_f32_16x16x32_bf16 v[156:159], v[140:143], v[96:99], v[156:159]
  v_mfma_f32_16x16x32_bf16 v[152:155], v[136:139], v[100:103], v[152:155]
  v_mfma_f32_16x16x32_bf16 v[160:163], v[144:147], v[96:99], v[160:163]
  s_waitcnt lgkmcnt(0)
  s_cmp_gt_u32 s27, 320
  s_cbranch_scc1 k2_mir
  v_lshlrev_b32 v48, 16, v116
  v_and_b32 v56, 0xffff0000, v116
  v_lshlrev_b32 v49, 16, v117
  v_and_b32 v57, 0xffff0000, v117
  v_lshlrev_b32 v50, 16, v118
  v_and_b32 v58, 0xffff0000, v118
  v_lshlrev_b32 v51, 16, v119
  v_and_b32 v59, 0xffff0000, v119
  v_lshlrev_b32 v52, 16, v120
  v_and_b32 v60, 0xffff0000, v120
  v_lshlrev_b32 v53, 16, v121
  v_and_b32 v61, 0xffff0000, v121
  v_lshlrev_b32 v54, 16, v122
  v_and_b32 v62, 0xffff0000, v122
  v_lshlrev_b32 v55, 16, v123
  v_and_b32 v63, 0xffff0000, v123
  s_branch k2_join
k2_mir:
  v_bfrev_b32 v44, 1
  s_mov_b32 s28, 0xffff0000
  v_lshlrev_b32 v48, 16, v123
  v_bitop3_b32 v56, v123, v44, s28 bitop3:0x28
  v_lshlrev_b32 v49, 16, v122
  v_bitop3_b32 v57, v122, v44, s28 bitop3:0x28
  v_lshlrev_b32 v50, 16, v121
  v_bitop3_b32 v58, v121, v44, s28 bitop3:0x28
  v_lshlrev_b32 v51, 16, v120
  v_bitop3_b32 v59, v120, v44, s28 bitop3:0x28
  v_lshlrev_b32 v52, 16, v119
  v_bitop3_b32 v60, v119, v44, s28 bitop3:0x28
  v_lshlrev_b32 v53, 16, v118
  v_bitop3_b32 v61, v118, v44, s28 bitop3:0x28
  v_lshlrev_b32 v54, 16, v117
  v_bitop3_b32 v62, v117, v44, s28 bitop3:0x28
  v_lshlrev_b32 v55, 16, v116
  v_bitop3_b32 v63, v116, v44, s28 bitop3:0x28
k2_join:
  v_pk_mul_f32 v[80:81], v[148:149], v[48:49]
  v_pk_mul_f32 v[88:89], v[156:157], v[48:49]
  v_pk_fma_f32 v[80:81], v[156:157], v[56:57], v[80:81] neg_lo:[1,0,0] neg_hi:[1,0,0]
  v_pk_fma_f32 v[88:89], v[148:149], v[56:57], v[88:89]
  v_pk_mul_f32 v[82:83], v[150:151], v[50:51]
  v_pk_mul_f32 v[90:91], v[158:159], v[50:51]
  v_pk_fma_f32 v[82:83], v[158:159], v[58:59], v[82:83] neg_lo:[1,0,0] neg_hi:[1,0,0]
  v_pk_fma_f32 v[90:91], v[150:151], v[58:59], v[90:91]
  v_pk_mul_f32 v[84:85], v[152:153], v[52:53]
  v_pk_mul_f32 v[92:93], v[160:161], v[52:53]
  v_pk_fma_f32 v[84:85], v[160:161], v[60:61], v[84:85] neg_lo:[1,0,0] neg_hi:[1,0,0]
  v_pk_fma_f32 v[92:93], v[152:153], v[60:61], v[92:93]
  v_pk_mul_f32 v[86:87], v[154:155], v[54:55]
  v_pk_mul_f32 v[94:95], v[162:163], v[54:55]
  v_pk_fma_f32 v[86:87], v[162:163], v[62:63], v[86:87] neg_lo:[1,0,0] neg_hi:[1,0,0]
  v_pk_fma_f32 v[94:95], v[154:155], v[62:63], v[94:95]
  v_cvt_pk_bf16_f32 v96, v80, v81
  v_cvt_pk_bf16_f32 v100, v88, v89
  v_cvt_pk_bf16_f32 v97, v82, v83
  v_cvt_pk_bf16_f32 v101, v90, v91
  v_cvt_pk_bf16_f32 v98, v84, v85
  v_cvt_pk_bf16_f32 v102, v92, v93
  v_cvt_pk_bf16_f32 v99, v86, v87
  v_cvt_pk_bf16_f32 v103, v94, v95
  s_nop 0
  v_mfma_f32_16x16x32_bf16 v[148:151], v[96:99], v[124:127], 0
  v_mfma_f32_16x16x32_bf16 v[156:159], v[100:103], v[124:127], 0
  v_mfma_f32_16x16x32_bf16 v[152:155], v[96:99], v[128:131], 0
  v_mfma_f32_16x16x32_bf16 v[160:163], v[100:103], v[128:131], 0
  v_mfma_f32_16x16x32_bf16 v[148:151], v[100:103], v[140:143], v[148:151]
  v_mfma_f32_16x16x32_bf16 v[156:159], v[96:99], v[132:135], v[156:159]
  v_mfma_f32_16x16x32_bf16 v[152:155], v[100:103], v[144:147], v[152:155]
  v_mfma_f32_16x16x32_bf16 v[160:163], v[96:99], v[136:139], v[160:163]
  v_lshlrev_b32 v114, 4, v1
  s_lshl_b32 s24, s3, 11
  v_add_u32 v113, s24, v114
  v_lshrrev_b32 v115, 1, v3
  v_lshl_add_u32 v115, v2, 2, v115
  v_mul_u32_u24 v115, 11264, v115
  v_and_b32 v44, 1, v3
  v_lshl_add_u32 v115, v44, 4, v115
  s_mul_i32 s24, s3, 720896
  s_lshl_b32 s25, s12, 5
  s_add_u32 s24, s24, s25
  s_add_u32 s25, s24, 22528
  v_pk_mul_f32 v[80:81], v[148:149], v[64:65]
  v_pk_mul_f32 v[88:89], v[156:157], v[64:65]
  v_pk_fma_f32 v[80:81], v[156:157], v[72:73], v[80:81] neg_lo:[1,0,0] neg_hi:[1,0,0]
  v_pk_fma_f32 v[88:89], v[148:149], v[72:73], v[88:89]
  v_pk_mul_f32 v[82:83], v[150:151], v[66:67]
  v_pk_mul_f32 v[90:91], v[158:159], v[66:67]
  v_pk_fma_f32 v[82:83], v[158:159], v[74:75], v[82:83] neg_lo:[1,0,0] neg_hi:[1,0,0]
  v_pk_fma_f32 v[90:91], v[150:151], v[74:75], v[90:91]
  v_pk_mul_f32 v[84:85], v[152:153], v[68:69]
  v_pk_mul_f32 v[92:93], v[160:161], v[68:69]
  v_pk_fma_f32 v[84:85], v[160:161], v[76:77], v[84:85] neg_lo:[1,0,0] neg_hi:[1,0,0]
  v_pk_fma_f32 v[92:93], v[152:153], v[76:77], v[92:93]
  v_pk_mul_f32 v[86:87], v[154:155], v[70:71]
  v_pk_mul_f32 v[94:95], v[162:163], v[70:71]
  v_pk_fma_f32 v[86:87], v[162:163], v[78:79], v[86:87] neg_lo:[1,0,0] neg_hi:[1,0,0]
  v_pk_fma_f32 v[94:95], v[154:155], v[78:79], v[94:95]
  v_cvt_pk_bf16_f32 v48, v80, -v88
  v_cvt_pk_bf16_f32 v49, v81, -v89
  v_cvt_pk_bf16_f32 v50, v82, -v90
  v_cvt_pk_bf16_f32 v51, v83, -v91
  ds_write_b128 v113, v[48:51] offset:0
  v_cvt_pk_bf16_f32 v52, v84, -v92
  v_cvt_pk_bf16_f32 v53, v85, -v93
  v_cvt_pk_bf16_f32 v54, v86, -v94
  v_cvt_pk_bf16_f32 v55, v87, -v95
  ds_write_b128 v113, v[52:55] offset:1024
  s_waitcnt lgkmcnt(0)
  s_barrier
  ds_read_b128 v[80:83], v114 offset:0
  ds_read_b128 v[96:99], v114 offset:1024
  ds_read_b128 v[84:87], v114 offset:2048
  ds_read_b128 v[100:103], v114 offset:3072
  ds_read_b128 v[88:91], v114 offset:4096
  ds_read_b128 v[104:107], v114 offset:5120
  ds_read_b128 v[92:95], v114 offset:6144
  ds_read_b128 v[108:111], v114 offset:7168
  s_waitcnt lgkmcnt(7)
  v_mfma_f32_16x16x32_bf16 v[148:151], v[80:83], v[12:15], 0
  v_mfma_f32_16x16x32_bf16 v[156:159], v[80:83], v[28:31], 0
  s_waitcnt lgkmcnt(6)
  v_mfma_f32_16x16x32_bf16 v[152:155], v[96:99], v[12:15], 0
  v_mfma_f32_16x16x32_bf16 v[160:163], v[96:99], v[28:31], 0
  s_waitcnt lgkmcnt(5)
  v_mfma_f32_16x16x32_bf16 v[148:151], v[84:87], v[16:19], v[148:151]
  v_mfma_f32_16x16x32_bf16 v[156:159], v[84:87], v[32:35], v[156:159]
  s_waitcnt lgkmcnt(4)
  v_mfma_f32_16x16x32_bf16 v[152:155], v[100:103], v[16:19], v[152:155]
  v_mfma_f32_16x16x32_bf16 v[160:163], v[100:103], v[32:35], v[160:163]
  s_waitcnt lgkmcnt(3)
  v_mfma_f32_16x16x32_bf16 v[148:151], v[88:91], v[20:23], v[148:151]
  v_mfma_f32_16x16x32_bf16 v[156:159], v[88:91], v[36:39], v[156:159]
  s_waitcnt lgkmcnt(2)
  v_mfma_f32_16x16x32_bf16 v[152:155], v[104:107], v[20:23], v[152:155]
  v_mfma_f32_16x16x32_bf16 v[160:163], v[104:107], v[36:39], v[160:163]
  s_waitcnt lgkmcnt(1)
  v_mfma_f32_16x16x32_bf16 v[148:151], v[92:95], v[24:27], v[148:151]
  v_mfma_f32_16x16x32_bf16 v[156:159], v[92:95], v[40:43], v[156:159]
  s_waitcnt lgkmcnt(0)
  v_mfma_f32_16x16x32_bf16 v[152:155], v[108:111], v[24:27], v[152:155]
  v_mfma_f32_16x16x32_bf16 v[160:163], v[108:111], v[40:43], v[160:163]
  s_nop 4
  v_cvt_pk_bf16_f32 v64, v148, -v156
  v_cvt_pk_bf16_f32 v65, v149, -v157
  v_cvt_pk_bf16_f32 v66, v150, -v158
  v_cvt_pk_bf16_f32 v67, v151, -v159
  buffer_store_dwordx4 v[64:67], v115, s[16:19], s24 offen
  v_cvt_pk_bf16_f32 v68, v152, -v160
  v_cvt_pk_bf16_f32 v69, v153, -v161
  v_cvt_pk_bf16_f32 v70, v154, -v162
  v_cvt_pk_bf16_f32 v71, v155, -v163
  buffer_store_dwordx4 v[68:71], v115, s[16:19], s25 offen
  s_endpgm
k2_prep:
  s_nop 3
  s_sub_u32 s12, s2, 321
  s_mul_i32 s12, s12, 4
  s_add_u32 s12, s12, s3
  s_cmp_ge_u32 s3, 4
  s_cbranch_scc1 k2_end
  s_cmp_ge_u32 s12, 740
  s_cbranch_scc1 k2_end
  s_cmp_ge_u32 s12, 100
  s_cbranch_scc1 k2_kernel_wp1
  s_sub_u32 s12, s12, 0
  s_mov_b32 s40, 0x0
  s_mov_b32 s41, 0x0
  s_load_dwordx2 s[16:17], s[0:1], 32
  s_mov_b32 s18, 0xc8000
  s_mov_b32 s19, 0x00020000
  s_mov_b32 s42, 0x3000000
  s_mov_b32 s22, 0xc8000
  s_mov_b32 s23, 0x00020000
  s_movk_i32 s24, 1280
  s_movk_i32 s25, 5
  s_movk_i32 s26, 13108
  s_movk_i32 s27, 20
  s_movk_i32 s28, 6554
  s_movk_i32 s29, 10
  s_branch k2_kernel_wp5
k2_kernel_wp1:
  s_cmp_ge_u32 s12, 200
  s_cbranch_scc1 k2_kernel_wp2
  s_sub_u32 s12, s12, 100
  s_mov_b32 s40, 0x21084
  s_mov_b32 s41, 0x0
  s_waitcnt lgkmcnt(0)
  s_load_dwordx2 s[16:17], s[0:1], 40
  s_mov_b32 s18, 0xc8000
  s_mov_b32 s19, 0x00020000
  s_mov_b32 s42, 0x3100000
  s_mov_b32 s22, 0xc8000
  s_mov_b32 s23, 0x00020000
  s_movk_i32 s24, 1280
  s_movk_i32 s25, 5
  s_movk_i32 s26, 13108
  s_movk_i32 s27, 20
  s_movk_i32 s28, 6554
  s_movk_i32 s29, 10
  s_branch k2_kernel_wp5
k2_kernel_wp2:
  s_cmp_ge_u32 s12, 470
  s_cbranch_scc1 k2_kernel_wp3
  s_sub_u32 s12, s12, 200
  s_mov_b32 s40, 0x21084
  s_mov_b32 s41, 0x0
  s_waitcnt lgkmcnt(0)
  s_load_dwordx2 s[16:17], s[0:1], 48
  s_mov_b32 s18, 0x21c000
  s_mov_b32 s19, 0x00020000
  s_mov_b32 s42, 0x3200000
  s_mov_b32 s22, 0x230000
  s_mov_b32 s23, 0x00020000
  s_movk_i32 s24, 3456
  s_movk_i32 s25, 7
  s_movk_i32 s26, 9363
  s_movk_i32 s27, 20
  s_movk_i32 s28, 2428
  s_movk_i32 s29, 27
  s_branch k2_kernel_wp5
k2_kernel_wp3:
  s_sub_u32 s12, s12, 470
  s_mov_b32 s40, 0x81020408
  s_mov_b32 s41, 0x40
  s_waitcnt lgkmcnt(0)
  s_load_dwordx2 s[16:17], s[0:1], 56
  s_mov_b32 s18, 0x21c000
  s_mov_b32 s19, 0x00020000
  s_mov_b32 s42, 0x3600000
  s_mov_b32 s22, 0x21c000
  s_mov_b32 s23, 0x00020000
  s_movk_i32 s24, 1280
  s_movk_i32 s25, 5
  s_movk_i32 s26, 13108
  s_movk_i32 s27, 54
  s_movk_i32 s28, 6554
  s_movk_i32 s29, 10
k2_kernel_wp5:
  s_mul_i32 s30, s12, s28
  s_lshr_b32 s30, s30, 16
  s_mul_i32 s31, s30, s29
  s_sub_u32 s31, s12, s31
  v_lshrrev_b32 v4, 3, v1
  v_and_b32 v5, 7, v1
  v_lshlrev_b32 v6, 3, v4
  s_lshl_b32 s33, s30, 1
  s_lshr_b64 s[40:41], s[40:41], s33
  v_lshrrev_b32 v72, 2, v4
  v_lshrrev_b32 v73, v72, s40
  v_and_b32 v73, 1, v73
  v_cmp_eq_u32 vcc, 1, v73
  v_lshlrev_b32 v72, 5, v72
  v_and_b32 v7, 1, v4
  v_lshl_add_u32 v72, v7, 4, v72
  v_and_b32 v7, 2, v4
  v_lshl_add_u32 v72, v7, 1, v72
  v_cndmask_b32 v6, v6, v72, vcc
  v_lshl_add_u32 v7, v73, 2, v6
  v_mul_u32_u24 v7, s24, v7
  v_lshl_add_u32 v7, v5, 4, v7
  v_mul_u32_u24 v6, s24, v6
  v_lshl_add_u32 v6, v5, 4, v6
  s_lshl_b32 s33, s30, 6
  s_mul_i32 s33, s33, s24
  s_lshl_b32 s34, s31, 7
  s_add_u32 s33, s33, s34
  s_waitcnt lgkmcnt(0)
  s_add_u32 s20, s14, s42
  s_addc_u32 s21, s15, 0
  buffer_load_dwordx4 v[8:11], v6, s[16:19], s33 offen
  s_add_u32 s33, s33, s24
  buffer_load_dwordx4 v[12:15], v6, s[16:19], s33 offen
  s_add_u32 s33, s33, s24
  buffer_load_dwordx4 v[16:19], v6, s[16:19], s33 offen
  s_add_u32 s33, s33, s24
  buffer_load_dwordx4 v[20:23], v6, s[16:19], s33 offen
  s_add_u32 s33, s33, s24
  buffer_load_dwordx4 v[24:27], v7, s[16:19], s33 offen
  s_add_u32 s33, s33, s24
  buffer_load_dwordx4 v[28:31], v7, s[16:19], s33 offen
  s_add_u32 s33, s33, s24
  buffer_load_dwordx4 v[32:35], v7, s[16:19], s33 offen
  s_add_u32 s33, s33, s24
  buffer_load_dwordx4 v[36:39], v7, s[16:19], s33 offen
  v_and_b32 v79, 3, v4
  v_lshlrev_b32 v79, 8, v79
  v_and_b32 v78, 3, v5
  v_lshl_add_u32 v79, v78, 6, v79
  v_lshrrev_b32 v78, 2, v4
  v_lshrrev_b32 v77, 2, v5
  v_lshl_add_u32 v78, v78, 1, v77
  v_mul_u32_u24 v78, 2080, v78
  s_mul_i32 s35, s3, 8320
  v_add3_u32 v79, v79, v78, s35
  v_lshlrev_b32 v81, 4, v1
  v_add_u32 v80, s35, v81
  s_lshl_b32 s35, s25, 10
  v_add_u32 v82, s35, v81
  s_lshl_b32 s33, s31, 2
  s_sub_u32 s34, s25, 1
  s_lshl_b32 s35, s30, 1
  v_and_b32 v74, 3, v1
  v_add_u32 v74, s33, v74
  v_mul_u32_u24 v75, s26, v74
  v_lshrrev_b32 v75, 16, v75
  v_mul_u32_u24 v76, s25, v75
  v_sub_u32 v76, v74, v76
  v_subrev_u32 v77, 1, v76
  v_mov_b32 v78, s34
  v_cmp_eq_u32 vcc, 0, v76
  s_nop 1
  v_cndmask_b32 v77, v77, v78, vcc
  v_and_b32 v78, 1, v75
  v_cmp_eq_u32 vcc, 1, v78
  s_nop 1
  v_cndmask_b32 v76, v76, v77, vcc
  v_subrev_u32 v77, 84, v74
  v_mul_u32_u24 v78, 43, v77
  v_lshrrev_b32 v78, 8, v78
  v_cmp_le_u32 vcc, 84, v74
  v_mul_u32_u24 v74, 6, v78
  v_sub_u32 v77, v77, v74
  v_add_u32 v78, 12, v78
  v_cndmask_b32 v75, v75, v78, vcc
  v_cndmask_b32 v76, v76, v77, vcc
  v_mov_b32 v78, s35
  v_mad_u32_u24 v75, v75, s27, v78
  v_mad_u32_u24 v75, v75, s25, v76
  v_lshlrev_b32 v75, 10, v75
  s_nop 0
  v_readlane_b32 s36, v75, 0
  v_readlane_b32 s37, v75, 1
  v_readlane_b32 s38, v75, 2
  v_readlane_b32 s39, v75, 3
  s_mov_b32 s33, 0x05040100
  s_mov_b32 s34, 0x07060302
  s_waitcnt vmcnt(7)
  s_waitcnt vmcnt(0)
  v_perm_b32 v40, v12, v8, s33
  v_perm_b32 v41, v20, v16, s33
  v_perm_b32 v42, v28, v24, s33
  v_perm_b32 v43, v36, v32, s33
  ds_write_b128 v79, v[40:43] offset:0
  v_perm_b32 v44, v12, v8, s34
  v_perm_b32 v45, v20, v16, s34
  v_perm_b32 v46, v28, v24, s34
  v_perm_b32 v47, v36, v32, s34
  ds_write_b128 v79, v[44:47] offset:16
  v_perm_b32 v48, v13, v9, s33
  v_perm_b32 v49, v21, v17, s33
  v_perm_b32 v50, v29, v25, s33
  v_perm_b32 v51, v37, v33, s33
  ds_write_b128 v79, v[48:51] offset:32
  v_perm_b32 v52, v13, v9, s34
  v_perm_b32 v53, v21, v17, s34
  v_perm_b32 v54, v29, v25, s34
  v_perm_b32 v55, v37, v33, s34
  ds_write_b128 v79, v[52:55] offset:48
  v_perm_b32 v56, v14, v10, s33
  v_perm_b32 v57, v22, v18, s33
  v_perm_b32 v58, v30, v26, s33
  v_perm_b32 v59, v38, v34, s33
  ds_write_b128 v79, v[56:59] offset:1040
  v_perm_b32 v60, v14, v10, s34
  v_perm_b32 v61, v22, v18, s34
  v_perm_b32 v62, v30, v26, s34
  v_perm_b32 v63, v38, v34, s34
  ds_write_b128 v79, v[60:63] offset:1056
  v_perm_b32 v64, v15, v11, s33
  v_perm_b32 v65, v23, v19, s33
  v_perm_b32 v66, v31, v27, s33
  v_perm_b32 v67, v39, v35, s33
  ds_write_b128 v79, v[64:67] offset:1072
  v_perm_b32 v68, v15, v11, s34
  v_perm_b32 v69, v23, v19, s34
  v_perm_b32 v70, v31, v27, s34
  v_perm_b32 v71, v39, v35, s34
  ds_write_b128 v79, v[68:71] offset:1088
  s_waitcnt lgkmcnt(0)
  ds_read_b128 v[8:11], v80 offset:0
  ds_read_b128 v[12:15], v80 offset:1040
  ds_read_b128 v[16:19], v80 offset:2080
  ds_read_b128 v[20:23], v80 offset:3120
  ds_read_b128 v[24:27], v80 offset:4160
  ds_read_b128 v[28:31], v80 offset:5200
  ds_read_b128 v[32:35], v80 offset:6240
  ds_read_b128 v[36:39], v80 offset:7280
  s_waitcnt lgkmcnt(7)
  buffer_store_dwordx4 v[8:11], v81, s[20:23], s36 offen sc1
  s_waitcnt lgkmcnt(6)
  buffer_store_dwordx4 v[12:15], v81, s[20:23], s37 offen sc1
  s_waitcnt lgkmcnt(5)
  buffer_store_dwordx4 v[16:19], v81, s[20:23], s38 offen sc1
  s_waitcnt lgkmcnt(4)
  buffer_store_dwordx4 v[20:23], v81, s[20:23], s39 offen sc1
  s_waitcnt lgkmcnt(3)
  buffer_store_dwordx4 v[24:27], v82, s[20:23], s36 offen sc1
  s_waitcnt lgkmcnt(2)
  buffer_store_dwordx4 v[28:31], v82, s[20:23], s37 offen sc1
  s_waitcnt lgkmcnt(1)
  buffer_store_dwordx4 v[32:35], v82, s[20:23], s38 offen sc1
  s_waitcnt lgkmcnt(0)
  buffer_store_dwordx4 v[36:39], v82, s[20:23], s39 offen sc1
  s_cmp_lg_u32 s25, 7
  s_cbranch_scc1 k2_end
  v_bfe_u32 v77, v1, 2, 2
  v_mov_b32 v78, 0x3f803f80
  v_cmp_eq_u32 vcc, 0, v77
  s_nop 1
  v_cndmask_b32 v40, 0, v78, vcc
  v_cndmask_b32 v41, 0, v78, vcc
  v_cndmask_b32 v42, 0, v78, vcc
  v_cndmask_b32 v43, 0, v78, vcc
  v_cmp_eq_u32 vcc, 1, v77
  s_nop 1
  v_cndmask_b32 v44, 0, v78, vcc
  v_cndmask_b32 v45, 0, v78, vcc
  v_cndmask_b32 v46, 0, v78, vcc
  v_cndmask_b32 v47, 0, v78, vcc
  v_cmp_eq_u32 vcc, 2, v77
  s_nop 1
  v_cndmask_b32 v48, 0, v78, vcc
  v_cndmask_b32 v49, 0, v78, vcc
  v_cndmask_b32 v50, 0, v78, vcc
  v_cndmask_b32 v51, 0, v78, vcc
  v_cmp_eq_u32 vcc, 3, v77
  s_nop 1
  v_cndmask_b32 v52, 0, v78, vcc
  v_cndmask_b32 v53, 0, v78, vcc
  v_cndmask_b32 v54, 0, v78, vcc
  v_cndmask_b32 v55, 0, v78, vcc
  v_mfma_f32_16x16x32_bf16 v[56:59], v[40:43], v[8:11], 0
  v_mfma_f32_16x16x32_bf16 v[56:59], v[44:47], v[12:15], v[56:59]
  v_mfma_f32_16x16x32_bf16 v[56:59], v[48:51], v[16:19], v[56:59]
  v_mfma_f32_16x16x32_bf16 v[56:59], v[52:55], v[20:23], v[56:59]
  v_mfma_f32_16x16x32_bf16 v[56:59], v[40:43], v[24:27], v[56:59]
  v_mfma_f32_16x16x32_bf16 v[56:59], v[44:47], v[28:31], v[56:59]
  v_mfma_f32_16x16x32_bf16 v[56:59], v[48:51], v[32:35], v[56:59]
  v_mfma_f32_16x16x32_bf16 v[56:59], v[52:55], v[36:39], v[56:59]
  s_add_u32 s16, s14, 0x3a00000
  s_addc_u32 s17, s15, 0
  s_mov_b32 s18, 0x10e00
  s_mov_b32 s19, 0x00020000
  v_lshrrev_b32 v78, 5, v1
  v_lshlrev_b32 v78, 7, v78
  v_lshl_add_u32 v78, v77, 5, v78
  v_and_b32 v77, 16, v1
  v_add_u32 v78, v77, v78
  v_and_b32 v77, 3, v1
  v_lshl_add_u32 v78, v77, 2, v78
  s_mul_i32 s33, s30, 6912
  s_lshl_b32 s34, s31, 8
  s_add_u32 s33, s33, s34
  buffer_store_dword v56, v78, s[16:19], s33 offen
k2_end:
  s_endpgm
.globl kf_kernel
.p2align 8
.type kf_kernel,@function
kf_kernel:
  s_load_dwordx2 s[14:15], s[0:1], 80
  s_load_dwordx2 s[4:5], s[0:1], 0
  s_load_dwordx2 s[6:7], s[0:1], 64
  s_cmp_ge_u32 s2, 256
  s_cbranch_scc1 kf_end
  v_lshrrev_b32 v3, 6, v0
  v_and_b32 v1, 63, v0
  v_readfirstlane_b32 s3, v3
  v_and_b32 v2, 15, v0
  v_lshrrev_b32 v3, 4, v1
  v_lshlrev_b32 v4, 4, v1
  s_cmp_ge_u32 s3, 4
  s_cbranch_scc1 kf_ld
  v_mov_b32 v6, 159744
  v_mov_b32 v7, 0
  ds_write_b32 v6, v7
  v_mov_b32 v7, 1
  s_and_b32 s12, s2, 7
  s_lshl_b32 s12, s12, 5
  s_lshr_b32 s13, s2, 3
  s_add_u32 s12, s12, s13
  s_mul_i32 s13, s12, 11264
  s_lshl_b32 s24, s3, 10
  s_add_u32 s13, s13, s24
  s_mul_i32 s24, s3, 1032
  s_add_u32 s24, s24, 126976
  s_lshl_b32 s52, s12, 8
  s_waitcnt lgkmcnt(0)
  s_add_u32 s16, s14, 0x800000
  s_addc_u32 s17, s15, 0
  s_mov_b32 s18, 0x2c0000
  s_mov_b32 s19, 0x00020000
  s_cmp_eq_u32 s3, 0
  s_cselect_b32 exec_hi, 255, -1
  s_mov_b32 m0, s24
  s_nop 0
  buffer_load_dwordx4 v4, s[16:19], s13 offen lds
  s_mov_b32 exec_hi, -1
  s_add_u32 s13, s13, 4096
  s_add_u32 s24, s24, 4128
  s_mov_b32 m0, s24
  s_nop 0
  buffer_load_dwordx4 v4, s[16:19], s13 offen lds
  s_add_u32 s13, s13, 4096
  s_add_u32 s24, s24, 4128
  s_cmp_eq_u32 s3, 3
  s_cbranch_scc1 kf_nodma
  s_cmp_eq_u32 s3, 2
  s_cselect_b32 exec_hi, 0, -1
  s_mov_b32 m0, s24
  s_nop 0
  buffer_load_dwordx4 v4, s[16:19], s13 offen lds
  s_mov_b32 exec_hi, -1
kf_nodma:
  s_mov_b32 s20, s4
  s_mov_b32 s21, s5
  s_mov_b32 s22, 0x280000
  s_mov_b32 s23, 0x00020000
  s_lshl_b32 s53, s12, 3
  s_lshl_b32 s13, s3, 1
  s_add_u32 s12, s53, s13
  s_mul_i32 s13, s12, 1280
  v_lshlrev_b32 v10, 6, v2
  v_lshl_add_u32 v10, v3, 4, v10
  v_lshrrev_b32 v12, 2, v2
  v_and_b32 v13, 3, v2
  v_mul_u32_u24 v11, 1280, v12
  v_lshl_add_u32 v11, v13, 6, v11
  v_lshl_add_u32 v11, v3, 4, v11
  v_bfrev_b32 v14, 1
  v_cmp_gt_u32 vcc, 8, v2
  s_nop 1
  v_cndmask_b32 v11, v14, v11, vcc
  buffer_load_dwordx4 v[20:23], v10, s[20:23], s13 offen
  buffer_load_dwordx4 v[24:27], v10, s[20:23], s13 offen offset:1280
  buffer_load_dwordx4 v[28:31], v11, s[20:23], s13 offen offset:1024
  s_lshl_b32 s28, s3, 5
  s_add_u32 s28, s28, 138400
  v_mul_u32_u24 v18, 528, v2
  v_lshl_add_u32 v18, v3, 7, v18
  v_add_u32 v18, s28, v18
  v_add_u32 v19, 16, v13
  v_mul_u32_u24 v19, 528, v19
  v_lshl_add_u32 v19, v12, 4, v19
  v_lshl_add_u32 v19, v3, 7, v19
  v_add_u32 v19, s28, v19
  v_cmp_eq_u32 vcc, 0, v12
  s_nop 1
  v_cndmask_b32 v16, 0, 1.0, vcc
  v_cmp_eq_u32 vcc, 1, v12
  s_nop 1
  v_cndmask_b32 v17, 0, 1.0, vcc
  v_lshrrev_b32 v33, 5, v1
  v_mul_u32_u24 v32, 16, v33
  s_mul_i32 s28, s3, 1056
  s_add_u32 s28, s28, 138400
  v_add3_u32 v32, v32, v4, s28
  v_lshlrev_b32 v33, 17, v33
  v_bfe_u32 v14, v1, 3, 2
  v_lshl_add_u32 v33, v14, 8, v33
  v_and_b32 v14, 7, v1
  v_lshl_add_u32 v33, v14, 4, v33
  s_add_u32 s16, s14, 0xc00000
  s_addc_u32 s17, s15, 0
  s_mov_b32 s18, 0x680000
  s_mov_b32 s19, 0x00020000
  s_add_u32 s24, s14, 0x3b40000
  s_addc_u32 s25, s15, 0
  s_mov_b32 s26, 0x4000
  s_mov_b32 s27, 0x00020000
  s_add_u32 s48, s14, 0x3b00000
  s_addc_u32 s49, s15, 0
  s_mov_b32 s50, 0x40000
  s_mov_b32 s51, 0x00020000
  s_lshr_b32 s13, s53, 4
  s_lshl_b32 s13, s13, 10
  s_and_b32 s28, s53, 8
  s_lshl_b32 s28, s28, 4
  s_add_u32 s13, s13, s28
  s_lshl_b32 s28, s3, 18
  s_add_u32 s13, s13, s28
  s_lshl_b32 s12, s12, 3
  v_cvt_f32_u32 v34, v2
  v_cvt_f32_u32 v35, v3
  v_fma_f32 v36, v34, 2.0, 0.0
  v_mul_f32 v36, 0x3d000000, v36
  v_mul_f32 v37, v35, v36
  v_mul_f32 v37, 4.0, v37
  v_mov_b32 v68, v37
  v_fmac_f32 v68, 0x00000000, v36
  v_cos_f32 v64, v68
  v_sin_f32 v66, v68
  v_mov_b32 v69, v37
  v_fmac_f32 v69, 0x3f800000, v36
  v_cos_f32 v65, v69
  v_sin_f32 v67, v69
  v_cvt_pk_bf16_f32 v40, v64, v65
  v_cvt_pk_bf16_f32 v48, v66, v67
  v_cvt_pk_bf16_f32 v56, -v66, -v67
  v_mov_b32 v42, v40
  v_mov_b32 v50, v48
  v_mov_b32 v58, v56
  v_mov_b32 v68, v37
  v_fmac_f32 v68, 0x40000000, v36
  v_cos_f32 v64, v68
  v_sin_f32 v66, v68
  v_mov_b32 v69, v37
  v_fmac_f32 v69, 0x40400000, v36
  v_cos_f32 v65, v69
  v_sin_f32 v67, v69
  v_cvt_pk_bf16_f32 v41, v64, v65
  v_cvt_pk_bf16_f32 v49, v66, v67
  v_cvt_pk_bf16_f32 v57, -v66, -v67
  v_mov_b32 v43, v41
  v_mov_b32 v51, v49
  v_mov_b32 v59, v57
  v_fma_f32 v36, v34, 2.0, 1.0
  v_mul_f32 v36, 0x3d000000, v36
  v_mul_f32 v37, v35, v36
  v_mul_f32 v37, 4.0, v37
  v_mov_b32 v68, v37
  v_fmac_f32 v68, 0x00000000, v36
  v_cos_f32 v64, v68
  v_sin_f32 v66, v68
  v_mov_b32 v69, v37
  v_fmac_f32 v69, 0x3f800000, v36
  v_cos_f32 v65, v69
  v_sin_f32 v67, v69
  v_cvt_pk_bf16_f32 v44, v64, v65
  v_cvt_pk_bf16_f32 v52, v66, v67
  v_cvt_pk_bf16_f32 v60, -v66, -v67
  v_xor_b32 v46, 0x80008000, v44
  v_mov_b32 v54, v60
  v_mov_b32 v62, v52
  v_mov_b32 v68, v37
  v_fmac_f32 v68, 0x40000000, v36
  v_cos_f32 v64, v68
  v_sin_f32 v66, v68
  v_mov_b32 v69, v37
  v_fmac_f32 v69, 0x40400000, v36
  v_cos_f32 v65, v69
  v_sin_f32 v67, v69
  v_cvt_pk_bf16_f32 v45, v64, v65
  v_cvt_pk_bf16_f32 v53, v66, v67
  v_cvt_pk_bf16_f32 v61, -v66, -v67
  v_xor_b32 v47, 0x80008000, v45
  v_mov_b32 v55, v61
  v_mov_b32 v63, v53
  v_mov_b32 v64, 0x35cccccd
  v_cmp_gt_u32 vcc, 3, v3
  s_nop 1
  v_cndmask_b32 v38, 0, v64, vcc
  v_cmp_gt_u32 vcc, 2, v3
  s_nop 1
  v_cndmask_b32 v39, 0, v64, vcc
  v_fma_f32 v36, v34, 2.0, 0.0
  v_mul_f32 v36, 0x3acccccd, v36
  v_mul_f32 v37, v35, v36
  v_mul_f32 v37, 4.0, v37
  v_mov_b32 v64, v37
  v_fmac_f32 v64, 0x00000000, v36
  v_cos_f32 v70, v64
  v_sin_f32 v78, v64
  v_mul_f32 v70, v38, v70
  v_mul_f32 v78, v38, v78
  v_mov_b32 v64, v37
  v_fmac_f32 v64, 0x3f800000, v36
  v_cos_f32 v71, v64
  v_sin_f32 v79, v64
  v_mul_f32 v71, v38, v71
  v_mul_f32 v79, v38, v79
  v_mov_b32 v64, v37
  v_fmac_f32 v64, 0x40000000, v36
  v_cos_f32 v72, v64
  v_sin_f32 v80, v64
  v_mul_f32 v72, v38, v72
  v_mul_f32 v80, v38, v80
  v_mov_b32 v64, v37
  v_fmac_f32 v64, 0x40400000, v36
  v_cos_f32 v73, v64
  v_sin_f32 v81, v64
  v_mul_f32 v73, v39, v73
  v_mul_f32 v81, v39, v81
  v_fma_f32 v36, v34, 2.0, 1.0
  v_mul_f32 v36, 0x3acccccd, v36
  v_mul_f32 v37, v35, v36
  v_mul_f32 v37, 4.0, v37
  v_mov_b32 v64, v37
  v_fmac_f32 v64, 0x00000000, v36
  v_cos_f32 v74, v64
  v_sin_f32 v82, v64
  v_mul_f32 v74, v38, v74
  v_mul_f32 v82, v38, v82
  v_mov_b32 v64, v37
  v_fmac_f32 v64, 0x3f800000, v36
  v_cos_f32 v75, v64
  v_sin_f32 v83, v64
  v_mul_f32 v75, v38, v75
  v_mul_f32 v83, v38, v83
  v_mov_b32 v64, v37
  v_fmac_f32 v64, 0x40000000, v36
  v_cos_f32 v76, v64
  v_sin_f32 v84, v64
  v_mul_f32 v76, v38, v76
  v_mul_f32 v84, v38, v84
  v_mov_b32 v64, v37
  v_fmac_f32 v64, 0x40400000, v36
  v_cos_f32 v77, v64
  v_sin_f32 v85, v64
  v_mul_f32 v77, v39, v77
  v_mul_f32 v85, v39, v85
  v_mul_f32 v36, 0x3d4ccccd, v34
  v_mul_f32 v37, v35, v36
  v_mul_f32 v37, 4.0, v37
  v_mov_b32 v64, v37
  v_fmac_f32 v64, 0x00000000, v36
  v_cos_f32 v100, v64
  v_sin_f32 v104, v64
  v_mov_b32 v64, v37
  v_fmac_f32 v64, 0x3f800000, v36
  v_cos_f32 v101, v64
  v_sin_f32 v105, v64
  v_mov_b32 v64, v37
  v_fmac_f32 v64, 0x40000000, v36
  v_cos_f32 v102, v64
  v_sin_f32 v106, v64
  v_mov_b32 v64, v37
  v_fmac_f32 v64, 0x40400000, v36
  v_cos_f32 v103, v64
  v_sin_f32 v107, v64
  v_cvt_pk_bf16_f32 v88, v100, v101
  v_cvt_pk_bf16_f32 v89, v102, v103
  v_cvt_pk_bf16_f32 v90, -v104, -v105
  v_cvt_pk_bf16_f32 v91, -v106, -v107
  v_cvt_f32_u32 v36, v13
  v_add_f32 v36, 0x41800000, v36
  v_mul_f32 v36, 0x3d4ccccd, v36
  v_mul_f32 v37, v35, v36
  v_mul_f32 v37, 4.0, v37
  v_mov_b32 v64, v37
  v_fmac_f32 v64, 0x00000000, v36
  v_cos_f32 v100, v64
  v_sin_f32 v104, v64
  v_mov_b32 v64, v37
  v_fmac_f32 v64, 0x3f800000, v36
  v_cos_f32 v101, v64
  v_sin_f32 v105, v64
  v_mov_b32 v64, v37
  v_fmac_f32 v64, 0x40000000, v36
  v_cos_f32 v102, v64
  v_sin_f32 v106, v64
  v_mov_b32 v64, v37
  v_fmac_f32 v64, 0x40400000, v36
  v_cos_f32 v103, v64
  v_sin_f32 v107, v64
  v_cvt_pk_bf16_f32 v92, v100, v101
  v_cvt_pk_bf16_f32 v93, v102, v103
  v_cvt_pk_bf16_f32 v94, -v104, -v105
  v_cvt_pk_bf16_f32 v95, -v106, -v107
  v_cmp_eq_u32 vcc, 1, v12
  s_nop 1
  v_cndmask_b32 v96, 0, v92, vcc
  v_cndmask_b32 v97, 0, v93, vcc
  v_cndmask_b32 v98, 0, v94, vcc
  v_cndmask_b32 v99, 0, v95, vcc
  v_cmp_eq_u32 vcc, 0, v12
  s_nop 1
  v_cndmask_b32 v92, 0, v92, vcc
  v_cndmask_b32 v93, 0, v93, vcc
  v_cndmask_b32 v94, 0, v94, vcc
  v_cndmask_b32 v95, 0, v95, vcc
  s_mov_b32 s28, 0x05040100
  s_mov_b32 s29, 0x07060302
  v_subrev_u32 v64, 1, v2
  v_cmp_gt_u32 vcc, 9, v64
  v_mov_b32 v64, 0x0c0c0c0c
  v_mov_b32 v65, s28
  v_mov_b32 v66, s29
  v_cndmask_b32 v101, v64, v65, vcc
  v_cndmask_b32 v103, v64, v66, vcc
  v_cmp_eq_u32 vcc, 0, v1
  v_mov_b32 v65, 0x0c0c0100
  v_mov_b32 v66, 0x0c0c0302
  v_cndmask_b32 v100, v101, v65, vcc
  v_cndmask_b32 v102, v103, v66, vcc
  v_min_u32 v86, 10, v2
  v_mul_u32_u24 v86, 1032, v86
  v_lshl_add_u32 v86, v3, 7, v86
  s_lshl_b32 s30, s3, 3
  s_add_u32 s30, s30, 126976
  v_add_u32 v86, s30, v86
  s_waitcnt vmcnt(3)
  s_barrier
  ds_read_b64 v[104:105], v86 offset:0
  ds_read_b64 v[106:107], v86 offset:32
  ds_read_b64 v[108:109], v86 offset:64
  ds_read_b64 v[110:111], v86 offset:96
  ds_read_b64 v[112:113], v86 offset:512
  ds_read_b64 v[114:115], v86 offset:544
  ds_read_b64 v[116:117], v86 offset:576
  ds_read_b64 v[118:119], v86 offset:608
  s_waitcnt lgkmcnt(6)
  v_perm_b32 v120, v106, v104, s28
  v_perm_b32 v128, v106, v104, s29
  s_waitcnt lgkmcnt(4)
  v_perm_b32 v121, v110, v108, s28
  v_perm_b32 v129, v110, v108, s29
  s_waitcnt lgkmcnt(2)
  v_perm_b32 v122, v114, v112, v100
  v_perm_b32 v130, v114, v112, v102
  s_waitcnt lgkmcnt(0)
  v_perm_b32 v123, v118, v116, v101
  v_perm_b32 v131, v118, v116, v103
  s_nop 0
  v_mfma_f32_16x16x32_bf16 v[136:139], v[120:123], v[40:43], 0
  v_mfma_f32_16x16x32_bf16 v[152:155], v[128:131], v[40:43], 0
  v_mfma_f32_16x16x32_bf16 v[140:143], v[120:123], v[44:47], 0
  v_mfma_f32_16x16x32_bf16 v[156:159], v[128:131], v[44:47], 0
  v_mfma_f32_16x16x32_bf16 v[136:139], v[128:131], v[56:59], v[136:139]
  v_mfma_f32_16x16x32_bf16 v[152:155], v[120:123], v[48:51], v[152:155]
  v_mfma_f32_16x16x32_bf16 v[140:143], v[128:131], v[60:63], v[140:143]
  v_mfma_f32_16x16x32_bf16 v[156:159], v[120:123], v[52:55], v[156:159]
  v_perm_b32 v124, v107, v105, s28
  v_perm_b32 v132, v107, v105, s29
  v_perm_b32 v125, v111, v109, s28
  v_perm_b32 v133, v111, v109, s29
  v_perm_b32 v126, v115, v113, v100
  v_perm_b32 v134, v115, v113, v102
  v_perm_b32 v127, v119, v117, v101
  v_perm_b32 v135, v119, v117, v103
  s_nop 0
  v_mfma_f32_16x16x32_bf16 v[144:147], v[124:127], v[40:43], 0
  v_mfma_f32_16x16x32_bf16 v[160:163], v[132:135], v[40:43], 0
  v_mfma_f32_16x16x32_bf16 v[148:151], v[124:127], v[44:47], 0
  v_mfma_f32_16x16x32_bf16 v[164:167], v[132:135], v[44:47], 0
  v_mfma_f32_16x16x32_bf16 v[144:147], v[132:135], v[56:59], v[144:147]
  v_mfma_f32_16x16x32_bf16 v[160:163], v[124:127], v[48:51], v[160:163]
  v_mfma_f32_16x16x32_bf16 v[148:151], v[132:135], v[60:63], v[148:151]
  v_mfma_f32_16x16x32_bf16 v[164:167], v[124:127], v[52:55], v[164:167]
  s_waitcnt vmcnt(2)
  v_lshlrev_b32 v192, 16, v20
  v_and_b32 v193, 0xffff0000, v20
  v_lshlrev_b32 v194, 16, v21
  v_and_b32 v195, 0xffff0000, v21
  v_lshlrev_b32 v196, 16, v22
  v_and_b32 v197, 0xffff0000, v22
  v_lshlrev_b32 v198, 16, v23
  v_and_b32 v199, 0xffff0000, v23
  s_waitcnt vmcnt(1)
  v_lshlrev_b32 v200, 16, v24
  v_and_b32 v201, 0xffff0000, v24
  v_lshlrev_b32 v202, 16, v25
  v_and_b32 v203, 0xffff0000, v25
  v_lshlrev_b32 v204, 16, v26
  v_and_b32 v205, 0xffff0000, v26
  v_lshlrev_b32 v206, 16, v27
  v_and_b32 v207, 0xffff0000, v27
  s_waitcnt vmcnt(0)
  v_lshlrev_b32 v208, 16, v28
  v_and_b32 v209, 0xffff0000, v28
  v_lshlrev_b32 v210, 16, v29
  v_and_b32 v211, 0xffff0000, v29
  v_lshlrev_b32 v212, 16, v30
  v_and_b32 v213, 0xffff0000, v30
  v_lshlrev_b32 v214, 16, v31
  v_and_b32 v215, 0xffff0000, v31
  v_pk_mul_f32 v[104:105], v[136:137], v[70:71]
  v_pk_mul_f32 v[112:113], v[152:153], v[70:71]
  v_pk_fma_f32 v[104:105], v[152:153], v[78:79], v[104:105] neg_lo:[1,0,0] neg_hi:[1,0,0]
  v_pk_fma_f32 v[112:113], v[136:137], v[78:79], v[112:113]
  v_pk_mul_f32 v[106:107], v[138:139], v[72:73]
  v_pk_mul_f32 v[114:115], v[154:155], v[72:73]
  v_pk_fma_f32 v[106:107], v[154:155], v[80:81], v[106:107] neg_lo:[1,0,0] neg_hi:[1,0,0]
  v_pk_fma_f32 v[114:115], v[138:139], v[80:81], v[114:115]
  v_pk_mul_f32 v[108:109], v[140:141], v[74:75]
  v_pk_mul_f32 v[116:117], v[156:157], v[74:75]
  v_pk_fma_f32 v[108:109], v[156:157], v[82:83], v[108:109] neg_lo:[1,0,0] neg_hi:[1,0,0]
  v_pk_fma_f32 v[116:117], v[140:141], v[82:83], v[116:117]
  v_pk_mul_f32 v[110:111], v[142:143], v[76:77]
  v_pk_mul_f32 v[118:119], v[158:159], v[76:77]
  v_pk_fma_f32 v[110:111], v[158:159], v[84:85], v[110:111] neg_lo:[1,0,0] neg_hi:[1,0,0]
  v_pk_fma_f32 v[118:119], v[142:143], v[84:85], v[118:119]
  v_cvt_pk_bf16_f32 v120, v104, v105
  v_cvt_pk_bf16_f32 v121, v106, v107
  v_cvt_pk_bf16_f32 v122, v112, v113
  v_cvt_pk_bf16_f32 v123, v114, v115
  s_nop 1
  v_mfma_f32_16x16x32_bf16 v[168:171], v[120:123], v[88:91], 0
  v_mfma_f32_16x16x32_bf16 v[184:187], v[120:123], v[92:95], 0
  v_cvt_pk_bf16_f32 v128, v108, v109
  v_cvt_pk_bf16_f32 v129, v110, v111
  v_cvt_pk_bf16_f32 v130, v116, v117
  v_cvt_pk_bf16_f32 v131, v118, v119
  s_nop 1
  v_mfma_f32_16x16x32_bf16 v[172:175], v[128:131], v[88:91], 0
  v_mfma_f32_16x16x32_bf16 v[188:191], v[128:131], v[92:95], 0
  v_pk_mul_f32 v[104:105], v[144:145], v[70:71]
  v_pk_mul_f32 v[112:113], v[160:161], v[70:71]
  v_pk_fma_f32 v[104:105], v[160:161], v[78:79], v[104:105] neg_lo:[1,0,0] neg_hi:[1,0,0]
  v_pk_fma_f32 v[112:113], v[144:145], v[78:79], v[112:113]
  v_pk_mul_f32 v[106:107], v[146:147], v[72:73]
  v_pk_mul_f32 v[114:115], v[162:163], v[72:73]
  v_pk_fma_f32 v[106:107], v[162:163], v[80:81], v[106:107] neg_lo:[1,0,0] neg_hi:[1,0,0]
  v_pk_fma_f32 v[114:115], v[146:147], v[80:81], v[114:115]
  v_pk_mul_f32 v[108:109], v[148:149], v[74:75]
  v_pk_mul_f32 v[116:117], v[164:165], v[74:75]
  v_pk_fma_f32 v[108:109], v[164:165], v[82:83], v[108:109] neg_lo:[1,0,0] neg_hi:[1,0,0]
  v_pk_fma_f32 v[116:117], v[148:149], v[82:83], v[116:117]
  v_pk_mul_f32 v[110:111], v[150:151], v[76:77]
  v_pk_mul_f32 v[118:119], v[166:167], v[76:77]
  v_pk_fma_f32 v[110:111], v[166:167], v[84:85], v[110:111] neg_lo:[1,0,0] neg_hi:[1,0,0]
  v_pk_fma_f32 v[118:119], v[150:151], v[84:85], v[118:119]
  v_cvt_pk_bf16_f32 v124, v104, v105
  v_cvt_pk_bf16_f32 v125, v106, v107
  v_cvt_pk_bf16_f32 v126, v112, v113
  v_cvt_pk_bf16_f32 v127, v114, v115
  s_nop 1
  v_mfma_f32_16x16x32_bf16 v[176:179], v[124:127], v[88:91], 0
  v_mfma_f32_16x16x32_bf16 v[184:187], v[124:127], v[96:99], v[184:187]
  v_cvt_pk_bf16_f32 v132, v108, v109
  v_cvt_pk_bf16_f32 v133, v110, v111
  v_cvt_pk_bf16_f32 v134, v116, v117
  v_cvt_pk_bf16_f32 v135, v118, v119
  s_nop 1
  v_mfma_f32_16x16x32_bf16 v[180:183], v[132:135], v[88:91], 0
  v_mfma_f32_16x16x32_bf16 v[188:191], v[132:135], v[96:99], v[188:191]
  s_mov_b32 s36, 0x00ff00ff
  s_mov_b32 s37, 0x00ff00ff
  v_cvt_pk_bf16_f32 v64, v168, v172
  v_lshlrev_b32 v66, 16, v64
  v_and_b32 v67, 0xffff0000, v64
  v_pk_add_f32 v[192:193], v[192:193], v[66:67]
  v_cvt_pk_bf16_f32 v20, v192, v193
  v_lshlrev_b32 v192, 16, v20
  v_and_b32 v193, 0xffff0000, v20
  v_cvt_pk_bf16_f32 v64, v169, v173
  v_lshlrev_b32 v66, 16, v64
  v_and_b32 v67, 0xffff0000, v64
  v_pk_add_f32 v[194:195], v[194:195], v[66:67]
  v_cvt_pk_bf16_f32 v21, v194, v195
  v_lshlrev_b32 v194, 16, v21
  v_and_b32 v195, 0xffff0000, v21
  v_cvt_pk_bf16_f32 v64, v170, v174
  v_lshlrev_b32 v66, 16, v64
  v_and_b32 v67, 0xffff0000, v64
  v_pk_add_f32 v[196:197], v[196:197], v[66:67]
  v_cvt_pk_bf16_f32 v22, v196, v197
  v_lshlrev_b32 v196, 16, v22
  v_and_b32 v197, 0xffff0000, v22
  v_cvt_pk_bf16_f32 v64, v171, v175
  v_lshlrev_b32 v66, 16, v64
  v_and_b32 v67, 0xffff0000, v64
  v_pk_add_f32 v[198:199], v[198:199], v[66:67]
  v_cvt_pk_bf16_f32 v23, v198, v199
  v_lshlrev_b32 v198, 16, v23
  v_and_b32 v199, 0xffff0000, v23
  ds_write_b128 v18, v[20:23] offset:10560
  v_cvt_pk_bf16_f32 v64, v176, v180
  v_lshlrev_b32 v66, 16, v64
  v_and_b32 v67, 0xffff0000, v64
  v_pk_add_f32 v[200:201], v[200:201], v[66:67]
  v_cvt_pk_bf16_f32 v24, v200, v201
  v_lshlrev_b32 v200, 16, v24
  v_and_b32 v201, 0xffff0000, v24
  v_cvt_pk_bf16_f32 v64, v177, v181
  v_lshlrev_b32 v66, 16, v64
  v_and_b32 v67, 0xffff0000, v64
  v_pk_add_f32 v[202:203], v[202:203], v[66:67]
  v_cvt_pk_bf16_f32 v25, v202, v203
  v_lshlrev_b32 v202, 16, v25
  v_and_b32 v203, 0xffff0000, v25
  v_cvt_pk_bf16_f32 v64, v178, v182
  v_lshlrev_b32 v66, 16, v64
  v_and_b32 v67, 0xffff0000, v64
  v_pk_add_f32 v[204:205], v[204:205], v[66:67]
  v_cvt_pk_bf16_f32 v26, v204, v205
  v_lshlrev_b32 v204, 16, v26
  v_and_b32 v205, 0xffff0000, v26
  v_cvt_pk_bf16_f32 v64, v179, v183
  v_lshlrev_b32 v66, 16, v64
  v_and_b32 v67, 0xffff0000, v64
  v_pk_add_f32 v[206:207], v[206:207], v[66:67]
  v_cvt_pk_bf16_f32 v27, v206, v207
  v_lshlrev_b32 v206, 16, v27
  v_and_b32 v207, 0xffff0000, v27
  ds_write_b128 v18, v[24:27] offset:10576
  v_cvt_pk_bf16_f32 v64, v184, v188
  v_lshlrev_b32 v66, 16, v64
  v_and_b32 v67, 0xffff0000, v64
  v_pk_add_f32 v[208:209], v[208:209], v[66:67]
  v_cvt_pk_bf16_f32 v28, v208, v209
  v_lshlrev_b32 v208, 16, v28
  v_and_b32 v209, 0xffff0000, v28
  v_cvt_pk_bf16_f32 v64, v185, v189
  v_lshlrev_b32 v66, 16, v64
  v_and_b32 v67, 0xffff0000, v64
  v_pk_add_f32 v[210:211], v[210:211], v[66:67]
  v_cvt_pk_bf16_f32 v29, v210, v211
  v_lshlrev_b32 v210, 16, v29
  v_and_b32 v211, 0xffff0000, v29
  v_cvt_pk_bf16_f32 v64, v186, v190
  v_lshlrev_b32 v66, 16, v64
  v_and_b32 v67, 0xffff0000, v64
  v_pk_add_f32 v[212:213], v[212:213], v[66:67]
  v_cvt_pk_bf16_f32 v30, v212, v213
  v_lshlrev_b32 v212, 16, v30
  v_and_b32 v213, 0xffff0000, v30
  v_cvt_pk_bf16_f32 v64, v187, v191
  v_lshlrev_b32 v66, 16, v64
  v_and_b32 v67, 0xffff0000, v64
  v_pk_add_f32 v[214:215], v[214:215], v[66:67]
  v_cvt_pk_bf16_f32 v31, v214, v215
  v_lshlrev_b32 v214, 16, v31
  v_and_b32 v215, 0xffff0000, v31
  s_mov_b64 exec, s[36:37]
  ds_write_b128 v19, v[28:31] offset:10560
  s_mov_b64 exec, -1
  v_pk_add_f32 v[216:217], v[192:193], v[194:195]
  v_pk_mul_f32 v[218:219], v[192:193], v[192:193]
  v_pk_fma_f32 v[218:219], v[194:195], v[194:195], v[218:219]
  v_pk_add_f32 v[216:217], v[216:217], v[196:197]
  v_pk_fma_f32 v[218:219], v[196:197], v[196:197], v[218:219]
  v_pk_add_f32 v[216:217], v[216:217], v[198:199]
  v_pk_fma_f32 v[218:219], v[198:199], v[198:199], v[218:219]
  v_add_f32 v216, v216, v217
  v_add_f32 v218, v218, v219
  v_pk_add_f32 v[220:221], v[200:201], v[202:203]
  v_pk_mul_f32 v[222:223], v[200:201], v[200:201]
  v_pk_fma_f32 v[222:223], v[202:203], v[202:203], v[222:223]
  v_pk_add_f32 v[220:221], v[220:221], v[204:205]
  v_pk_fma_f32 v[222:223], v[204:205], v[204:205], v[222:223]
  v_pk_add_f32 v[220:221], v[220:221], v[206:207]
  v_pk_fma_f32 v[222:223], v[206:207], v[206:207], v[222:223]
  v_add_f32 v220, v220, v221
  v_add_f32 v222, v222, v223
  v_pk_add_f32 v[224:225], v[208:209], v[210:211]
  v_pk_mul_f32 v[226:227], v[208:209], v[208:209]
  v_pk_fma_f32 v[226:227], v[210:211], v[210:211], v[226:227]
  v_pk_add_f32 v[224:225], v[224:225], v[212:213]
  v_pk_fma_f32 v[226:227], v[212:213], v[212:213], v[226:227]
  v_pk_add_f32 v[224:225], v[224:225], v[214:215]
  v_pk_fma_f32 v[226:227], v[214:215], v[214:215], v[226:227]
  v_add_f32 v224, v224, v225
  v_add_f32 v226, v226, v227
  v_fmac_f32 v216, v16, v224
  v_fmac_f32 v218, v16, v226
  v_fmac_f32 v220, v17, v224
  v_fmac_f32 v222, v17, v226
  v_permlane32_swap_b32 v216, v218
  s_nop 0
  v_permlane32_swap_b32 v220, v222
  v_add_f32 v216, v216, v218
  v_add_f32 v220, v220, v222
  s_nop 1
  v_permlane16_swap_b32 v216, v220
  v_add_f32 v216, v216, v220
  s_nop 1
  v_add_f32_dpp v216, v216, v216 row_ror:8 row_mask:0xf bank_mask:0xf
  s_nop 1
  v_add_f32_dpp v216, v216, v216 row_ror:4 row_mask:0xf bank_mask:0xf
  s_nop 1
  v_add_f32_dpp v216, v216, v216 row_ror:2 row_mask:0xf bank_mask:0xf
  s_nop 1
  v_add_f32_dpp v216, v216, v216 row_ror:1 row_mask:0xf bank_mask:0xf
  v_mov_b32 v217, v216
  s_nop 1
  v_permlane32_swap_b32 v216, v217
  v_mul_f32 v216, 0x3acccccd, v216
  v_mul_f32 v217, 0x3acccccd, v217
  v_fma_f32 v217, -v216, v216, v217
  v_max_f32 v217, 0, v217
  v_cvt_pk_bf16_f32 v218, v216, v217
  v_lshlrev_b32 v216, 16, v218
  v_and_b32 v217, 0xffff0000, v218
  v_add_f32 v217, 0x3727c5ac, v217
  v_cvt_pk_bf16_f32 v217, v217, v217
  v_lshlrev_b32 v217, 16, v217
  v_sqrt_f32 v217, v217
  s_nop 0
  v_cvt_pk_bf16_f32 v217, v217, v217
  v_lshlrev_b32 v217, 16, v217
  v_rcp_f32 v217, v217
  v_lshlrev_b32 v64, 3, v3
  s_mov_b64 exec, 0x10001
  buffer_store_dwordx2 v[216:217], v64, s[24:27], s12 offen sc1
  s_mov_b64 exec, -1
  v_readlane_b32 s32, v216, 0
  v_readlane_b32 s33, v217, 0
  v_readlane_b32 s34, v216, 16
  v_readlane_b32 s35, v217, 16
  v_mov_b32 v228, s32
  v_mov_b32 v234, s33
  v_mov_b32 v230, s34
  v_mov_b32 v236, s35
  v_mul_f32 v232, v16, v228
  v_fmac_f32 v232, v17, v230
  v_mul_f32 v238, v16, v234
  v_fmac_f32 v238, v17, v236
  v_pk_add_f32 v[192:193], v[192:193], v[228:229] op_sel_hi:[1,0] neg_lo:[0,1] neg_hi:[0,1]
  v_cvt_pk_bf16_f32 v64, v192, v193
  v_lshlrev_b32 v192, 16, v64
  v_and_b32 v193, 0xffff0000, v64
  v_pk_mul_f32 v[192:193], v[192:193], v[234:235] op_sel_hi:[1,0]
  v_cvt_pk_bf16_f32 v64, v192, v193
  v_lshlrev_b32 v192, 16, v64
  v_and_b32 v193, 0xffff0000, v64
  v_pk_add_f32 v[194:195], v[194:195], v[228:229] op_sel_hi:[1,0] neg_lo:[0,1] neg_hi:[0,1]
  v_cvt_pk_bf16_f32 v64, v194, v195
  v_lshlrev_b32 v194, 16, v64
  v_and_b32 v195, 0xffff0000, v64
  v_pk_mul_f32 v[194:195], v[194:195], v[234:235] op_sel_hi:[1,0]
  v_cvt_pk_bf16_f32 v64, v194, v195
  v_lshlrev_b32 v194, 16, v64
  v_and_b32 v195, 0xffff0000, v64
  v_pk_add_f32 v[196:197], v[196:197], v[228:229] op_sel_hi:[1,0] neg_lo:[0,1] neg_hi:[0,1]
  v_cvt_pk_bf16_f32 v64, v196, v197
  v_lshlrev_b32 v196, 16, v64
  v_and_b32 v197, 0xffff0000, v64
  v_pk_mul_f32 v[196:197], v[196:197], v[234:235] op_sel_hi:[1,0]
  v_cvt_pk_bf16_f32 v64, v196, v197
  v_lshlrev_b32 v196, 16, v64
  v_and_b32 v197, 0xffff0000, v64
  v_pk_add_f32 v[198:199], v[198:199], v[228:229] op_sel_hi:[1,0] neg_lo:[0,1] neg_hi:[0,1]
  v_cvt_pk_bf16_f32 v64, v198, v199
  v_lshlrev_b32 v198, 16, v64
  v_and_b32 v199, 0xffff0000, v64
  v_pk_mul_f32 v[198:199], v[198:199], v[234:235] op_sel_hi:[1,0]
  v_cvt_pk_bf16_f32 v64, v198, v199
  v_lshlrev_b32 v198, 16, v64
  v_and_b32 v199, 0xffff0000, v64
  v_pk_add_f32 v[200:201], v[200:201], v[230:231] op_sel_hi:[1,0] neg_lo:[0,1] neg_hi:[0,1]
  v_cvt_pk_bf16_f32 v64, v200, v201
  v_lshlrev_b32 v200, 16, v64
  v_and_b32 v201, 0xffff0000, v64
  v_pk_mul_f32 v[200:201], v[200:201], v[236:237] op_sel_hi:[1,0]
  v_cvt_pk_bf16_f32 v64, v200, v201
  v_lshlrev_b32 v200, 16, v64
  v_and_b32 v201, 0xffff0000, v64
  v_pk_add_f32 v[202:203], v[202:203], v[230:231] op_sel_hi:[1,0] neg_lo:[0,1] neg_hi:[0,1]
  v_cvt_pk_bf16_f32 v64, v202, v203
  v_lshlrev_b32 v202, 16, v64
  v_and_b32 v203, 0xffff0000, v64
  v_pk_mul_f32 v[202:203], v[202:203], v[236:237] op_sel_hi:[1,0]
  v_cvt_pk_bf16_f32 v64, v202, v203
  v_lshlrev_b32 v202, 16, v64
  v_and_b32 v203, 0xffff0000, v64
  v_pk_add_f32 v[204:205], v[204:205], v[230:231] op_sel_hi:[1,0] neg_lo:[0,1] neg_hi:[0,1]
  v_cvt_pk_bf16_f32 v64, v204, v205
  v_lshlrev_b32 v204, 16, v64
  v_and_b32 v205, 0xffff0000, v64
  v_pk_mul_f32 v[204:205], v[204:205], v[236:237] op_sel_hi:[1,0]
  v_cvt_pk_bf16_f32 v64, v204, v205
  v_lshlrev_b32 v204, 16, v64
  v_and_b32 v205, 0xffff0000, v64
  v_pk_add_f32 v[206:207], v[206:207], v[230:231] op_sel_hi:[1,0] neg_lo:[0,1] neg_hi:[0,1]
  v_cvt_pk_bf16_f32 v64, v206, v207
  v_lshlrev_b32 v206, 16, v64
  v_and_b32 v207, 0xffff0000, v64
  v_pk_mul_f32 v[206:207], v[206:207], v[236:237] op_sel_hi:[1,0]
  v_cvt_pk_bf16_f32 v64, v206, v207
  v_lshlrev_b32 v206, 16, v64
  v_and_b32 v207, 0xffff0000, v64
  v_pk_add_f32 v[208:209], v[208:209], v[232:233] op_sel_hi:[1,0] neg_lo:[0,1] neg_hi:[0,1]
  v_cvt_pk_bf16_f32 v64, v208, v209
  v_lshlrev_b32 v208, 16, v64
  v_and_b32 v209, 0xffff0000, v64
  v_pk_mul_f32 v[208:209], v[208:209], v[238:239] op_sel_hi:[1,0]
  v_cvt_pk_bf16_f32 v64, v208, v209
  v_lshlrev_b32 v208, 16, v64
  v_and_b32 v209, 0xffff0000, v64
  v_pk_add_f32 v[210:211], v[210:211], v[232:233] op_sel_hi:[1,0] neg_lo:[0,1] neg_hi:[0,1]
  v_cvt_pk_bf16_f32 v64, v210, v211
  v_lshlrev_b32 v210, 16, v64
  v_and_b32 v211, 0xffff0000, v64
  v_pk_mul_f32 v[210:211], v[210:211], v[238:239] op_sel_hi:[1,0]
  v_cvt_pk_bf16_f32 v64, v210, v211
  v_lshlrev_b32 v210, 16, v64
  v_and_b32 v211, 0xffff0000, v64
  v_pk_add_f32 v[212:213], v[212:213], v[232:233] op_sel_hi:[1,0] neg_lo:[0,1] neg_hi:[0,1]
  v_cvt_pk_bf16_f32 v64, v212, v213
  v_lshlrev_b32 v212, 16, v64
  v_and_b32 v213, 0xffff0000, v64
  v_pk_mul_f32 v[212:213], v[212:213], v[238:239] op_sel_hi:[1,0]
  v_cvt_pk_bf16_f32 v64, v212, v213
  v_lshlrev_b32 v212, 16, v64
  v_and_b32 v213, 0xffff0000, v64
  v_pk_add_f32 v[214:215], v[214:215], v[232:233] op_sel_hi:[1,0] neg_lo:[0,1] neg_hi:[0,1]
  v_cvt_pk_bf16_f32 v64, v214, v215
  v_lshlrev_b32 v214, 16, v64
  v_and_b32 v215, 0xffff0000, v64
  v_pk_mul_f32 v[214:215], v[214:215], v[238:239] op_sel_hi:[1,0]
  v_cvt_pk_bf16_f32 v64, v214, v215
  v_lshlrev_b32 v214, 16, v64
  v_and_b32 v215, 0xffff0000, v64
  v_pk_add_f32 v[216:217], v[192:193], v[194:195]
  v_pk_mul_f32 v[218:219], v[192:193], v[192:193]
  v_pk_fma_f32 v[218:219], v[194:195], v[194:195], v[218:219]
  v_pk_add_f32 v[216:217], v[216:217], v[196:197]
  v_pk_fma_f32 v[218:219], v[196:197], v[196:197], v[218:219]
  v_pk_add_f32 v[216:217], v[216:217], v[198:199]
  v_pk_fma_f32 v[218:219], v[198:199], v[198:199], v[218:219]
  v_add_f32 v216, v216, v217
  v_add_f32 v218, v218, v219
  v_pk_add_f32 v[220:221], v[200:201], v[202:203]
  v_pk_mul_f32 v[222:223], v[200:201], v[200:201]
  v_pk_fma_f32 v[222:223], v[202:203], v[202:203], v[222:223]
  v_pk_add_f32 v[220:221], v[220:221], v[204:205]
  v_pk_fma_f32 v[222:223], v[204:205], v[204:205], v[222:223]
  v_pk_add_f32 v[220:221], v[220:221], v[206:207]
  v_pk_fma_f32 v[222:223], v[206:207], v[206:207], v[222:223]
  v_add_f32 v220, v220, v221
  v_add_f32 v222, v222, v223
  v_pk_add_f32 v[224:225], v[208:209], v[210:211]
  v_pk_mul_f32 v[226:227], v[208:209], v[208:209]
  v_pk_fma_f32 v[226:227], v[210:211], v[210:211], v[226:227]
  v_pk_add_f32 v[224:225], v[224:225], v[212:213]
  v_pk_fma_f32 v[226:227], v[212:213], v[212:213], v[226:227]
  v_pk_add_f32 v[224:225], v[224:225], v[214:215]
  v_pk_fma_f32 v[226:227], v[214:215], v[214:215], v[226:227]
  v_add_f32 v224, v224, v225
  v_add_f32 v226, v226, v227
  v_fmac_f32 v216, v16, v224
  v_fmac_f32 v218, v16, v226
  v_fmac_f32 v220, v17, v224
  v_fmac_f32 v222, v17, v226
  v_permlane32_swap_b32 v216, v218
  s_nop 0
  v_permlane32_swap_b32 v220, v222
  v_add_f32 v216, v216, v218
  v_add_f32 v220, v220, v222
  s_nop 1
  v_permlane16_swap_b32 v216, v220
  v_add_f32 v216, v216, v220
  s_nop 1
  v_add_f32_dpp v216, v216, v216 row_ror:8 row_mask:0xf bank_mask:0xf
  s_nop 1
  v_add_f32_dpp v216, v216, v216 row_ror:4 row_mask:0xf bank_mask:0xf
  s_nop 1
  v_add_f32_dpp v216, v216, v216 row_ror:2 row_mask:0xf bank_mask:0xf
  s_nop 1
  v_add_f32_dpp v216, v216, v216 row_ror:1 row_mask:0xf bank_mask:0xf
  v_mov_b32 v217, v216
  s_nop 1
  v_permlane32_swap_b32 v216, v217
  v_mul_f32 v216, 0x3acccccd, v216
  v_mul_f32 v217, 0x3acccccd, v217
  v_fma_f32 v217, -v216, v216, v217
  v_max_f32 v217, 0, v217
  v_cvt_pk_bf16_f32 v218, v216, v217
  v_lshlrev_b32 v216, 16, v218
  v_and_b32 v217, 0xffff0000, v218
  v_add_f32 v217, 0x3727c5ac, v217
  v_cvt_pk_bf16_f32 v217, v217, v217
  v_lshlrev_b32 v217, 16, v217
  v_sqrt_f32 v217, v217
  s_nop 0
  v_cvt_pk_bf16_f32 v217, v217, v217
  v_lshlrev_b32 v217, 16, v217
  v_rcp_f32 v217, v217
  v_readlane_b32 s32, v216, 0
  v_readlane_b32 s33, v217, 0
  v_readlane_b32 s34, v216, 16
  v_readlane_b32 s35, v217, 16
  v_mov_b32 v228, s32
  v_mov_b32 v234, s33
  v_mov_b32 v230, s34
  v_mov_b32 v236, s35
  v_mul_f32 v232, v16, v228
  v_fmac_f32 v232, v17, v230
  v_mul_f32 v238, v16, v234
  v_fmac_f32 v238, v17, v236
  v_pk_add_f32 v[192:193], v[192:193], v[228:229] op_sel_hi:[1,0] neg_lo:[0,1] neg_hi:[0,1]
  v_cvt_pk_bf16_f32 v64, v192, v193
  v_lshlrev_b32 v192, 16, v64
  v_and_b32 v193, 0xffff0000, v64
  v_pk_mul_f32 v[192:193], v[192:193], v[234:235] op_sel_hi:[1,0]
  v_cvt_pk_bf16_f32 v168, v192, v193
  v_pk_add_f32 v[194:195], v[194:195], v[228:229] op_sel_hi:[1,0] neg_lo:[0,1] neg_hi:[0,1]
  v_cvt_pk_bf16_f32 v64, v194, v195
  v_lshlrev_b32 v194, 16, v64
  v_and_b32 v195, 0xffff0000, v64
  v_pk_mul_f32 v[194:195], v[194:195], v[234:235] op_sel_hi:[1,0]
  v_cvt_pk_bf16_f32 v169, v194, v195
  v_pk_add_f32 v[196:197], v[196:197], v[228:229] op_sel_hi:[1,0] neg_lo:[0,1] neg_hi:[0,1]
  v_cvt_pk_bf16_f32 v64, v196, v197
  v_lshlrev_b32 v196, 16, v64
  v_and_b32 v197, 0xffff0000, v64
  v_pk_mul_f32 v[196:197], v[196:197], v[234:235] op_sel_hi:[1,0]
  v_cvt_pk_bf16_f32 v170, v196, v197
  v_pk_add_f32 v[198:199], v[198:199], v[228:229] op_sel_hi:[1,0] neg_lo:[0,1] neg_hi:[0,1]
  v_cvt_pk_bf16_f32 v64, v198, v199
  v_lshlrev_b32 v198, 16, v64
  v_and_b32 v199, 0xffff0000, v64
  v_pk_mul_f32 v[198:199], v[198:199], v[234:235] op_sel_hi:[1,0]
  v_cvt_pk_bf16_f32 v171, v198, v199
  ds_write_b128 v18, v[168:171] offset:0
  v_pk_add_f32 v[200:201], v[200:201], v[230:231] op_sel_hi:[1,0] neg_lo:[0,1] neg_hi:[0,1]
  v_cvt_pk_bf16_f32 v64, v200, v201
  v_lshlrev_b32 v200, 16, v64
  v_and_b32 v201, 0xffff0000, v64
  v_pk_mul_f32 v[200:201], v[200:201], v[236:237] op_sel_hi:[1,0]
  v_cvt_pk_bf16_f32 v176, v200, v201
  v_pk_add_f32 v[202:203], v[202:203], v[230:231] op_sel_hi:[1,0] neg_lo:[0,1] neg_hi:[0,1]
  v_cvt_pk_bf16_f32 v64, v202, v203
  v_lshlrev_b32 v202, 16, v64
  v_and_b32 v203, 0xffff0000, v64
  v_pk_mul_f32 v[202:203], v[202:203], v[236:237] op_sel_hi:[1,0]
  v_cvt_pk_bf16_f32 v177, v202, v203
  v_pk_add_f32 v[204:205], v[204:205], v[230:231] op_sel_hi:[1,0] neg_lo:[0,1] neg_hi:[0,1]
  v_cvt_pk_bf16_f32 v64, v204, v205
  v_lshlrev_b32 v204, 16, v64
  v_and_b32 v205, 0xffff0000, v64
  v_pk_mul_f32 v[204:205], v[204:205], v[236:237] op_sel_hi:[1,0]
  v_cvt_pk_bf16_f32 v178, v204, v205
  v_pk_add_f32 v[206:207], v[206:207], v[230:231] op_sel_hi:[1,0] neg_lo:[0,1] neg_hi:[0,1]
  v_cvt_pk_bf16_f32 v64, v206, v207
  v_lshlrev_b32 v206, 16, v64
  v_and_b32 v207, 0xffff0000, v64
  v_pk_mul_f32 v[206:207], v[206:207], v[236:237] op_sel_hi:[1,0]
  v_cvt_pk_bf16_f32 v179, v206, v207
  ds_write_b128 v18, v[176:179] offset:16
  v_pk_add_f32 v[208:209], v[208:209], v[232:233] op_sel_hi:[1,0] neg_lo:[0,1] neg_hi:[0,1]
  v_cvt_pk_bf16_f32 v64, v208, v209
  v_lshlrev_b32 v208, 16, v64
  v_and_b32 v209, 0xffff0000, v64
  v_pk_mul_f32 v[208:209], v[208:209], v[238:239] op_sel_hi:[1,0]
  v_cvt_pk_bf16_f32 v184, v208, v209
  v_pk_add_f32 v[210:211], v[210:211], v[232:233] op_sel_hi:[1,0] neg_lo:[0,1] neg_hi:[0,1]
  v_cvt_pk_bf16_f32 v64, v210, v211
  v_lshlrev_b32 v210, 16, v64
  v_and_b32 v211, 0xffff0000, v64
  v_pk_mul_f32 v[210:211], v[210:211], v[238:239] op_sel_hi:[1,0]
  v_cvt_pk_bf16_f32 v185, v210, v211
  v_pk_add_f32 v[212:213], v[212:213], v[232:233] op_sel_hi:[1,0] neg_lo:[0,1] neg_hi:[0,1]
  v_cvt_pk_bf16_f32 v64, v212, v213
  v_lshlrev_b32 v212, 16, v64
  v_and_b32 v213, 0xffff0000, v64
  v_pk_mul_f32 v[212:213], v[212:213], v[238:239] op_sel_hi:[1,0]
  v_cvt_pk_bf16_f32 v186, v212, v213
  v_pk_add_f32 v[214:215], v[214:215], v[232:233] op_sel_hi:[1,0] neg_lo:[0,1] neg_hi:[0,1]
  v_cvt_pk_bf16_f32 v64, v214, v215
  v_lshlrev_b32 v214, 16, v64
  v_and_b32 v215, 0xffff0000, v64
  v_pk_mul_f32 v[214:215], v[214:215], v[238:239] op_sel_hi:[1,0]
  v_cvt_pk_bf16_f32 v187, v214, v215
  s_mov_b64 exec, s[36:37]
  ds_write_b128 v19, v[184:187] offset:0
  s_mov_b64 exec, -1
  s_add_u32 s28, s13, 4194304
  s_add_u32 s29, s13, 5242880
  s_add_u32 s30, s13, 6291456
  s_sub_u32 s31, s13, 524288
  s_cmp_lt_u32 s3, 2
  s_cselect_b32 s30, s30, s31
  s_add_u32 s31, s13, 524288
  s_add_u32 s32, s13, 1572864
  s_waitcnt lgkmcnt(0)
  s_barrier
  ds_read_b128 v[236:239], v32 offset:0
  ds_read_b128 v[240:243], v32 offset:4224
  ds_read_b128 v[244:247], v32 offset:8448
  ds_read_b128 v[248:251], v32 offset:12672
  ds_read_b128 v[252:255], v32 offset:16896
  s_waitcnt lgkmcnt(4)
  buffer_store_dwordx4 v[236:239], v33, s[16:19], s28 offen sc1
  s_waitcnt lgkmcnt(3)
  buffer_store_dwordx4 v[240:243], v33, s[16:19], s29 offen sc1
  s_waitcnt lgkmcnt(2)
  buffer_store_dwordx4 v[244:247], v33, s[16:19], s30 offen sc1
  s_waitcnt lgkmcnt(1)
  buffer_store_dwordx4 v[248:251], v33, s[16:19], s31 offen sc1
  s_waitcnt lgkmcnt(0)
  buffer_store_dwordx4 v[252:255], v33, s[16:19], s32 offen sc1
  s_barrier
  v_add_u32 v10, 65536, v4
  v_add_u32 v11, 131072, v4
  v_lshrrev_b32 v13, 1, v3
  v_lshlrev_b32 v13, 8, v13
  v_lshl_add_u32 v13, v2, 4, v13
  v_lshlrev_b32 v14, 31, v3
  v_or_b32 v13, v14, v13
  s_and_b32 s12, s2, 7
  s_lshl_b32 s12, s12, 2
  s_lshr_b32 s13, s2, 3
  s_and_b32 s8, s13, 3
  s_add_u32 s12, s12, s8
  s_lshr_b32 s13, s13, 2
  s_lshl_b32 s12, s12, 6
  s_lshl_b32 s8, s3, 4
  s_add_u32 s12, s12, s8
  s_lshl_b32 s11, s12, 6
  v_add_u32 v5, s12, v2
  s_mul_i32 s24, s13, 5
  s_add_u32 s25, s24, 1
  s_lshr_b32 s25, s25, 1
  s_and_b32 s26, s13, 1
  s_add_u32 s27, s25, 2
  s_sub_u32 s28, s25, 1
  s_cmp_eq_u32 s26, 0
  s_cselect_b32 s27, s27, s28
  s_lshl_b32 s26, s26, 3
  s_add_u32 s24, s25, 0
  s_lshl_b32 s42, s24, 17
  s_add_u32 s42, s42, s11
  s_add_u32 s24, s25, 1
  s_lshl_b32 s43, s24, 17
  s_add_u32 s43, s43, s11
  s_lshl_b32 s44, s27, 17
  s_add_u32 s44, s44, s11
  s_add_u32 s46, s44, s26
  s_lshl_b32 s24, s26, 6
  s_add_u32 s44, s44, s24
  s_lshr_b32 s8, s12, 3
  s_lshl_b32 s8, s8, 8
  v_lshl_add_u32 v9, v1, 8, s8
  s_lshr_b32 s8, s12, 6
  s_lshl_b32 s8, s8, 3
  s_add_u32 s8, s8, s13
  s_lshl_b32 s8, s8, 8
  s_add_u32 s53, s8, 65536
  s_mov_b32 s10, 0
  s_lshl_b32 s10, s10, 17
  s_add_u32 s10, s10, s11
  s_add_u32 s20, s14, 0x1000000
  s_addc_u32 s21, s15, 0
  s_mov_b32 s22, 0x280000
  s_mov_b32 s23, 0x00020000
  s_add_u32 s32, s14, 0xc00000
  s_addc_u32 s33, s15, 0
  s_mov_b32 s34, 0x280000
  s_mov_b32 s35, 0x00020000
  s_add_u32 s36, s14, 0x3b40000
  s_addc_u32 s37, s15, 0
  s_mov_b32 s38, 0x4000
  s_mov_b32 s39, 0x00020000
  v_lshlrev_b32 v12, 3, v5
  v_mov_b32 v50, 0xbdd2d3e8
  v_mov_b32 v52, 0xc0135761
  v_mov_b32 v54, 1.0
  s_waitcnt vmcnt(0)
  s_mov_b64 exec, 1
  ds_add_rtn_u32 v8, v6, v7
  s_waitcnt lgkmcnt(0)
  v_readfirstlane_b32 s41, v8
  s_nop 0
  s_cmp_lg_u32 s41, 3
  s_cbranch_scc1 kf_kernel_ns101
  buffer_store_dword v7, off, s[48:51], s52 sc1
kf_kernel_ns101:
  s_add_u32 s24, s14, 0x1800000
  s_addc_u32 s25, s15, 0
  s_mov_b32 s26, 0x280000
  s_mov_b32 s27, 0x00020000
  s_mov_b64 exec, -1
  ds_read_b128 v[76:79], v4 offset:0
  ds_read_b128 v[80:83], v4 offset:1024
  ds_read_b128 v[84:87], v4 offset:2048
  ds_read_b128 v[88:91], v4 offset:3072
  ds_read_b128 v[92:95], v4 offset:4096
  ds_read_b128 v[96:99], v4 offset:5120
  ds_read_b128 v[100:103], v4 offset:6144
  ds_read_b128 v[104:107], v4 offset:7168
  ds_read_b128 v[108:111], v4 offset:8192
  ds_read_b128 v[112:115], v4 offset:9216
  ds_read_b128 v[116:119], v4 offset:10240
  ds_read_b128 v[120:123], v4 offset:11264
  ds_read_b128 v[124:127], v4 offset:12288
  ds_read_b128 v[128:131], v4 offset:13312
  ds_read_b128 v[132:135], v4 offset:14336
  s_mov_b64 exec, 3
  s_movk_i32 s40, 30000
kf_kernel_pl102:
  buffer_load_dword v8, v9, s[48:51], 0 offen sc1
  s_waitcnt vmcnt(0)
  v_cmp_eq_u32 vcc, 0, v8
  s_cbranch_vccz kf_kernel_pd103
  s_sub_u32 s40, s40, 1
  s_cbranch_scc0 kf_kernel_pl102
kf_kernel_pd103:
  s_mov_b64 exec, -1
  buffer_load_dwordx4 v[156:159], v4, s[20:23], s10 offen offset:0 sc1
  s_add_u32 s10, s10, 0x20000
  buffer_load_dwordx4 v[160:163], v4, s[20:23], s10 offen offset:0 sc1
  s_add_u32 s10, s10, 0x20000
  buffer_load_dwordx4 v[164:167], v4, s[20:23], s10 offen offset:0 sc1
  s_add_u32 s10, s10, 0x20000
  buffer_load_dwordx4 v[168:171], v4, s[20:23], s10 offen offset:0 sc1
  s_add_u32 s10, s10, 0x20000
  buffer_load_dwordx4 v[172:175], v4, s[20:23], s10 offen offset:0 sc1
  s_add_u32 s10, s10, 0x20000
  buffer_load_dwordx4 v[176:179], v4, s[20:23], s10 offen offset:0 sc1
  s_add_u32 s10, s10, 0x20000
  buffer_load_dwordx4 v[180:183], v4, s[20:23], s10 offen offset:0 sc1
  s_add_u32 s10, s10, 0x20000
  buffer_load_dwordx4 v[184:187], v4, s[20:23], s10 offen offset:0 sc1
  s_add_u32 s10, s10, 0x20000
  buffer_load_dwordx4 v[188:191], v4, s[20:23], s10 offen offset:0 sc1
  s_add_u32 s10, s10, 0x20000
  buffer_load_dwordx4 v[192:195], v4, s[20:23], s10 offen offset:0 sc1
  s_add_u32 s10, s10, 0x20000
  buffer_load_dwordx4 v[196:199], v4, s[20:23], s10 offen offset:0 sc1
  s_add_u32 s10, s10, 0x20000
  buffer_load_dwordx4 v[200:203], v4, s[20:23], s10 offen offset:0 sc1
  s_add_u32 s10, s10, 0x20000
  s_waitcnt vmcnt(11) lgkmcnt(14)
  v_mfma_f32_16x16x32_bf16 v[56:59], v[76:79], v[156:159], 0
  ds_read_b128 v[136:139], v4 offset:15360
  s_waitcnt lgkmcnt(14)
  v_mfma_f32_16x16x32_bf16 v[60:63], v[80:83], v[156:159], 0
  ds_read_b128 v[140:143], v4 offset:16384
  s_waitcnt lgkmcnt(14)
  v_mfma_f32_16x16x32_bf16 v[64:67], v[84:87], v[156:159], 0
  ds_read_b128 v[144:147], v4 offset:17408
  buffer_load_dwordx4 v[204:207], v4, s[20:23], s10 offen offset:0 sc1
  s_add_u32 s10, s10, 0x20000
  s_waitcnt lgkmcnt(14)
  v_mfma_f32_16x16x32_bf16 v[68:71], v[88:91], v[156:159], 0
  ds_read_b128 v[148:151], v4 offset:18432
  s_waitcnt lgkmcnt(14)
  v_mfma_f32_16x16x32_bf16 v[72:75], v[92:95], v[156:159], 0
  ds_read_b128 v[152:155], v4 offset:19456
  s_waitcnt vmcnt(11) lgkmcnt(14)
  v_mfma_f32_16x16x32_bf16 v[56:59], v[96:99], v[160:163], v[56:59]
  ds_read_b128 v[76:79], v4 offset:20480
  s_waitcnt lgkmcnt(14)
  v_mfma_f32_16x16x32_bf16 v[60:63], v[100:103], v[160:163], v[60:63]
  ds_read_b128 v[80:83], v4 offset:21504
  s_waitcnt lgkmcnt(14)
  v_mfma_f32_16x16x32_bf16 v[64:67], v[104:107], v[160:163], v[64:67]
  ds_read_b128 v[84:87], v4 offset:22528
  buffer_load_dwordx4 v[156:159], v4, s[20:23], s10 offen offset:0 sc1
  s_add_u32 s10, s10, 0x20000
  s_waitcnt lgkmcnt(14)
  v_mfma_f32_16x16x32_bf16 v[68:71], v[108:111], v[160:163], v[68:71]
  ds_read_b128 v[88:91], v4 offset:23552
  s_waitcnt lgkmcnt(14)
  v_mfma_f32_16x16x32_bf16 v[72:75], v[112:115], v[160:163], v[72:75]
  ds_read_b128 v[92:95], v4 offset:24576
  s_waitcnt vmcnt(11) lgkmcnt(14)
  v_mfma_f32_16x16x32_bf16 v[56:59], v[116:119], v[164:167], v[56:59]
  ds_read_b128 v[96:99], v4 offset:25600
  s_waitcnt lgkmcnt(14)
  v_mfma_f32_16x16x32_bf16 v[60:63], v[120:123], v[164:167], v[60:63]
  ds_read_b128 v[100:103], v4 offset:26624
  s_waitcnt lgkmcnt(14)
  v_mfma_f32_16x16x32_bf16 v[64:67], v[124:127], v[164:167], v[64:67]
  ds_read_b128 v[104:107], v4 offset:27648
  buffer_load_dwordx4 v[160:163], v4, s[20:23], s10 offen offset:0 sc1
  s_add_u32 s10, s10, 0x20000
  s_waitcnt lgkmcnt(14)
  v_mfma_f32_16x16x32_bf16 v[68:71], v[128:131], v[164:167], v[68:71]
  ds_read_b128 v[108:111], v4 offset:28672
  s_waitcnt lgkmcnt(14)
  v_mfma_f32_16x16x32_bf16 v[72:75], v[132:135], v[164:167], v[72:75]
  ds_read_b128 v[112:115], v4 offset:29696
  s_waitcnt vmcnt(11) lgkmcnt(14)
  v_mfma_f32_16x16x32_bf16 v[56:59], v[136:139], v[168:171], v[56:59]
  ds_read_b128 v[116:119], v4 offset:30720
  s_waitcnt lgkmcnt(14)
  v_mfma_f32_16x16x32_bf16 v[60:63], v[140:143], v[168:171], v[60:63]
  ds_read_b128 v[120:123], v4 offset:31744
  s_waitcnt lgkmcnt(14)
  v_mfma_f32_16x16x32_bf16 v[64:67], v[144:147], v[168:171], v[64:67]
  ds_read_b128 v[124:127], v4 offset:32768
  buffer_load_dwordx4 v[164:167], v4, s[20:23], s10 offen offset:0 sc1
  s_add_u32 s10, s10, 0x20000
  s_waitcnt lgkmcnt(14)
  v_mfma_f32_16x16x32_bf16 v[68:71], v[148:151], v[168:171], v[68:71]
  ds_read_b128 v[128:131], v4 offset:33792
  s_waitcnt lgkmcnt(14)
  v_mfma_f32_16x16x32_bf16 v[72:75], v[152:155], v[168:171], v[72:75]
  ds_read_b128 v[132:135], v4 offset:34816
  s_waitcnt vmcnt(11) lgkmcnt(14)
  v_mfma_f32_16x16x32_bf16 v[56:59], v[76:79], v[172:175], v[56:59]
  ds_read_b128 v[136:139], v4 offset:35840
  s_waitcnt lgkmcnt(14)
  v_mfma_f32_16x16x32_bf16 v[60:63], v[80:83], v[172:175], v[60:63]
  ds_read_b128 v[140:143], v4 offset:36864
  s_waitcnt lgkmcnt(14)
  v_mfma_f32_16x16x32_bf16 v[64:67], v[84:87], v[172:175], v[64:67]
  ds_read_b128 v[144:147], v4 offset:37888
  buffer_load_dwordx4 v[168:171], v4, s[20:23], s10 offen offset:0 sc1
  s_add_u32 s10, s10, 0x20000
  s_waitcnt lgkmcnt(14)
  v_mfma_f32_16x16x32_bf16 v[68:71], v[88:91], v[172:175], v[68:71]
  ds_read_b128 v[148:151], v4 offset:38912
  s_waitcnt lgkmcnt(14)
  v_mfma_f32_16x16x32_bf16 v[72:75], v[92:95], v[172:175], v[72:75]
  ds_read_b128 v[152:155], v4 offset:39936
  s_waitcnt vmcnt(11) lgkmcnt(14)
  v_mfma_f32_16x16x32_bf16 v[56:59], v[96:99], v[176:179], v[56:59]
  ds_read_b128 v[76:79], v4 offset:40960
  s_waitcnt lgkmcnt(14)
  v_mfma_f32_16x16x32_bf16 v[60:63], v[100:103], v[176:179], v[60:63]
  ds_read_b128 v[80:83], v4 offset:41984
  s_waitcnt lgkmcnt(14)
  v_mfma_f32_16x16x32_bf16 v[64:67], v[104:107], v[176:179], v[64:67]
  ds_read_b128 v[84:87], v4 offset:43008
  buffer_load_dwordx4 v[172:175], v4, s[20:23], s10 offen offset:0 sc1
  s_add_u32 s10, s10, 0x20000
  s_waitcnt lgkmcnt(14)
  v_mfma_f32_16x16x32_bf16 v[68:71], v[108:111], v[176:179], v[68:71]
  ds_read_b128 v[88:91], v4 offset:44032
  s_waitcnt lgkmcnt(14)
  v_mfma_f32_16x16x32_bf16 v[72:75], v[112:115], v[176:179], v[72:75]
  ds_read_b128 v[92:95], v4 offset:45056
  s_waitcnt vmcnt(11) lgkmcnt(14)
  v_mfma_f32_16x16x32_bf16 v[56:59], v[116:119], v[180:183], v[56:59]
  ds_read_b128 v[96:99], v4 offset:46080
  s_waitcnt lgkmcnt(14)
  v_mfma_f32_16x16x32_bf16 v[60:63], v[120:123], v[180:183], v[60:63]
  ds_read_b128 v[100:103], v4 offset:47104
  s_waitcnt lgkmcnt(14)
  v_mfma_f32_16x16x32_bf16 v[64:67], v[124:127], v[180:183], v[64:67]
  ds_read_b128 v[104:107], v4 offset:48128
  buffer_load_dwordx4 v[176:179], v4, s[20:23], s10 offen offset:0 sc1
  s_add_u32 s10, s10, 0x20000
  s_waitcnt lgkmcnt(14)
  v_mfma_f32_16x16x32_bf16 v[68:71], v[128:131], v[180:183], v[68:71]
  ds_read_b128 v[108:111], v4 offset:49152
  s_waitcnt lgkmcnt(14)
  v_mfma_f32_16x16x32_bf16 v[72:75], v[132:135], v[180:183], v[72:75]
  ds_read_b128 v[112:115], v4 offset:50176
  s_waitcnt vmcnt(11) lgkmcnt(14)
  v_mfma_f32_16x16x32_bf16 v[56:59], v[136:139], v[184:187], v[56:59]
  ds_read_b128 v[116:119], v4 offset:51200
  s_waitcnt lgkmcnt(14)
  v_mfma_f32_16x16x32_bf16 v[60:63], v[140:143], v[184:187], v[60:63]
  ds_read_b128 v[120:123], v4 offset:52224
  s_waitcnt lgkmcnt(14)
  v_mfma_f32_16x16x32_bf16 v[64:67], v[144:147], v[184:187], v[64:67]
  ds_read_b128 v[124:127], v4 offset:53248
  buffer_load_dwordx4 v[180:183], v4, s[20:23], s10 offen offset:0 sc1
  s_waitcnt lgkmcnt(14)
  v_mfma_f32_16x16x32_bf16 v[68:71], v[148:151], v[184:187], v[68:71]
  ds_read_b128 v[128:131], v4 offset:54272
  s_waitcnt lgkmcnt(14)
  v_mfma_f32_16x16x32_bf16 v[72:75], v[152:155], v[184:187], v[72:75]
  ds_read_b128 v[132:135], v4 offset:55296
  s_barrier
  s_waitcnt vmcnt(11) lgkmcnt(14)
  v_mfma_f32_16x16x32_bf16 v[56:59], v[76:79], v[188:191], v[56:59]
  ds_read_b128 v[136:139], v4 offset:56320
  s_waitcnt lgkmcnt(14)
  v_mfma_f32_16x16x32_bf16 v[60:63], v[80:83], v[188:191], v[60:63]
  ds_read_b128 v[140:143], v4 offset:57344
  s_waitcnt lgkmcnt(14)
  v_mfma_f32_16x16x32_bf16 v[64:67], v[84:87], v[188:191], v[64:67]
  ds_read_b128 v[144:147], v4 offset:58368
  buffer_load_dwordx4 v[40:43], v4, s[32:35], s42 offen sc1
  s_waitcnt lgkmcnt(14)
  v_mfma_f32_16x16x32_bf16 v[68:71], v[88:91], v[188:191], v[68:71]
  ds_read_b128 v[148:151], v4 offset:59392
  buffer_load_dwordx4 v[44:47], v4, s[32:35], s43 offen sc1
  s_waitcnt lgkmcnt(14)
  v_mfma_f32_16x16x32_bf16 v[72:75], v[92:95], v[188:191], v[72:75]
  ds_read_b128 v[152:155], v4 offset:60416
  s_waitcnt vmcnt(12) lgkmcnt(14)
  v_mfma_f32_16x16x32_bf16 v[56:59], v[96:99], v[192:195], v[56:59]
  ds_read_b128 v[76:79], v4 offset:61440
  s_waitcnt lgkmcnt(14)
  v_mfma_f32_16x16x32_bf16 v[60:63], v[100:103], v[192:195], v[60:63]
  ds_read_b128 v[80:83], v4 offset:62464
  s_waitcnt lgkmcnt(14)
  v_mfma_f32_16x16x32_bf16 v[64:67], v[104:107], v[192:195], v[64:67]
  ds_read_b128 v[84:87], v4 offset:63488
  buffer_load_dwordx2 v[48:49], v4, s[32:35], s46 offen sc1
  s_waitcnt lgkmcnt(14)
  v_mfma_f32_16x16x32_bf16 v[68:71], v[108:111], v[192:195], v[68:71]
  ds_read_b128 v[88:91], v4 offset:64512
  buffer_load_dwordx2 v[18:19], v12, s[36:39], 0 offen sc1
  s_waitcnt lgkmcnt(14)
  v_mfma_f32_16x16x32_bf16 v[72:75], v[112:115], v[192:195], v[72:75]
  ds_read_b128 v[92:95], v10 offset:0
  s_waitcnt vmcnt(13) lgkmcnt(14)
  v_mfma_f32_16x16x32_bf16 v[56:59], v[116:119], v[196:199], v[56:59]
  ds_read_b128 v[96:99], v10 offset:1024
  s_waitcnt lgkmcnt(14)
  v_mfma_f32_16x16x32_bf16 v[60:63], v[120:123], v[196:199], v[60:63]
  ds_read_b128 v[100:103], v10 offset:2048
  s_waitcnt lgkmcnt(14)
  v_mfma_f32_16x16x32_bf16 v[64:67], v[124:127], v[196:199], v[64:67]
  ds_read_b128 v[104:107], v10 offset:3072
  s_waitcnt lgkmcnt(14)
  v_mfma_f32_16x16x32_bf16 v[68:71], v[128:131], v[196:199], v[68:71]
  ds_read_b128 v[108:111], v10 offset:4096
  s_waitcnt lgkmcnt(14)
  v_mfma_f32_16x16x32_bf16 v[72:75], v[132:135], v[196:199], v[72:75]
  ds_read_b128 v[112:115], v10 offset:5120
  s_waitcnt vmcnt(12) lgkmcnt(14)
  v_mfma_f32_16x16x32_bf16 v[56:59], v[136:139], v[200:203], v[56:59]
  ds_read_b128 v[116:119], v10 offset:6144
  s_waitcnt lgkmcnt(14)
  v_mfma_f32_16x16x32_bf16 v[60:63], v[140:143], v[200:203], v[60:63]
  ds_read_b128 v[120:123], v10 offset:7168
  s_waitcnt lgkmcnt(14)
  v_mfma_f32_16x16x32_bf16 v[64:67], v[144:147], v[200:203], v[64:67]
  ds_read_b128 v[124:127], v10 offset:8192
  s_waitcnt lgkmcnt(14)
  v_mfma_f32_16x16x32_bf16 v[68:71], v[148:151], v[200:203], v[68:71]
  ds_read_b128 v[128:131], v10 offset:9216
  s_waitcnt lgkmcnt(14)
  v_mfma_f32_16x16x32_bf16 v[72:75], v[152:155], v[200:203], v[72:75]
  ds_read_b128 v[132:135], v10 offset:10240
  s_waitcnt vmcnt(11) lgkmcnt(14)
  v_mfma_f32_16x16x32_bf16 v[56:59], v[76:79], v[204:207], v[56:59]
  ds_read_b128 v[136:139], v10 offset:11264
  s_waitcnt lgkmcnt(14)
  v_mfma_f32_16x16x32_bf16 v[60:63], v[80:83], v[204:207], v[60:63]
  ds_read_b128 v[140:143], v10 offset:12288
  s_waitcnt lgkmcnt(14)
  v_mfma_f32_16x16x32_bf16 v[64:67], v[84:87], v[204:207], v[64:67]
  ds_read_b128 v[144:147], v10 offset:13312
  s_waitcnt lgkmcnt(14)
  v_mfma_f32_16x16x32_bf16 v[68:71], v[88:91], v[204:207], v[68:71]
  ds_read_b128 v[148:151], v10 offset:14336
  s_waitcnt lgkmcnt(14)
  v_mfma_f32_16x16x32_bf16 v[72:75], v[92:95], v[204:207], v[72:75]
  ds_read_b128 v[152:155], v10 offset:15360
  s_waitcnt vmcnt(10) lgkmcnt(14)
  v_mfma_f32_16x16x32_bf16 v[56:59], v[96:99], v[156:159], v[56:59]
  ds_read_b128 v[76:79], v10 offset:16384
  s_waitcnt lgkmcnt(14)
  v_mfma_f32_16x16x32_bf16 v[60:63], v[100:103], v[156:159], v[60:63]
  ds_read_b128 v[80:83], v10 offset:17408
  s_waitcnt lgkmcnt(14)
  v_mfma_f32_16x16x32_bf16 v[64:67], v[104:107], v[156:159], v[64:67]
  ds_read_b128 v[84:87], v10 offset:18432
  s_waitcnt lgkmcnt(14)
  v_mfma_f32_16x16x32_bf16 v[68:71], v[108:111], v[156:159], v[68:71]
  ds_read_b128 v[88:91], v10 offset:19456
  s_waitcnt lgkmcnt(14)
  v_mfma_f32_16x16x32_bf16 v[72:75], v[112:115], v[156:159], v[72:75]
  ds_read_b128 v[92:95], v10 offset:20480
  s_barrier
  s_waitcnt vmcnt(9) lgkmcnt(14)
  v_mfma_f32_16x16x32_bf16 v[56:59], v[116:119], v[160:163], v[56:59]
  ds_read_b128 v[96:99], v10 offset:21504
  s_waitcnt lgkmcnt(14)
  v_mfma_f32_16x16x32_bf16 v[60:63], v[120:123], v[160:163], v[60:63]
  ds_read_b128 v[100:103], v10 offset:22528
  s_waitcnt lgkmcnt(14)
  v_mfma_f32_16x16x32_bf16 v[64:67], v[124:127], v[160:163], v[64:67]
  ds_read_b128 v[104:107], v10 offset:23552
  s_waitcnt lgkmcnt(14)
  v_mfma_f32_16x16x32_bf16 v[68:71], v[128:131], v[160:163], v[68:71]
  ds_read_b128 v[108:111], v10 offset:24576
  s_waitcnt lgkmcnt(14)
  v_mfma_f32_16x16x32_bf16 v[72:75], v[132:135], v[160:163], v[72:75]
  ds_read_b128 v[112:115], v10 offset:25600
  s_waitcnt vmcnt(8) lgkmcnt(14)
  v_mfma_f32_16x16x32_bf16 v[56:59], v[136:139], v[164:167], v[56:59]
  ds_read_b128 v[116:119], v10 offset:26624
  s_waitcnt lgkmcnt(14)
  v_mfma_f32_16x16x32_bf16 v[60:63], v[140:143], v[164:167], v[60:63]
  ds_read_b128 v[120:123], v10 offset:27648
  s_waitcnt lgkmcnt(14)
  v_mfma_f32_16x16x32_bf16 v[64:67], v[144:147], v[164:167], v[64:67]
  ds_read_b128 v[124:127], v10 offset:28672
  s_waitcnt lgkmcnt(14)
  v_mfma_f32_16x16x32_bf16 v[68:71], v[148:151], v[164:167], v[68:71]
  ds_read_b128 v[128:131], v10 offset:29696
  s_waitcnt lgkmcnt(14)
  v_mfma_f32_16x16x32_bf16 v[72:75], v[152:155], v[164:167], v[72:75]
  ds_read_b128 v[132:135], v10 offset:30720
  s_waitcnt vmcnt(7) lgkmcnt(14)
  v_mfma_f32_16x16x32_bf16 v[56:59], v[76:79], v[168:171], v[56:59]
  ds_read_b128 v[136:139], v10 offset:31744
  s_waitcnt lgkmcnt(14)
  v_mfma_f32_16x16x32_bf16 v[60:63], v[80:83], v[168:171], v[60:63]
  ds_read_b128 v[140:143], v10 offset:32768
  s_waitcnt lgkmcnt(14)
  v_mfma_f32_16x16x32_bf16 v[64:67], v[84:87], v[168:171], v[64:67]
  ds_read_b128 v[144:147], v10 offset:33792
  s_waitcnt lgkmcnt(14)
  v_mfma_f32_16x16x32_bf16 v[68:71], v[88:91], v[168:171], v[68:71]
  ds_read_b128 v[148:151], v10 offset:34816
  s_waitcnt lgkmcnt(14)
  v_mfma_f32_16x16x32_bf16 v[72:75], v[92:95], v[168:171], v[72:75]
  ds_read_b128 v[152:155], v10 offset:35840
  s_waitcnt vmcnt(6) lgkmcnt(14)
  v_mfma_f32_16x16x32_bf16 v[56:59], v[96:99], v[172:175], v[56:59]
  s_waitcnt lgkmcnt(13)
  v_mfma_f32_16x16x32_bf16 v[60:63], v[100:103], v[172:175], v[60:63]
  s_waitcnt lgkmcnt(12)
  v_mfma_f32_16x16x32_bf16 v[64:67], v[104:107], v[172:175], v[64:67]
  s_waitcnt lgkmcnt(11)
  v_mfma_f32_16x16x32_bf16 v[68:71], v[108:111], v[172:175], v[68:71]
  s_waitcnt lgkmcnt(10)
  v_mfma_f32_16x16x32_bf16 v[72:75], v[112:115], v[172:175], v[72:75]
  s_waitcnt vmcnt(5) lgkmcnt(9)
  v_mfma_f32_16x16x32_bf16 v[56:59], v[116:119], v[176:179], v[56:59]
  s_waitcnt lgkmcnt(8)
  v_mfma_f32_16x16x32_bf16 v[60:63], v[120:123], v[176:179], v[60:63]
  s_waitcnt lgkmcnt(7)
  v_mfma_f32_16x16x32_bf16 v[64:67], v[124:127], v[176:179], v[64:67]
  s_waitcnt lgkmcnt(6)
  v_mfma_f32_16x16x32_bf16 v[68:71], v[128:131], v[176:179], v[68:71]
  s_waitcnt lgkmcnt(5)
  v_mfma_f32_16x16x32_bf16 v[72:75], v[132:135], v[176:179], v[72:75]
  s_waitcnt vmcnt(4) lgkmcnt(4)
  v_mfma_f32_16x16x32_bf16 v[56:59], v[136:139], v[180:183], v[56:59]
  s_waitcnt lgkmcnt(3)
  v_mfma_f32_16x16x32_bf16 v[60:63], v[140:143], v[180:183], v[60:63]
  s_waitcnt lgkmcnt(2)
  v_mfma_f32_16x16x32_bf16 v[64:67], v[144:147], v[180:183], v[64:67]
  s_waitcnt lgkmcnt(1)
  v_mfma_f32_16x16x32_bf16 v[68:71], v[148:151], v[180:183], v[68:71]
  s_waitcnt lgkmcnt(0)
  v_mfma_f32_16x16x32_bf16 v[72:75], v[152:155], v[180:183], v[72:75]
  s_barrier
  v_pk_mul_f32 v[96:97], v[56:57], v[56:57]
  v_pk_mul_f32 v[98:99], v[58:59], v[58:59]
  v_pk_mul_f32 v[100:101], v[60:61], v[60:61]
  v_pk_mul_f32 v[102:103], v[62:63], v[62:63]
  v_pk_fma_f32 v[96:97], v[96:97], v[50:51], v[52:53] op_sel_hi:[1,0,0]
  v_pk_fma_f32 v[98:99], v[98:99], v[50:51], v[52:53] op_sel_hi:[1,0,0]
  v_pk_fma_f32 v[100:101], v[100:101], v[50:51], v[52:53] op_sel_hi:[1,0,0]
  v_pk_fma_f32 v[102:103], v[102:103], v[50:51], v[52:53] op_sel_hi:[1,0,0]
  v_pk_mul_f32 v[96:97], v[96:97], v[56:57]
  v_pk_mul_f32 v[98:99], v[98:99], v[58:59]
  v_pk_mul_f32 v[100:101], v[100:101], v[60:61]
  v_pk_mul_f32 v[102:103], v[102:103], v[62:63]
  v_exp_f32 v96, v96
  v_exp_f32 v97, v97
  v_exp_f32 v98, v98
  v_exp_f32 v99, v99
  v_exp_f32 v100, v100
  v_exp_f32 v101, v101
  v_exp_f32 v102, v102
  v_exp_f32 v103, v103
  v_pk_fma_f32 v[96:97], v[96:97], v[54:55], v[54:55] op_sel_hi:[1,0,0]
  v_pk_fma_f32 v[98:99], v[98:99], v[54:55], v[54:55] op_sel_hi:[1,0,0]
  v_pk_fma_f32 v[100:101], v[100:101], v[54:55], v[54:55] op_sel_hi:[1,0,0]
  v_pk_fma_f32 v[102:103], v[102:103], v[54:55], v[54:55] op_sel_hi:[1,0,0]
  v_rcp_f32 v96, v96
  v_rcp_f32 v97, v97
  v_rcp_f32 v98, v98
  v_rcp_f32 v99, v99
  v_rcp_f32 v100, v100
  v_rcp_f32 v101, v101
  v_rcp_f32 v102, v102
  v_rcp_f32 v103, v103
  v_pk_mul_f32 v[56:57], v[56:57], v[96:97]
  v_pk_mul_f32 v[58:59], v[58:59], v[98:99]
  v_pk_mul_f32 v[60:61], v[60:61], v[100:101]
  v_pk_mul_f32 v[62:63], v[62:63], v[102:103]
  v_cvt_pk_bf16_f32 v156, v56, v57
  v_cvt_pk_bf16_f32 v157, v58, v59
  v_cvt_pk_bf16_f32 v158, v60, v61
  v_cvt_pk_bf16_f32 v159, v62, v63
  buffer_store_dwordx4 v[156:159], v4, s[24:27], s42 offen offset:0 sc1
  v_pk_mul_f32 v[104:105], v[64:65], v[64:65]
  v_pk_mul_f32 v[106:107], v[66:67], v[66:67]
  v_pk_mul_f32 v[108:109], v[68:69], v[68:69]
  v_pk_mul_f32 v[110:111], v[70:71], v[70:71]
  v_pk_fma_f32 v[104:105], v[104:105], v[50:51], v[52:53] op_sel_hi:[1,0,0]
  v_pk_fma_f32 v[106:107], v[106:107], v[50:51], v[52:53] op_sel_hi:[1,0,0]
  v_pk_fma_f32 v[108:109], v[108:109], v[50:51], v[52:53] op_sel_hi:[1,0,0]
  v_pk_fma_f32 v[110:111], v[110:111], v[50:51], v[52:53] op_sel_hi:[1,0,0]
  v_pk_mul_f32 v[104:105], v[104:105], v[64:65]
  v_pk_mul_f32 v[106:107], v[106:107], v[66:67]
  v_pk_mul_f32 v[108:109], v[108:109], v[68:69]
  v_pk_mul_f32 v[110:111], v[110:111], v[70:71]
  v_exp_f32 v104, v104
  v_exp_f32 v105, v105
  v_exp_f32 v106, v106
  v_exp_f32 v107, v107
  v_exp_f32 v108, v108
  v_exp_f32 v109, v109
  v_exp_f32 v110, v110
  v_exp_f32 v111, v111
  v_pk_fma_f32 v[104:105], v[104:105], v[54:55], v[54:55] op_sel_hi:[1,0,0]
  v_pk_fma_f32 v[106:107], v[106:107], v[54:55], v[54:55] op_sel_hi:[1,0,0]
  v_pk_fma_f32 v[108:109], v[108:109], v[54:55], v[54:55] op_sel_hi:[1,0,0]
  v_pk_fma_f32 v[110:111], v[110:111], v[54:55], v[54:55] op_sel_hi:[1,0,0]
  v_rcp_f32 v104, v104
  v_rcp_f32 v105, v105
  v_rcp_f32 v106, v106
  v_rcp_f32 v107, v107
  v_rcp_f32 v108, v108
  v_rcp_f32 v109, v109
  v_rcp_f32 v110, v110
  v_rcp_f32 v111, v111
  v_pk_mul_f32 v[64:65], v[64:65], v[104:105]
  v_pk_mul_f32 v[66:67], v[66:67], v[106:107]
  v_pk_mul_f32 v[68:69], v[68:69], v[108:109]
  v_pk_mul_f32 v[70:71], v[70:71], v[110:111]
  v_cvt_pk_bf16_f32 v160, v64, v65
  v_cvt_pk_bf16_f32 v161, v66, v67
  v_cvt_pk_bf16_f32 v162, v68, v69
  v_cvt_pk_bf16_f32 v163, v70, v71
  buffer_store_dwordx4 v[160:163], v4, s[24:27], s43 offen offset:0 sc1
  v_pk_mul_f32 v[96:97], v[72:73], v[72:73]
  v_pk_mul_f32 v[98:99], v[74:75], v[74:75]
  v_pk_fma_f32 v[96:97], v[96:97], v[50:51], v[52:53] op_sel_hi:[1,0,0]
  v_pk_fma_f32 v[98:99], v[98:99], v[50:51], v[52:53] op_sel_hi:[1,0,0]
  v_pk_mul_f32 v[96:97], v[96:97], v[72:73]
  v_pk_mul_f32 v[98:99], v[98:99], v[74:75]
  v_exp_f32 v96, v96
  v_exp_f32 v97, v97
  v_exp_f32 v98, v98
  v_exp_f32 v99, v99
  v_pk_fma_f32 v[96:97], v[96:97], v[54:55], v[54:55] op_sel_hi:[1,0,0]
  v_pk_fma_f32 v[98:99], v[98:99], v[54:55], v[54:55] op_sel_hi:[1,0,0]
  v_rcp_f32 v96, v96
  v_rcp_f32 v97, v97
  v_rcp_f32 v98, v98
  v_rcp_f32 v99, v99
  v_pk_mul_f32 v[72:73], v[72:73], v[96:97]
  v_pk_mul_f32 v[74:75], v[74:75], v[98:99]
  v_cvt_pk_bf16_f32 v164, v72, v73
  v_cvt_pk_bf16_f32 v165, v74, v75
  v_cvt_pk_bf16_f32 v166, v72, v73
  v_cvt_pk_bf16_f32 v167, v74, v75
  s_nop 0
  v_permlane16_swap_b32 v164, v166
  v_permlane16_swap_b32 v165, v167
  buffer_store_dwordx4 v[164:167], v13, s[24:27], s44 offen offset:0 sc1
  s_sub_u32 s8, s12, 2
  s_add_u32 s9, s12, 17
  s_cmp_eq_u32 s3, 0
  s_cselect_b32 s8, s8, s9
  s_max_i32 s8, s8, 0
  s_min_i32 s8, s8, 2047
  s_lshr_b32 s8, s8, 6
  s_lshr_b32 s9, s12, 6
  s_sub_u32 s8, s8, s9
  s_sub_u32 s8, s8, 1
  s_lshl_b32 s8, s8, 11
  s_lshl_b32 s9, s9, 11
  s_add_u32 s9, s9, 65536
  v_lshrrev_b32 v9, 3, v1
  v_mul_lo_u32 v9, v9, s8
  v_lshl_add_u32 v9, v1, 8, v9
  v_add_u32 v9, s9, v9
  s_lshr_b32 s8, s12, 6
  s_lshl_b32 s8, s8, 3
  s_add_u32 s8, s8, s13
  s_lshl_b32 s8, s8, 8
  s_add_u32 s52, s8, 131072
  v_bfrev_b32 v14, 1
  s_mov_b32 s10, 0
  s_mul_i32 s9, s10, 13
  s_lshr_b32 s9, s9, 6
  s_lshl_b32 s10, s10, 17
  s_add_u32 s8, s9, 0
  s_bfe_u32 s28, s8, 0x10001
  s_and_b32 s8, s8, 1
  s_lshl_b32 s8, s8, 1
  s_sub_u32 s8, s8, 1
  s_lshl_b32 s8, s8, s28
  v_add_u32 v50, s8, v5
  v_cmp_gt_u32 vcc, 2048, v50
  v_and_b32 v15, 15, v50
  v_lshrrev_b32 v50, 4, v50
  v_lshlrev_b32 v50, 10, v50
  v_lshl_add_u32 v50, v15, 4, v50
  v_lshl_add_u32 v50, v3, 8, v50
  v_cndmask_b32 v50, v14, v50, vcc
  s_add_u32 s8, s9, 1
  s_bfe_u32 s28, s8, 0x10001
  s_and_b32 s8, s8, 1
  s_lshl_b32 s8, s8, 1
  s_sub_u32 s8, s8, 1
  s_lshl_b32 s8, s8, s28
  v_add_u32 v51, s8, v5
  v_cmp_gt_u32 vcc, 2048, v51
  v_and_b32 v15, 15, v51
  v_lshrrev_b32 v51, 4, v51
  v_lshlrev_b32 v51, 10, v51
  v_lshl_add_u32 v51, v15, 4, v51
  v_lshl_add_u32 v51, v3, 8, v51
  v_cndmask_b32 v51, v14, v51, vcc
  s_add_u32 s8, s9, 2
  s_bfe_u32 s28, s8, 0x10001
  s_and_b32 s8, s8, 1
  s_lshl_b32 s8, s8, 1
  s_sub_u32 s8, s8, 1
  s_lshl_b32 s8, s8, s28
  v_add_u32 v52, s8, v5
  v_cmp_gt_u32 vcc, 2048, v52
  v_and_b32 v15, 15, v52
  v_lshrrev_b32 v52, 4, v52
  v_lshlrev_b32 v52, 10, v52
  v_lshl_add_u32 v52, v15, 4, v52
  v_lshl_add_u32 v52, v3, 8, v52
  v_cndmask_b32 v52, v14, v52, vcc
  s_add_u32 s8, s9, 3
  s_bfe_u32 s28, s8, 0x10001
  s_and_b32 s8, s8, 1
  s_lshl_b32 s8, s8, 1
  s_sub_u32 s8, s8, 1
  s_lshl_b32 s8, s8, s28
  v_add_u32 v53, s8, v5
  v_cmp_gt_u32 vcc, 2048, v53
  v_and_b32 v15, 15, v53
  v_lshrrev_b32 v53, 4, v53
  v_lshlrev_b32 v53, 10, v53
  v_lshl_add_u32 v53, v15, 4, v53
  v_lshl_add_u32 v53, v3, 8, v53
  v_cndmask_b32 v53, v14, v53, vcc
  s_waitcnt vmcnt(3)
  v_mov_b32 v16, v19
  v_lshlrev_b32 v20, 16, v40
  v_and_b32 v21, 0xffff0000, v40
  v_lshlrev_b32 v22, 16, v41
  v_and_b32 v23, 0xffff0000, v41
  v_pk_add_f32 v[20:21], v[20:21], v[18:19] op_sel_hi:[1,0] neg_lo:[0,1] neg_hi:[0,1]
  v_pk_add_f32 v[22:23], v[22:23], v[18:19] op_sel_hi:[1,0] neg_lo:[0,1] neg_hi:[0,1]
  v_cvt_pk_bf16_f32 v14, v20, v21
  v_cvt_pk_bf16_f32 v15, v22, v23
  v_lshlrev_b32 v20, 16, v14
  v_and_b32 v21, 0xffff0000, v14
  v_lshlrev_b32 v22, 16, v15
  v_and_b32 v23, 0xffff0000, v15
  v_pk_mul_f32 v[20:21], v[20:21], v[16:17] op_sel_hi:[1,0]
  v_pk_mul_f32 v[22:23], v[22:23], v[16:17] op_sel_hi:[1,0]
  v_cvt_pk_bf16_f32 v14, v20, v21
  v_cvt_pk_bf16_f32 v15, v22, v23
  v_lshlrev_b32 v20, 16, v14
  v_and_b32 v21, 0xffff0000, v14
  v_lshlrev_b32 v22, 16, v15
  v_and_b32 v23, 0xffff0000, v15
  v_lshlrev_b32 v24, 16, v42
  v_and_b32 v25, 0xffff0000, v42
  v_lshlrev_b32 v26, 16, v43
  v_and_b32 v27, 0xffff0000, v43
  v_pk_add_f32 v[24:25], v[24:25], v[18:19] op_sel_hi:[1,0] neg_lo:[0,1] neg_hi:[0,1]
  v_pk_add_f32 v[26:27], v[26:27], v[18:19] op_sel_hi:[1,0] neg_lo:[0,1] neg_hi:[0,1]
  v_cvt_pk_bf16_f32 v14, v24, v25
  v_cvt_pk_bf16_f32 v15, v26, v27
  v_lshlrev_b32 v24, 16, v14
  v_and_b32 v25, 0xffff0000, v14
  v_lshlrev_b32 v26, 16, v15
  v_and_b32 v27, 0xffff0000, v15
  v_pk_mul_f32 v[24:25], v[24:25], v[16:17] op_sel_hi:[1,0]
  v_pk_mul_f32 v[26:27], v[26:27], v[16:17] op_sel_hi:[1,0]
  v_cvt_pk_bf16_f32 v14, v24, v25
  v_cvt_pk_bf16_f32 v15, v26, v27
  v_lshlrev_b32 v24, 16, v14
  v_and_b32 v25, 0xffff0000, v14
  v_lshlrev_b32 v26, 16, v15
  v_and_b32 v27, 0xffff0000, v15
  v_lshlrev_b32 v28, 16, v44
  v_and_b32 v29, 0xffff0000, v44
  v_lshlrev_b32 v30, 16, v45
  v_and_b32 v31, 0xffff0000, v45
  v_pk_add_f32 v[28:29], v[28:29], v[18:19] op_sel_hi:[1,0] neg_lo:[0,1] neg_hi:[0,1]
  v_pk_add_f32 v[30:31], v[30:31], v[18:19] op_sel_hi:[1,0] neg_lo:[0,1] neg_hi:[0,1]
  v_cvt_pk_bf16_f32 v14, v28, v29
  v_cvt_pk_bf16_f32 v15, v30, v31
  v_lshlrev_b32 v28, 16, v14
  v_and_b32 v29, 0xffff0000, v14
  v_lshlrev_b32 v30, 16, v15
  v_and_b32 v31, 0xffff0000, v15
  v_pk_mul_f32 v[28:29], v[28:29], v[16:17] op_sel_hi:[1,0]
  v_pk_mul_f32 v[30:31], v[30:31], v[16:17] op_sel_hi:[1,0]
  v_cvt_pk_bf16_f32 v14, v28, v29
  v_cvt_pk_bf16_f32 v15, v30, v31
  v_lshlrev_b32 v28, 16, v14
  v_and_b32 v29, 0xffff0000, v14
  v_lshlrev_b32 v30, 16, v15
  v_and_b32 v31, 0xffff0000, v15
  v_lshlrev_b32 v32, 16, v46
  v_and_b32 v33, 0xffff0000, v46
  v_lshlrev_b32 v34, 16, v47
  v_and_b32 v35, 0xffff0000, v47
  v_pk_add_f32 v[32:33], v[32:33], v[18:19] op_sel_hi:[1,0] neg_lo:[0,1] neg_hi:[0,1]
  v_pk_add_f32 v[34:35], v[34:35], v[18:19] op_sel_hi:[1,0] neg_lo:[0,1] neg_hi:[0,1]
  v_cvt_pk_bf16_f32 v14, v32, v33
  v_cvt_pk_bf16_f32 v15, v34, v35
  v_lshlrev_b32 v32, 16, v14
  v_and_b32 v33, 0xffff0000, v14
  v_lshlrev_b32 v34, 16, v15
  v_and_b32 v35, 0xffff0000, v15
  v_pk_mul_f32 v[32:33], v[32:33], v[16:17] op_sel_hi:[1,0]
  v_pk_mul_f32 v[34:35], v[34:35], v[16:17] op_sel_hi:[1,0]
  v_cvt_pk_bf16_f32 v14, v32, v33
  v_cvt_pk_bf16_f32 v15, v34, v35
  v_lshlrev_b32 v32, 16, v14
  v_and_b32 v33, 0xffff0000, v14
  v_lshlrev_b32 v34, 16, v15
  v_and_b32 v35, 0xffff0000, v15
  v_lshlrev_b32 v36, 16, v48
  v_and_b32 v37, 0xffff0000, v48
  v_lshlrev_b32 v38, 16, v49
  v_and_b32 v39, 0xffff0000, v49
  v_pk_add_f32 v[36:37], v[36:37], v[18:19] op_sel_hi:[1,0] neg_lo:[0,1] neg_hi:[0,1]
  v_pk_add_f32 v[38:39], v[38:39], v[18:19] op_sel_hi:[1,0] neg_lo:[0,1] neg_hi:[0,1]
  v_cvt_pk_bf16_f32 v14, v36, v37
  v_cvt_pk_bf16_f32 v15, v38, v39
  v_lshlrev_b32 v36, 16, v14
  v_and_b32 v37, 0xffff0000, v14
  v_lshlrev_b32 v38, 16, v15
  v_and_b32 v39, 0xffff0000, v15
  v_pk_mul_f32 v[36:37], v[36:37], v[16:17] op_sel_hi:[1,0]
  v_pk_mul_f32 v[38:39], v[38:39], v[16:17] op_sel_hi:[1,0]
  v_cvt_pk_bf16_f32 v14, v36, v37
  v_cvt_pk_bf16_f32 v15, v38, v39
  v_lshlrev_b32 v36, 16, v14
  v_and_b32 v37, 0xffff0000, v14
  v_lshlrev_b32 v38, 16, v15
  v_and_b32 v39, 0xffff0000, v15
  s_add_u32 s20, s14, 0x1800000
  s_addc_u32 s21, s15, 0
  s_mov_b32 s22, 0x280000
  s_mov_b32 s23, 0x00020000
  s_waitcnt vmcnt(0)
  s_mov_b64 exec, 1
  ds_add_rtn_u32 v8, v6, v7
  s_waitcnt lgkmcnt(0)
  v_readfirstlane_b32 s41, v8
  s_nop 0
  s_cmp_lg_u32 s41, 7
  s_cbranch_scc1 kf_kernel_ns104
  buffer_store_dword v7, off, s[48:51], s53 sc1
kf_kernel_ns104:
  s_add_u32 s24, s14, 0x1c00000
  s_addc_u32 s25, s15, 0
  s_mov_b32 s26, 0x280000
  s_mov_b32 s27, 0x00020000
  s_mov_b64 exec, -1
  ds_read_b128 v[76:79], v10 offset:36864
  ds_read_b128 v[80:83], v10 offset:37888
  ds_read_b128 v[84:87], v10 offset:38912
  ds_read_b128 v[88:91], v10 offset:39936
  ds_read_b128 v[92:95], v10 offset:40960
  ds_read_b128 v[96:99], v10 offset:41984
  ds_read_b128 v[100:103], v10 offset:43008
  ds_read_b128 v[104:107], v10 offset:44032
  ds_read_b128 v[108:111], v10 offset:45056
  ds_read_b128 v[112:115], v10 offset:46080
  ds_read_b128 v[116:119], v10 offset:47104
  ds_read_b128 v[120:123], v10 offset:48128
  ds_read_b128 v[124:127], v10 offset:49152
  ds_read_b128 v[128:131], v10 offset:50176
  ds_read_b128 v[132:135], v10 offset:51200
  s_mov_b64 exec, 0xffff
  s_movk_i32 s40, 30000
kf_kernel_pl105:
  buffer_load_dword v8, v9, s[48:51], 0 offen sc1
  s_waitcnt vmcnt(0)
  v_cmp_eq_u32 vcc, 0, v8
  s_cbranch_vccz kf_kernel_pd106
  s_sub_u32 s40, s40, 1
  s_cbranch_scc0 kf_kernel_pl105
kf_kernel_pd106:
  s_mov_b64 exec, -1
  buffer_load_dwordx4 v[156:159], v50, s[20:23], s10 offen offset:0 sc1
  s_add_u32 s10, s10, 0x20000
  buffer_load_dwordx4 v[160:163], v50, s[20:23], s10 offen offset:0 sc1
  s_add_u32 s10, s10, 0x20000
  buffer_load_dwordx4 v[164:167], v50, s[20:23], s10 offen offset:0 sc1
  s_add_u32 s10, s10, 0x20000
  buffer_load_dwordx4 v[168:171], v50, s[20:23], s10 offen offset:0 sc1
  s_add_u32 s10, s10, 0x20000
  buffer_load_dwordx4 v[172:175], v50, s[20:23], s10 offen offset:0 sc1
  s_add_u32 s10, s10, 0x20000
  buffer_load_dwordx4 v[176:179], v51, s[20:23], s10 offen offset:0 sc1
  s_add_u32 s10, s10, 0x20000
  buffer_load_dwordx4 v[180:183], v51, s[20:23], s10 offen offset:0 sc1
  s_add_u32 s10, s10, 0x20000
  buffer_load_dwordx4 v[184:187], v51, s[20:23], s10 offen offset:0 sc1
  s_add_u32 s10, s10, 0x20000
  buffer_load_dwordx4 v[188:191], v51, s[20:23], s10 offen offset:0 sc1
  s_add_u32 s10, s10, 0x20000
  buffer_load_dwordx4 v[192:195], v51, s[20:23], s10 offen offset:0 sc1
  s_add_u32 s10, s10, 0x20000
  buffer_load_dwordx4 v[196:199], v52, s[20:23], s10 offen offset:0 sc1
  s_add_u32 s10, s10, 0x20000
  buffer_load_dwordx4 v[200:203], v52, s[20:23], s10 offen offset:0 sc1
  s_add_u32 s10, s10, 0x20000
  s_waitcnt vmcnt(11) lgkmcnt(14)
  v_mfma_f32_16x16x32_bf16 v[56:59], v[76:79], v[156:159], v[20:23]
  ds_read_b128 v[136:139], v10 offset:52224
  s_waitcnt lgkmcnt(14)
  v_mfma_f32_16x16x32_bf16 v[60:63], v[80:83], v[156:159], v[24:27]
  ds_read_b128 v[140:143], v10 offset:53248
  s_waitcnt lgkmcnt(14)
  v_mfma_f32_16x16x32_bf16 v[64:67], v[84:87], v[156:159], v[28:31]
  ds_read_b128 v[144:147], v10 offset:54272
  buffer_load_dwordx4 v[204:207], v52, s[20:23], s10 offen offset:0 sc1
  s_add_u32 s10, s10, 0x20000
  s_waitcnt lgkmcnt(14)
  v_mfma_f32_16x16x32_bf16 v[68:71], v[88:91], v[156:159], v[32:35]
  ds_read_b128 v[148:151], v10 offset:55296
  s_waitcnt lgkmcnt(14)
  v_mfma_f32_16x16x32_bf16 v[72:75], v[92:95], v[156:159], v[36:39]
  ds_read_b128 v[152:155], v10 offset:56320
  s_waitcnt vmcnt(11) lgkmcnt(14)
  v_mfma_f32_16x16x32_bf16 v[56:59], v[96:99], v[160:163], v[56:59]
  ds_read_b128 v[76:79], v10 offset:57344
  s_waitcnt lgkmcnt(14)
  v_mfma_f32_16x16x32_bf16 v[60:63], v[100:103], v[160:163], v[60:63]
  ds_read_b128 v[80:83], v10 offset:58368
  s_waitcnt lgkmcnt(14)
  v_mfma_f32_16x16x32_bf16 v[64:67], v[104:107], v[160:163], v[64:67]
  ds_read_b128 v[84:87], v10 offset:59392
  buffer_load_dwordx4 v[156:159], v52, s[20:23], s10 offen offset:0 sc1
  s_add_u32 s10, s10, 0x20000
  s_waitcnt lgkmcnt(14)
  v_mfma_f32_16x16x32_bf16 v[68:71], v[108:111], v[160:163], v[68:71]
  ds_read_b128 v[88:91], v10 offset:60416
  s_waitcnt lgkmcnt(14)
  v_mfma_f32_16x16x32_bf16 v[72:75], v[112:115], v[160:163], v[72:75]
  ds_read_b128 v[92:95], v10 offset:61440
  s_waitcnt vmcnt(11) lgkmcnt(14)
  v_mfma_f32_16x16x32_bf16 v[56:59], v[116:119], v[164:167], v[56:59]
  ds_read_b128 v[96:99], v10 offset:62464
  s_waitcnt lgkmcnt(14)
  v_mfma_f32_16x16x32_bf16 v[60:63], v[120:123], v[164:167], v[60:63]
  ds_read_b128 v[100:103], v10 offset:63488
  s_waitcnt lgkmcnt(14)
  v_mfma_f32_16x16x32_bf16 v[64:67], v[124:127], v[164:167], v[64:67]
  ds_read_b128 v[104:107], v10 offset:64512
  buffer_load_dwordx4 v[160:163], v52, s[20:23], s10 offen offset:0 sc1
  s_add_u32 s10, s10, 0x20000
  s_waitcnt lgkmcnt(14)
  v_mfma_f32_16x16x32_bf16 v[68:71], v[128:131], v[164:167], v[68:71]
  ds_read_b128 v[108:111], v11 offset:0
  s_waitcnt lgkmcnt(14)
  v_mfma_f32_16x16x32_bf16 v[72:75], v[132:135], v[164:167], v[72:75]
  ds_read_b128 v[112:115], v11 offset:1024
  s_barrier
  s_waitcnt vmcnt(11) lgkmcnt(14)
  v_mfma_f32_16x16x32_bf16 v[56:59], v[136:139], v[168:171], v[56:59]
  ds_read_b128 v[116:119], v11 offset:2048
  s_waitcnt lgkmcnt(14)
  v_mfma_f32_16x16x32_bf16 v[60:63], v[140:143], v[168:171], v[60:63]
  ds_read_b128 v[120:123], v11 offset:3072
  s_waitcnt lgkmcnt(14)
  v_mfma_f32_16x16x32_bf16 v[64:67], v[144:147], v[168:171], v[64:67]
  ds_read_b128 v[124:127], v11 offset:4096
  buffer_load_dwordx4 v[164:167], v53, s[20:23], s10 offen offset:0 sc1
  s_add_u32 s10, s10, 0x20000
  s_waitcnt lgkmcnt(14)
  v_mfma_f32_16x16x32_bf16 v[68:71], v[148:151], v[168:171], v[68:71]
  ds_read_b128 v[128:131], v11 offset:5120
  s_waitcnt lgkmcnt(14)
  v_mfma_f32_16x16x32_bf16 v[72:75], v[152:155], v[168:171], v[72:75]
  ds_read_b128 v[132:135], v11 offset:6144
  s_waitcnt vmcnt(11) lgkmcnt(14)
  v_mfma_f32_16x16x32_bf16 v[56:59], v[76:79], v[172:175], v[56:59]
  ds_read_b128 v[136:139], v11 offset:7168
  s_waitcnt lgkmcnt(14)
  v_mfma_f32_16x16x32_bf16 v[60:63], v[80:83], v[172:175], v[60:63]
  ds_read_b128 v[140:143], v11 offset:8192
  s_waitcnt lgkmcnt(14)
  v_mfma_f32_16x16x32_bf16 v[64:67], v[84:87], v[172:175], v[64:67]
  ds_read_b128 v[144:147], v11 offset:9216
  buffer_load_dwordx4 v[168:171], v53, s[20:23], s10 offen offset:0 sc1
  s_add_u32 s10, s10, 0x20000
  s_waitcnt lgkmcnt(14)
  v_mfma_f32_16x16x32_bf16 v[68:71], v[88:91], v[172:175], v[68:71]
  ds_read_b128 v[148:151], v11 offset:10240
  s_waitcnt lgkmcnt(14)
  v_mfma_f32_16x16x32_bf16 v[72:75], v[92:95], v[172:175], v[72:75]
  ds_read_b128 v[152:155], v11 offset:11264
  s_waitcnt vmcnt(11) lgkmcnt(14)
  v_mfma_f32_16x16x32_bf16 v[56:59], v[96:99], v[176:179], v[56:59]
  ds_read_b128 v[76:79], v11 offset:12288
  s_waitcnt lgkmcnt(14)
  v_mfma_f32_16x16x32_bf16 v[60:63], v[100:103], v[176:179], v[60:63]
  ds_read_b128 v[80:83], v11 offset:13312
  s_waitcnt lgkmcnt(14)
  v_mfma_f32_16x16x32_bf16 v[64:67], v[104:107], v[176:179], v[64:67]
  ds_read_b128 v[84:87], v11 offset:14336
  buffer_load_dwordx4 v[172:175], v53, s[20:23], s10 offen offset:0 sc1
  s_add_u32 s10, s10, 0x20000
  s_waitcnt lgkmcnt(14)
  v_mfma_f32_16x16x32_bf16 v[68:71], v[108:111], v[176:179], v[68:71]
  ds_read_b128 v[88:91], v11 offset:15360
  s_waitcnt lgkmcnt(14)
  v_mfma_f32_16x16x32_bf16 v[72:75], v[112:115], v[176:179], v[72:75]
  ds_read_b128 v[92:95], v11 offset:16384
  s_waitcnt vmcnt(11) lgkmcnt(14)
  v_mfma_f32_16x16x32_bf16 v[56:59], v[116:119], v[180:183], v[56:59]
  ds_read_b128 v[96:99], v11 offset:17408
  s_waitcnt lgkmcnt(14)
  v_mfma_f32_16x16x32_bf16 v[60:63], v[120:123], v[180:183], v[60:63]
  ds_read_b128 v[100:103], v11 offset:18432
  s_waitcnt lgkmcnt(14)
  v_mfma_f32_16x16x32_bf16 v[64:67], v[124:127], v[180:183], v[64:67]
  ds_read_b128 v[104:107], v11 offset:19456
  buffer_load_dwordx4 v[176:179], v53, s[20:23], s10 offen offset:0 sc1
  s_add_u32 s10, s10, 0x20000
  s_waitcnt lgkmcnt(14)
  v_mfma_f32_16x16x32_bf16 v[68:71], v[128:131], v[180:183], v[68:71]
  ds_read_b128 v[108:111], v11 offset:20480
  s_waitcnt lgkmcnt(14)
  v_mfma_f32_16x16x32_bf16 v[72:75], v[132:135], v[180:183], v[72:75]
  ds_read_b128 v[112:115], v11 offset:21504
  s_waitcnt vmcnt(11) lgkmcnt(14)
  v_mfma_f32_16x16x32_bf16 v[56:59], v[136:139], v[184:187], v[56:59]
  ds_read_b128 v[116:119], v11 offset:22528
  s_waitcnt lgkmcnt(14)
  v_mfma_f32_16x16x32_bf16 v[60:63], v[140:143], v[184:187], v[60:63]
  ds_read_b128 v[120:123], v11 offset:23552
  s_waitcnt lgkmcnt(14)
  v_mfma_f32_16x16x32_bf16 v[64:67], v[144:147], v[184:187], v[64:67]
  ds_read_b128 v[124:127], v11 offset:24576
  buffer_load_dwordx4 v[180:183], v53, s[20:23], s10 offen offset:0 sc1
  s_waitcnt lgkmcnt(14)
  v_mfma_f32_16x16x32_bf16 v[68:71], v[148:151], v[184:187], v[68:71]
  ds_read_b128 v[128:131], v11 offset:25600
  s_waitcnt lgkmcnt(14)
  v_mfma_f32_16x16x32_bf16 v[72:75], v[152:155], v[184:187], v[72:75]
  ds_read_b128 v[132:135], v11 offset:26624
  s_barrier
  s_waitcnt vmcnt(11) lgkmcnt(14)
  v_mfma_f32_16x16x32_bf16 v[56:59], v[76:79], v[188:191], v[56:59]
  ds_read_b128 v[136:139], v11 offset:27648
  s_waitcnt lgkmcnt(14)
  v_mfma_f32_16x16x32_bf16 v[60:63], v[80:83], v[188:191], v[60:63]
  ds_read_b128 v[140:143], v4 offset:0
  s_waitcnt lgkmcnt(14)
  v_mfma_f32_16x16x32_bf16 v[64:67], v[84:87], v[188:191], v[64:67]
  ds_read_b128 v[144:147], v4 offset:1024
  s_waitcnt lgkmcnt(14)
  v_mfma_f32_16x16x32_bf16 v[68:71], v[88:91], v[188:191], v[68:71]
  ds_read_b128 v[148:151], v4 offset:2048
  s_waitcnt lgkmcnt(14)
  v_mfma_f32_16x16x32_bf16 v[72:75], v[92:95], v[188:191], v[72:75]
  ds_read_b128 v[152:155], v4 offset:3072
  s_waitcnt vmcnt(10) lgkmcnt(14)
  v_mfma_f32_16x16x32_bf16 v[56:59], v[96:99], v[192:195], v[56:59]
  ds_read_b128 v[76:79], v4 offset:4096
  s_waitcnt lgkmcnt(14)
  v_mfma_f32_16x16x32_bf16 v[60:63], v[100:103], v[192:195], v[60:63]
  ds_read_b128 v[80:83], v4 offset:5120
  s_waitcnt lgkmcnt(14)
  v_mfma_f32_16x16x32_bf16 v[64:67], v[104:107], v[192:195], v[64:67]
  ds_read_b128 v[84:87], v4 offset:6144
  s_waitcnt lgkmcnt(14)
  v_mfma_f32_16x16x32_bf16 v[68:71], v[108:111], v[192:195], v[68:71]
  ds_read_b128 v[88:91], v4 offset:7168
  s_waitcnt lgkmcnt(14)
  v_mfma_f32_16x16x32_bf16 v[72:75], v[112:115], v[192:195], v[72:75]
  ds_read_b128 v[92:95], v4 offset:8192
  s_waitcnt vmcnt(9) lgkmcnt(14)
  v_mfma_f32_16x16x32_bf16 v[56:59], v[116:119], v[196:199], v[56:59]
  ds_read_b128 v[96:99], v4 offset:9216
  s_waitcnt lgkmcnt(14)
  v_mfma_f32_16x16x32_bf16 v[60:63], v[120:123], v[196:199], v[60:63]
  ds_read_b128 v[100:103], v4 offset:10240
  s_waitcnt lgkmcnt(14)
  v_mfma_f32_16x16x32_bf16 v[64:67], v[124:127], v[196:199], v[64:67]
  ds_read_b128 v[104:107], v4 offset:11264
  s_waitcnt lgkmcnt(14)
  v_mfma_f32_16x16x32_bf16 v[68:71], v[128:131], v[196:199], v[68:71]
  ds_read_b128 v[108:111], v4 offset:12288
  s_waitcnt lgkmcnt(14)
  v_mfma_f32_16x16x32_bf16 v[72:75], v[132:135], v[196:199], v[72:75]
  ds_read_b128 v[112:115], v4 offset:13312
  s_waitcnt vmcnt(8) lgkmcnt(14)
  v_mfma_f32_16x16x32_bf16 v[56:59], v[136:139], v[200:203], v[56:59]
  ds_read_b128 v[116:119], v4 offset:14336
  s_waitcnt lgkmcnt(14)
  v_mfma_f32_16x16x32_bf16 v[60:63], v[140:143], v[200:203], v[60:63]
  ds_read_b128 v[120:123], v4 offset:15360
  s_waitcnt lgkmcnt(14)
  v_mfma_f32_16x16x32_bf16 v[64:67], v[144:147], v[200:203], v[64:67]
  ds_read_b128 v[124:127], v4 offset:16384
  s_waitcnt lgkmcnt(14)
  v_mfma_f32_16x16x32_bf16 v[68:71], v[148:151], v[200:203], v[68:71]
  ds_read_b128 v[128:131], v4 offset:17408
  s_waitcnt lgkmcnt(14)
  v_mfma_f32_16x16x32_bf16 v[72:75], v[152:155], v[200:203], v[72:75]
  ds_read_b128 v[132:135], v4 offset:18432
  s_waitcnt vmcnt(7) lgkmcnt(14)
  v_mfma_f32_16x16x32_bf16 v[56:59], v[76:79], v[204:207], v[56:59]
  ds_read_b128 v[136:139], v4 offset:19456
  s_waitcnt lgkmcnt(14)
  v_mfma_f32_16x16x32_bf16 v[60:63], v[80:83], v[204:207], v[60:63]
  ds_read_b128 v[140:143], v4 offset:20480
  s_waitcnt lgkmcnt(14)
  v_mfma_f32_16x16x32_bf16 v[64:67], v[84:87], v[204:207], v[64:67]
  ds_read_b128 v[144:147], v4 offset:21504
  s_waitcnt lgkmcnt(14)
  v_mfma_f32_16x16x32_bf16 v[68:71], v[88:91], v[204:207], v[68:71]
  ds_read_b128 v[148:151], v4 offset:22528
  s_waitcnt lgkmcnt(14)
  v_mfma_f32_16x16x32_bf16 v[72:75], v[92:95], v[204:207], v[72:75]
  ds_read_b128 v[152:155], v4 offset:23552
  s_waitcnt vmcnt(6) lgkmcnt(14)
  v_mfma_f32_16x16x32_bf16 v[56:59], v[96:99], v[156:159], v[56:59]
  ds_read_b128 v[76:79], v4 offset:24576
  s_waitcnt lgkmcnt(14)
  v_mfma_f32_16x16x32_bf16 v[60:63], v[100:103], v[156:159], v[60:63]
  ds_read_b128 v[80:83], v4 offset:25600
  s_waitcnt lgkmcnt(14)
  v_mfma_f32_16x16x32_bf16 v[64:67], v[104:107], v[156:159], v[64:67]
  ds_read_b128 v[84:87], v4 offset:26624
  s_waitcnt lgkmcnt(14)
  v_mfma_f32_16x16x32_bf16 v[68:71], v[108:111], v[156:159], v[68:71]
  ds_read_b128 v[88:91], v4 offset:27648
  s_waitcnt lgkmcnt(14)
  v_mfma_f32_16x16x32_bf16 v[72:75], v[112:115], v[156:159], v[72:75]
  ds_read_b128 v[92:95], v4 offset:28672
  s_barrier
  s_waitcnt vmcnt(5) lgkmcnt(14)
  v_mfma_f32_16x16x32_bf16 v[56:59], v[116:119], v[160:163], v[56:59]
  ds_read_b128 v[96:99], v4 offset:29696
  s_waitcnt lgkmcnt(14)
  v_mfma_f32_16x16x32_bf16 v[60:63], v[120:123], v[160:163], v[60:63]
  ds_read_b128 v[100:103], v4 offset:30720
  s_waitcnt lgkmcnt(14)
  v_mfma_f32_16x16x32_bf16 v[64:67], v[124:127], v[160:163], v[64:67]
  ds_read_b128 v[104:107], v4 offset:31744
  s_waitcnt lgkmcnt(14)
  v_mfma_f32_16x16x32_bf16 v[68:71], v[128:131], v[160:163], v[68:71]
  ds_read_b128 v[108:111], v4 offset:32768
  s_waitcnt lgkmcnt(14)
  v_mfma_f32_16x16x32_bf16 v[72:75], v[132:135], v[160:163], v[72:75]
  ds_read_b128 v[112:115], v4 offset:33792
  s_waitcnt vmcnt(4) lgkmcnt(14)
  v_mfma_f32_16x16x32_bf16 v[56:59], v[136:139], v[164:167], v[56:59]
  ds_read_b128 v[116:119], v4 offset:34816
  s_waitcnt lgkmcnt(14)
  v_mfma_f32_16x16x32_bf16 v[60:63], v[140:143], v[164:167], v[60:63]
  ds_read_b128 v[120:123], v4 offset:35840
  s_waitcnt lgkmcnt(14)
  v_mfma_f32_16x16x32_bf16 v[64:67], v[144:147], v[164:167], v[64:67]
  ds_read_b128 v[124:127], v4 offset:36864
  s_waitcnt lgkmcnt(14)
  v_mfma_f32_16x16x32_bf16 v[68:71], v[148:151], v[164:167], v[68:71]
  ds_read_b128 v[128:131], v4 offset:37888
  s_waitcnt lgkmcnt(14)
  v_mfma_f32_16x16x32_bf16 v[72:75], v[152:155], v[164:167], v[72:75]
  ds_read_b128 v[132:135], v4 offset:38912
  s_waitcnt vmcnt(3) lgkmcnt(14)
  v_mfma_f32_16x16x32_bf16 v[56:59], v[76:79], v[168:171], v[56:59]
  ds_read_b128 v[136:139], v4 offset:39936
  s_waitcnt lgkmcnt(14)
  v_mfma_f32_16x16x32_bf16 v[60:63], v[80:83], v[168:171], v[60:63]
  ds_read_b128 v[140:143], v4 offset:40960
  s_waitcnt lgkmcnt(14)
  v_mfma_f32_16x16x32_bf16 v[64:67], v[84:87], v[168:171], v[64:67]
  ds_read_b128 v[144:147], v4 offset:41984
  s_waitcnt lgkmcnt(14)
  v_mfma_f32_16x16x32_bf16 v[68:71], v[88:91], v[168:171], v[68:71]
  ds_read_b128 v[148:151], v4 offset:43008
  s_waitcnt lgkmcnt(14)
  v_mfma_f32_16x16x32_bf16 v[72:75], v[92:95], v[168:171], v[72:75]
  ds_read_b128 v[152:155], v4 offset:44032
  s_waitcnt vmcnt(2) lgkmcnt(14)
  v_mfma_f32_16x16x32_bf16 v[56:59], v[96:99], v[172:175], v[56:59]
  s_waitcnt lgkmcnt(13)
  v_mfma_f32_16x16x32_bf16 v[60:63], v[100:103], v[172:175], v[60:63]
  s_waitcnt lgkmcnt(12)
  v_mfma_f32_16x16x32_bf16 v[64:67], v[104:107], v[172:175], v[64:67]
  s_waitcnt lgkmcnt(11)
  v_mfma_f32_16x16x32_bf16 v[68:71], v[108:111], v[172:175], v[68:71]
  s_waitcnt lgkmcnt(10)
  v_mfma_f32_16x16x32_bf16 v[72:75], v[112:115], v[172:175], v[72:75]
  s_waitcnt vmcnt(1) lgkmcnt(9)
  v_mfma_f32_16x16x32_bf16 v[56:59], v[116:119], v[176:179], v[56:59]
  s_waitcnt lgkmcnt(8)
  v_mfma_f32_16x16x32_bf16 v[60:63], v[120:123], v[176:179], v[60:63]
  s_waitcnt lgkmcnt(7)
  v_mfma_f32_16x16x32_bf16 v[64:67], v[124:127], v[176:179], v[64:67]
  s_waitcnt lgkmcnt(6)
  v_mfma_f32_16x16x32_bf16 v[68:71], v[128:131], v[176:179], v[68:71]
  s_waitcnt lgkmcnt(5)
  v_mfma_f32_16x16x32_bf16 v[72:75], v[132:135], v[176:179], v[72:75]
  s_waitcnt vmcnt(0) lgkmcnt(4)
  v_mfma_f32_16x16x32_bf16 v[56:59], v[136:139], v[180:183], v[56:59]
  s_waitcnt lgkmcnt(3)
  v_mfma_f32_16x16x32_bf16 v[60:63], v[140:143], v[180:183], v[60:63]
  s_waitcnt lgkmcnt(2)
  v_mfma_f32_16x16x32_bf16 v[64:67], v[144:147], v[180:183], v[64:67]
  s_waitcnt lgkmcnt(1)
  v_mfma_f32_16x16x32_bf16 v[68:71], v[148:151], v[180:183], v[68:71]
  s_waitcnt lgkmcnt(0)
  v_mfma_f32_16x16x32_bf16 v[72:75], v[152:155], v[180:183], v[72:75]
  s_barrier
  v_cvt_pk_bf16_f32 v156, v56, v57
  v_cvt_pk_bf16_f32 v157, v58, v59
  v_cvt_pk_bf16_f32 v158, v60, v61
  v_cvt_pk_bf16_f32 v159, v62, v63
  buffer_store_dwordx4 v[156:159], v4, s[24:27], s42 offen offset:0 sc1
  v_cvt_pk_bf16_f32 v160, v64, v65
  v_cvt_pk_bf16_f32 v161, v66, v67
  v_cvt_pk_bf16_f32 v162, v68, v69
  v_cvt_pk_bf16_f32 v163, v70, v71
  buffer_store_dwordx4 v[160:163], v4, s[24:27], s43 offen offset:0 sc1
  v_cvt_pk_bf16_f32 v164, v72, v73
  v_cvt_pk_bf16_f32 v165, v74, v75
  v_cvt_pk_bf16_f32 v172, v72, v73
  v_cvt_pk_bf16_f32 v173, v74, v75
  v_cvt_pk_bf16_f32 v174, v72, v73
  v_cvt_pk_bf16_f32 v175, v74, v75
  s_nop 0
  v_permlane16_swap_b32 v172, v174
  v_permlane16_swap_b32 v173, v175
  buffer_store_dwordx4 v[172:175], v13, s[24:27], s44 offen offset:0 sc1
  v_pk_add_f32 v[168:169], v[56:57], v[58:59]
  v_pk_mul_f32 v[170:171], v[56:57], v[56:57]
  v_pk_fma_f32 v[170:171], v[58:59], v[58:59], v[170:171]
  v_pk_add_f32 v[168:169], v[168:169], v[60:61]
  v_pk_fma_f32 v[170:171], v[60:61], v[60:61], v[170:171]
  v_pk_add_f32 v[168:169], v[168:169], v[62:63]
  v_pk_fma_f32 v[170:171], v[62:63], v[62:63], v[170:171]
  v_pk_add_f32 v[168:169], v[168:169], v[64:65]
  v_pk_fma_f32 v[170:171], v[64:65], v[64:65], v[170:171]
  v_pk_add_f32 v[168:169], v[168:169], v[66:67]
  v_pk_fma_f32 v[170:171], v[66:67], v[66:67], v[170:171]
  v_pk_add_f32 v[168:169], v[168:169], v[68:69]
  v_pk_fma_f32 v[170:171], v[68:69], v[68:69], v[170:171]
  v_pk_add_f32 v[168:169], v[168:169], v[70:71]
  v_pk_fma_f32 v[170:171], v[70:71], v[70:71], v[170:171]
  v_pk_add_f32 v[168:169], v[168:169], v[72:73]
  v_pk_fma_f32 v[170:171], v[72:73], v[72:73], v[170:171]
  v_pk_add_f32 v[168:169], v[168:169], v[74:75]
  v_pk_fma_f32 v[170:171], v[74:75], v[74:75], v[170:171]
  v_add_f32 v168, v168, v169
  v_add_f32 v170, v170, v171
  s_nop 1
  v_permlane32_swap_b32 v168, v170
  v_add_f32 v168, v168, v170
  v_mov_b32 v170, v168
  s_nop 1
  v_permlane16_swap_b32 v168, v170
  v_add_f32 v168, v168, v170
  v_mov_b32 v170, v168
  s_nop 1
  v_permlane32_swap_b32 v168, v170
  s_add_u32 s16, s14, 0x2000000
  s_addc_u32 s17, s15, 0
  s_mov_b32 s18, 0x20000
  s_mov_b32 s19, 0x00020000
  v_mov_b32 v169, v170
  s_lshl_b32 s28, s13, 7
  s_add_u32 s28, s28, s11
  v_lshlrev_b32 v14, 3, v1
  s_mov_b64 exec, 0xffff
  buffer_store_dwordx2 v[168:169], v14, s[16:19], s28 offen sc1
  s_mov_b64 exec, -1
  v_lshlrev_b32 v20, 16, v40
  v_and_b32 v21, 0xffff0000, v40
  v_lshlrev_b32 v14, 16, v156
  v_and_b32 v15, 0xffff0000, v156
  v_pk_add_f32 v[20:21], v[20:21], v[14:15]
  v_lshlrev_b32 v22, 16, v41
  v_and_b32 v23, 0xffff0000, v41
  v_lshlrev_b32 v14, 16, v157
  v_and_b32 v15, 0xffff0000, v157
  v_pk_add_f32 v[22:23], v[22:23], v[14:15]
  v_lshlrev_b32 v24, 16, v42
  v_and_b32 v25, 0xffff0000, v42
  v_lshlrev_b32 v14, 16, v158
  v_and_b32 v15, 0xffff0000, v158
  v_pk_add_f32 v[24:25], v[24:25], v[14:15]
  v_lshlrev_b32 v26, 16, v43
  v_and_b32 v27, 0xffff0000, v43
  v_lshlrev_b32 v14, 16, v159
  v_and_b32 v15, 0xffff0000, v159
  v_pk_add_f32 v[26:27], v[26:27], v[14:15]
  v_lshlrev_b32 v28, 16, v44
  v_and_b32 v29, 0xffff0000, v44
  v_lshlrev_b32 v14, 16, v160
  v_and_b32 v15, 0xffff0000, v160
  v_pk_add_f32 v[28:29], v[28:29], v[14:15]
  v_lshlrev_b32 v30, 16, v45
  v_and_b32 v31, 0xffff0000, v45
  v_lshlrev_b32 v14, 16, v161
  v_and_b32 v15, 0xffff0000, v161
  v_pk_add_f32 v[30:31], v[30:31], v[14:15]
  v_lshlrev_b32 v32, 16, v46
  v_and_b32 v33, 0xffff0000, v46
  v_lshlrev_b32 v14, 16, v162
  v_and_b32 v15, 0xffff0000, v162
  v_pk_add_f32 v[32:33], v[32:33], v[14:15]
  v_lshlrev_b32 v34, 16, v47
  v_and_b32 v35, 0xffff0000, v47
  v_lshlrev_b32 v14, 16, v163
  v_and_b32 v15, 0xffff0000, v163
  v_pk_add_f32 v[34:35], v[34:35], v[14:15]
  v_lshlrev_b32 v36, 16, v48
  v_and_b32 v37, 0xffff0000, v48
  v_lshlrev_b32 v14, 16, v164
  v_and_b32 v15, 0xffff0000, v164
  v_pk_add_f32 v[36:37], v[36:37], v[14:15]
  v_lshlrev_b32 v38, 16, v49
  v_and_b32 v39, 0xffff0000, v49
  v_lshlrev_b32 v14, 16, v165
  v_and_b32 v15, 0xffff0000, v165
  v_pk_add_f32 v[38:39], v[38:39], v[14:15]
  s_bfe_u32 s12, s2, 0x20001
  s_lshl_b32 s12, s12, 2
  s_bfe_u32 s8, s2, 0x20003
  s_add_u32 s12, s12, s8
  s_lshl_b32 s12, s12, 7
  s_lshl_b32 s8, s3, 5
  s_add_u32 s12, s12, s8
  s_lshr_b32 s13, s2, 5
  s_lshl_b32 s13, s13, 1
  s_and_b32 s8, s2, 1
  s_add_u32 s13, s13, s8
  s_lshl_b32 s11, s12, 6
  v_add_u32 v5, s12, v2
  s_mul_i32 s24, s13, 7
  s_add_u32 s25, s24, 1
  s_lshr_b32 s25, s25, 1
  s_and_b32 s26, s13, 1
  s_add_u32 s27, s25, 3
  s_sub_u32 s28, s25, 1
  s_cmp_eq_u32 s26, 0
  s_cselect_b32 s27, s27, s28
  s_mul_i32 s24, s13, 3
  s_add_u32 s24, s24, 6
  s_cmp_ge_u32 s13, 12
  s_cselect_b32 s25, s24, s25
  s_cselect_b32 s27, 0x2000, s27
  s_lshl_b32 s26, s26, 3
  s_add_u32 s24, s25, 0
  s_lshl_b32 s42, s24, 17
  s_add_u32 s42, s42, s11
  s_add_u32 s24, s25, 1
  s_lshl_b32 s43, s24, 17
  s_add_u32 s43, s43, s11
  s_add_u32 s24, s25, 2
  s_lshl_b32 s44, s24, 17
  s_add_u32 s44, s44, s11
  s_lshl_b32 s45, s27, 17
  s_add_u32 s45, s45, s11
  s_add_u32 s46, s45, s26
  s_lshl_b32 s24, s26, 6
  s_add_u32 s45, s45, s24
  s_lshr_b32 s8, s12, 6
  s_lshl_b32 s8, s8, 11
  s_add_u32 s8, s8, 131072
  v_lshl_add_u32 v9, v1, 8, s8
  s_lshr_b32 s8, s12, 7
  s_lshl_b32 s8, s8, 4
  s_add_u32 s8, s8, s13
  s_lshl_b32 s8, s8, 8
  s_add_u32 s53, s8, 196608
  s_mov_b32 s10, 0
  s_lshl_b32 s10, s10, 17
  s_add_u32 s10, s10, s11
  s_add_u32 s20, s14, 0x1c00000
  s_addc_u32 s21, s15, 0
  s_mov_b32 s22, 0x280000
  s_mov_b32 s23, 0x00020000
  s_add_u32 s32, s14, 0x2000000
  s_addc_u32 s33, s15, 0
  s_mov_b32 s34, 0x20000
  s_mov_b32 s35, 0x00020000
  s_cmp_lt_u32 s27, s25
  s_cselect_b32 s28, 128, 0
  s_cselect_b32 s29, 16, 384
  s_add_u32 s28, s28, 159808
  s_add_u32 s29, s29, 159808
  v_lshl_add_u32 v12, v3, 5, s28
  v_lshl_add_u32 v14, v3, 5, s29
  v_lshlrev_b32 v15, 8, v3
  v_lshl_add_u32 v15, v2, 3, v15
  s_waitcnt vmcnt(0)
  s_mov_b64 exec, 1
  ds_add_rtn_u32 v8, v6, v7
  s_waitcnt lgkmcnt(0)
  v_readfirstlane_b32 s41, v8
  s_nop 0
  s_cmp_lg_u32 s41, 11
  s_cbranch_scc1 kf_kernel_ns107
  buffer_store_dword v7, off, s[48:51], s52 sc1
kf_kernel_ns107:
  s_add_u32 s24, s14, 0x2400000
  s_addc_u32 s25, s15, 0
  s_mov_b32 s26, 0x6c0000
  s_mov_b32 s27, 0x00020000
  s_mov_b64 exec, -1
  ds_read_b128 v[96:99], v4 offset:45056
  ds_read_b128 v[100:103], v4 offset:46080
  ds_read_b128 v[104:107], v4 offset:47104
  ds_read_b128 v[108:111], v4 offset:48128
  ds_read_b128 v[112:115], v4 offset:49152
  ds_read_b128 v[116:119], v4 offset:50176
  ds_read_b128 v[120:123], v4 offset:51200
  s_mov_b64 exec, 0xff
  s_movk_i32 s40, 30000
kf_kernel_pl108:
  buffer_load_dword v8, v9, s[48:51], 0 offen sc1
  s_waitcnt vmcnt(0)
  v_cmp_eq_u32 vcc, 0, v8
  s_cbranch_vccz kf_kernel_pd109
  s_sub_u32 s40, s40, 1
  s_cbranch_scc0 kf_kernel_pl108
kf_kernel_pd109:
  s_mov_b64 exec, -1
  buffer_load_dwordx2 v[216:217], v15, s[32:35], s11 offen offset:0 sc1
  buffer_load_dwordx2 v[218:219], v15, s[32:35], s11 offen offset:128 sc1
  buffer_load_dwordx2 v[220:221], v15, s[32:35], s11 offen offset:1024 sc1
  buffer_load_dwordx2 v[222:223], v15, s[32:35], s11 offen offset:1152 sc1
  buffer_load_dwordx4 v[152:155], v4, s[20:23], s10 offen offset:0 sc1
  buffer_load_dwordx4 v[156:159], v4, s[20:23], s10 offen offset:1024 sc1
  s_add_u32 s10, s10, 0x20000
  buffer_load_dwordx4 v[160:163], v4, s[20:23], s10 offen offset:0 sc1
  buffer_load_dwordx4 v[164:167], v4, s[20:23], s10 offen offset:1024 sc1
  s_add_u32 s10, s10, 0x20000
  buffer_load_dwordx4 v[168:171], v4, s[20:23], s10 offen offset:0 sc1
  buffer_load_dwordx4 v[172:175], v4, s[20:23], s10 offen offset:1024 sc1
  s_add_u32 s10, s10, 0x20000
  buffer_load_dwordx4 v[176:179], v4, s[20:23], s10 offen offset:0 sc1
  buffer_load_dwordx4 v[180:183], v4, s[20:23], s10 offen offset:1024 sc1
  s_add_u32 s10, s10, 0x20000
  buffer_load_dwordx4 v[184:187], v4, s[20:23], s10 offen offset:0 sc1
  buffer_load_dwordx4 v[188:191], v4, s[20:23], s10 offen offset:1024 sc1
  s_add_u32 s10, s10, 0x20000
  buffer_load_dwordx4 v[192:195], v4, s[20:23], s10 offen offset:0 sc1
  buffer_load_dwordx4 v[196:199], v4, s[20:23], s10 offen offset:1024 sc1
  s_add_u32 s10, s10, 0x20000
  buffer_load_dwordx4 v[200:203], v4, s[20:23], s10 offen offset:0 sc1
  buffer_load_dwordx4 v[204:207], v4, s[20:23], s10 offen offset:1024 sc1
  s_add_u32 s10, s10, 0x20000
  s_waitcnt vmcnt(13) lgkmcnt(6)
  v_mfma_f32_16x16x32_bf16 v[40:43], v[96:99], v[152:155], 0
  ds_read_b128 v[124:127], v4 offset:52224
  s_waitcnt vmcnt(12)
  v_mfma_f32_16x16x32_bf16 v[68:71], v[96:99], v[156:159], 0
  ds_read_b128 v[128:131], v4 offset:53248
  s_waitcnt lgkmcnt(7)
  v_mfma_f32_16x16x32_bf16 v[44:47], v[100:103], v[152:155], 0
  ds_read_b128 v[132:135], v4 offset:54272
  v_mfma_f32_16x16x32_bf16 v[72:75], v[100:103], v[156:159], 0
  ds_read_b128 v[136:139], v4 offset:55296
  s_waitcnt lgkmcnt(8)
  v_mfma_f32_16x16x32_bf16 v[48:51], v[104:107], v[152:155], 0
  ds_read_b128 v[140:143], v4 offset:56320
  v_mfma_f32_16x16x32_bf16 v[76:79], v[104:107], v[156:159], 0
  ds_read_b128 v[144:147], v4 offset:57344
  buffer_load_dwordx4 v[208:211], v4, s[20:23], s10 offen offset:0 sc1
  s_waitcnt lgkmcnt(9)
  v_mfma_f32_16x16x32_bf16 v[52:55], v[108:111], v[152:155], 0
  ds_read_b128 v[148:151], v4 offset:58368
  v_mfma_f32_16x16x32_bf16 v[80:83], v[108:111], v[156:159], 0
  buffer_load_dwordx4 v[212:215], v4, s[20:23], s10 offen offset:1024 sc1
  s_add_u32 s10, s10, 0x20000
  s_waitcnt lgkmcnt(9)
  v_mfma_f32_16x16x32_bf16 v[56:59], v[112:115], v[152:155], 0
  v_mfma_f32_16x16x32_bf16 v[84:87], v[112:115], v[156:159], 0
  s_waitcnt lgkmcnt(8)
  v_mfma_f32_16x16x32_bf16 v[60:63], v[116:119], v[152:155], 0
  v_mfma_f32_16x16x32_bf16 v[88:91], v[116:119], v[156:159], 0
  s_waitcnt lgkmcnt(7)
  v_mfma_f32_16x16x32_bf16 v[64:67], v[120:123], v[152:155], 0
  v_mfma_f32_16x16x32_bf16 v[92:95], v[120:123], v[156:159], 0
  s_waitcnt vmcnt(13) lgkmcnt(6)
  v_mfma_f32_16x16x32_bf16 v[40:43], v[124:127], v[160:163], v[40:43]
  ds_read_b128 v[96:99], v4 offset:59392
  s_waitcnt vmcnt(12)
  v_mfma_f32_16x16x32_bf16 v[68:71], v[124:127], v[164:167], v[68:71]
  ds_read_b128 v[100:103], v4 offset:60416
  s_waitcnt lgkmcnt(7)
  v_mfma_f32_16x16x32_bf16 v[44:47], v[128:131], v[160:163], v[44:47]
  ds_read_b128 v[104:107], v4 offset:61440
  v_mfma_f32_16x16x32_bf16 v[72:75], v[128:131], v[164:167], v[72:75]
  ds_read_b128 v[108:111], v4 offset:62464
  s_waitcnt lgkmcnt(8)
  v_mfma_f32_16x16x32_bf16 v[48:51], v[132:135], v[160:163], v[48:51]
  ds_read_b128 v[112:115], v4 offset:63488
  v_mfma_f32_16x16x32_bf16 v[76:79], v[132:135], v[164:167], v[76:79]
  ds_read_b128 v[116:119], v4 offset:64512
  buffer_load_dwordx4 v[152:155], v4, s[20:23], s10 offen offset:0 sc1
  s_waitcnt lgkmcnt(9)
  v_mfma_f32_16x16x32_bf16 v[52:55], v[136:139], v[160:163], v[52:55]
  ds_read_b128 v[120:123], v10 offset:0
  v_mfma_f32_16x16x32_bf16 v[80:83], v[136:139], v[164:167], v[80:83]
  buffer_load_dwordx4 v[156:159], v4, s[20:23], s10 offen offset:1024 sc1
  s_add_u32 s10, s10, 0x20000
  s_waitcnt lgkmcnt(9)
  v_mfma_f32_16x16x32_bf16 v[56:59], v[140:143], v[160:163], v[56:59]
  v_mfma_f32_16x16x32_bf16 v[84:87], v[140:143], v[164:167], v[84:87]
  s_waitcnt lgkmcnt(8)
  v_mfma_f32_16x16x32_bf16 v[60:63], v[144:147], v[160:163], v[60:63]
  v_mfma_f32_16x16x32_bf16 v[88:91], v[144:147], v[164:167], v[88:91]
  s_waitcnt lgkmcnt(7)
  v_mfma_f32_16x16x32_bf16 v[64:67], v[148:151], v[160:163], v[64:67]
  v_mfma_f32_16x16x32_bf16 v[92:95], v[148:151], v[164:167], v[92:95]
  s_barrier
  s_waitcnt vmcnt(13) lgkmcnt(6)
  v_mfma_f32_16x16x32_bf16 v[40:43], v[96:99], v[168:171], v[40:43]
  ds_read_b128 v[124:127], v10 offset:1024
  s_waitcnt vmcnt(12)
  v_mfma_f32_16x16x32_bf16 v[68:71], v[96:99], v[172:175], v[68:71]
  ds_read_b128 v[128:131], v10 offset:2048
  s_waitcnt lgkmcnt(7)
  v_mfma_f32_16x16x32_bf16 v[44:47], v[100:103], v[168:171], v[44:47]
  ds_read_b128 v[132:135], v10 offset:3072
  v_mfma_f32_16x16x32_bf16 v[72:75], v[100:103], v[172:175], v[72:75]
  ds_read_b128 v[136:139], v10 offset:4096
  v_add_f32 v216, v216, v218
  s_waitcnt lgkmcnt(8)
  v_mfma_f32_16x16x32_bf16 v[48:51], v[104:107], v[168:171], v[48:51]
  ds_read_b128 v[140:143], v10 offset:5120
  v_mfma_f32_16x16x32_bf16 v[76:79], v[104:107], v[172:175], v[76:79]
  ds_read_b128 v[144:147], v10 offset:6144
  buffer_load_dwordx4 v[160:163], v4, s[20:23], s10 offen offset:0 sc1
  s_waitcnt lgkmcnt(9)
  v_mfma_f32_16x16x32_bf16 v[52:55], v[108:111], v[168:171], v[52:55]
  ds_read_b128 v[148:151], v10 offset:7168
  v_add_f32 v217, v217, v219
  v_mfma_f32_16x16x32_bf16 v[80:83], v[108:111], v[172:175], v[80:83]
  buffer_load_dwordx4 v[164:167], v4, s[20:23], s10 offen offset:1024 sc1
  s_add_u32 s10, s10, 0x20000
  s_waitcnt lgkmcnt(9)
  v_mfma_f32_16x16x32_bf16 v[56:59], v[112:115], v[168:171], v[56:59]
  v_mfma_f32_16x16x32_bf16 v[84:87], v[112:115], v[172:175], v[84:87]
  s_waitcnt lgkmcnt(8)
  v_mfma_f32_16x16x32_bf16 v[60:63], v[116:119], v[168:171], v[60:63]
  v_permlane32_swap_b32 v216, v217
  v_mfma_f32_16x16x32_bf16 v[88:91], v[116:119], v[172:175], v[88:91]
  s_waitcnt lgkmcnt(7)
  v_mfma_f32_16x16x32_bf16 v[64:67], v[120:123], v[168:171], v[64:67]
  v_mfma_f32_16x16x32_bf16 v[92:95], v[120:123], v[172:175], v[92:95]
  v_add_f32 v216, v216, v217
  s_waitcnt vmcnt(13) lgkmcnt(6)
  v_mfma_f32_16x16x32_bf16 v[40:43], v[124:127], v[176:179], v[40:43]
  ds_read_b128 v[96:99], v10 offset:8192
  s_waitcnt vmcnt(12)
  v_mfma_f32_16x16x32_bf16 v[68:71], v[124:127], v[180:183], v[68:71]
  ds_read_b128 v[100:103], v10 offset:9216
  s_waitcnt lgkmcnt(7)
  v_mfma_f32_16x16x32_bf16 v[44:47], v[128:131], v[176:179], v[44:47]
  ds_read_b128 v[104:107], v10 offset:10240
  v_mfma_f32_16x16x32_bf16 v[72:75], v[128:131], v[180:183], v[72:75]
  ds_read_b128 v[108:111], v10 offset:11264
  v_mov_b32 v217, v216
  s_waitcnt lgkmcnt(8)
  v_mfma_f32_16x16x32_bf16 v[48:51], v[132:135], v[176:179], v[48:51]
  ds_read_b128 v[112:115], v10 offset:12288
  v_mfma_f32_16x16x32_bf16 v[76:79], v[132:135], v[180:183], v[76:79]
  ds_read_b128 v[116:119], v10 offset:13312
  buffer_load_dwordx4 v[168:171], v4, s[20:23], s10 offen offset:0 sc1
  s_waitcnt lgkmcnt(9)
  v_mfma_f32_16x16x32_bf16 v[52:55], v[136:139], v[176:179], v[52:55]
  ds_read_b128 v[120:123], v10 offset:14336
  v_permlane16_swap_b32 v216, v217
  v_mfma_f32_16x16x32_bf16 v[80:83], v[136:139], v[180:183], v[80:83]
  buffer_load_dwordx4 v[172:175], v4, s[20:23], s10 offen offset:1024 sc1
  s_add_u32 s10, s10, 0x20000
  s_waitcnt lgkmcnt(9)
  v_mfma_f32_16x16x32_bf16 v[56:59], v[140:143], v[176:179], v[56:59]
  v_mfma_f32_16x16x32_bf16 v[84:87], v[140:143], v[180:183], v[84:87]
  s_waitcnt lgkmcnt(8)
  v_mfma_f32_16x16x32_bf16 v[60:63], v[144:147], v[176:179], v[60:63]
  v_add_f32 v216, v216, v217
  v_mfma_f32_16x16x32_bf16 v[88:91], v[144:147], v[180:183], v[88:91]
  s_waitcnt lgkmcnt(7)
  v_mfma_f32_16x16x32_bf16 v[64:67], v[148:151], v[176:179], v[64:67]
  v_mfma_f32_16x16x32_bf16 v[92:95], v[148:151], v[180:183], v[92:95]
  v_mov_b32 v217, v216
  s_barrier
  s_waitcnt vmcnt(13) lgkmcnt(6)
  v_mfma_f32_16x16x32_bf16 v[40:43], v[96:99], v[184:187], v[40:43]
  ds_read_b128 v[124:127], v10 offset:15360
  s_waitcnt vmcnt(12)
  v_mfma_f32_16x16x32_bf16 v[68:71], v[96:99], v[188:191], v[68:71]
  ds_read_b128 v[128:131], v10 offset:16384
  s_waitcnt lgkmcnt(7)
  v_mfma_f32_16x16x32_bf16 v[44:47], v[100:103], v[184:187], v[44:47]
  ds_read_b128 v[132:135], v10 offset:17408
  v_mfma_f32_16x16x32_bf16 v[72:75], v[100:103], v[188:191], v[72:75]
  ds_read_b128 v[136:139], v10 offset:18432
  v_permlane32_swap_b32 v216, v217
  s_waitcnt lgkmcnt(8)
  v_mfma_f32_16x16x32_bf16 v[48:51], v[104:107], v[184:187], v[48:51]
  ds_read_b128 v[140:143], v10 offset:19456
  v_mfma_f32_16x16x32_bf16 v[76:79], v[104:107], v[188:191], v[76:79]
  ds_read_b128 v[144:147], v10 offset:20480
  buffer_load_dwordx4 v[176:179], v4, s[20:23], s10 offen offset:0 sc1
  s_waitcnt lgkmcnt(9)
  v_mfma_f32_16x16x32_bf16 v[52:55], v[108:111], v[184:187], v[52:55]
  ds_read_b128 v[148:151], v10 offset:21504
  v_mul_f32 v216, 0x3acccccd, v216
  v_mfma_f32_16x16x32_bf16 v[80:83], v[108:111], v[188:191], v[80:83]
  buffer_load_dwordx4 v[180:183], v4, s[20:23], s10 offen offset:1024 sc1
  s_add_u32 s10, s10, 0x20000
  s_waitcnt lgkmcnt(9)
  v_mfma_f32_16x16x32_bf16 v[56:59], v[112:115], v[184:187], v[56:59]
  v_mfma_f32_16x16x32_bf16 v[84:87], v[112:115], v[188:191], v[84:87]
  s_waitcnt lgkmcnt(8)
  v_mfma_f32_16x16x32_bf16 v[60:63], v[116:119], v[184:187], v[60:63]
  v_mul_f32 v217, 0x3acccccd, v217
  v_mfma_f32_16x16x32_bf16 v[88:91], v[116:119], v[188:191], v[88:91]
  s_waitcnt lgkmcnt(7)
  v_mfma_f32_16x16x32_bf16 v[64:67], v[120:123], v[184:187], v[64:67]
  v_mfma_f32_16x16x32_bf16 v[92:95], v[120:123], v[188:191], v[92:95]
  v_fma_f32 v217, -v216, v216, v217
  s_waitcnt vmcnt(13) lgkmcnt(6)
  v_mfma_f32_16x16x32_bf16 v[40:43], v[124:127], v[192:195], v[40:43]
  ds_read_b128 v[96:99], v10 offset:22528
  s_waitcnt vmcnt(12)
  v_mfma_f32_16x16x32_bf16 v[68:71], v[124:127], v[196:199], v[68:71]
  ds_read_b128 v[100:103], v10 offset:23552
  s_waitcnt lgkmcnt(7)
  v_mfma_f32_16x16x32_bf16 v[44:47], v[128:131], v[192:195], v[44:47]
  ds_read_b128 v[104:107], v10 offset:24576
  v_mfma_f32_16x16x32_bf16 v[72:75], v[128:131], v[196:199], v[72:75]
  ds_read_b128 v[108:111], v10 offset:25600
  v_max_f32 v217, 0, v217
  s_waitcnt lgkmcnt(8)
  v_mfma_f32_16x16x32_bf16 v[48:51], v[132:135], v[192:195], v[48:51]
  ds_read_b128 v[112:115], v10 offset:26624
  v_mfma_f32_16x16x32_bf16 v[76:79], v[132:135], v[196:199], v[76:79]
  ds_read_b128 v[116:119], v10 offset:27648
  buffer_load_dwordx4 v[184:187], v4, s[20:23], s10 offen offset:0 sc1
  s_waitcnt lgkmcnt(9)
  v_mfma_f32_16x16x32_bf16 v[52:55], v[136:139], v[192:195], v[52:55]
  ds_read_b128 v[120:123], v10 offset:28672
  v_cvt_pk_bf16_f32 v218, v216, v217
  v_mfma_f32_16x16x32_bf16 v[80:83], v[136:139], v[196:199], v[80:83]
  buffer_load_dwordx4 v[188:191], v4, s[20:23], s10 offen offset:1024 sc1
  s_add_u32 s10, s10, 0x20000
  s_waitcnt lgkmcnt(9)
  v_mfma_f32_16x16x32_bf16 v[56:59], v[140:143], v[192:195], v[56:59]
  v_mfma_f32_16x16x32_bf16 v[84:87], v[140:143], v[196:199], v[84:87]
  s_waitcnt lgkmcnt(8)
  v_mfma_f32_16x16x32_bf16 v[60:63], v[144:147], v[192:195], v[60:63]
  v_lshlrev_b32 v216, 16, v218
  v_mfma_f32_16x16x32_bf16 v[88:91], v[144:147], v[196:199], v[88:91]
  s_waitcnt lgkmcnt(7)
  v_mfma_f32_16x16x32_bf16 v[64:67], v[148:151], v[192:195], v[64:67]
  v_mfma_f32_16x16x32_bf16 v[92:95], v[148:151], v[196:199], v[92:95]
  v_and_b32 v217, 0xffff0000, v218
  s_barrier
  s_waitcnt vmcnt(13) lgkmcnt(6)
  v_mfma_f32_16x16x32_bf16 v[40:43], v[96:99], v[200:203], v[40:43]
  ds_read_b128 v[124:127], v10 offset:29696
  s_waitcnt vmcnt(12)
  v_mfma_f32_16x16x32_bf16 v[68:71], v[96:99], v[204:207], v[68:71]
  ds_read_b128 v[128:131], v10 offset:30720
  s_waitcnt lgkmcnt(7)
  v_mfma_f32_16x16x32_bf16 v[44:47], v[100:103], v[200:203], v[44:47]
  ds_read_b128 v[132:135], v10 offset:31744
  v_mfma_f32_16x16x32_bf16 v[72:75], v[100:103], v[204:207], v[72:75]
  ds_read_b128 v[136:139], v10 offset:32768
  v_add_f32 v217, 0x3727c5ac, v217
  s_waitcnt lgkmcnt(8)
  v_mfma_f32_16x16x32_bf16 v[48:51], v[104:107], v[200:203], v[48:51]
  ds_read_b128 v[140:143], v10 offset:33792
  v_mfma_f32_16x16x32_bf16 v[76:79], v[104:107], v[204:207], v[76:79]
  ds_read_b128 v[144:147], v10 offset:34816
  buffer_load_dwordx4 v[192:195], v4, s[20:23], s10 offen offset:0 sc1
  s_waitcnt lgkmcnt(9)
  v_mfma_f32_16x16x32_bf16 v[52:55], v[108:111], v[200:203], v[52:55]
  ds_read_b128 v[148:151], v10 offset:35840
  v_cvt_pk_bf16_f32 v217, v217, v217
  v_mfma_f32_16x16x32_bf16 v[80:83], v[108:111], v[204:207], v[80:83]
  buffer_load_dwordx4 v[196:199], v4, s[20:23], s10 offen offset:1024 sc1
  s_add_u32 s10, s10, 0x20000
  s_waitcnt lgkmcnt(9)
  v_mfma_f32_16x16x32_bf16 v[56:59], v[112:115], v[200:203], v[56:59]
  v_mfma_f32_16x16x32_bf16 v[84:87], v[112:115], v[204:207], v[84:87]
  s_waitcnt lgkmcnt(8)
  v_mfma_f32_16x16x32_bf16 v[60:63], v[116:119], v[200:203], v[60:63]
  v_lshlrev_b32 v217, 16, v217
  v_mfma_f32_16x16x32_bf16 v[88:91], v[116:119], v[204:207], v[88:91]
  s_waitcnt lgkmcnt(7)
  v_mfma_f32_16x16x32_bf16 v[64:67], v[120:123], v[200:203], v[64:67]
  v_mfma_f32_16x16x32_bf16 v[92:95], v[120:123], v[204:207], v[92:95]
  v_sqrt_f32 v217, v217
  s_waitcnt vmcnt(13) lgkmcnt(6)
  v_mfma_f32_16x16x32_bf16 v[40:43], v[124:127], v[208:211], v[40:43]
  ds_read_b128 v[96:99], v10 offset:36864
  s_waitcnt vmcnt(12)
  v_mfma_f32_16x16x32_bf16 v[68:71], v[124:127], v[212:215], v[68:71]
  ds_read_b128 v[100:103], v10 offset:37888
  s_waitcnt lgkmcnt(7)
  v_mfma_f32_16x16x32_bf16 v[44:47], v[128:131], v[208:211], v[44:47]
  ds_read_b128 v[104:107], v10 offset:38912
  v_mfma_f32_16x16x32_bf16 v[72:75], v[128:131], v[212:215], v[72:75]
  ds_read_b128 v[108:111], v10 offset:39936
  v_cvt_pk_bf16_f32 v217, v217, v217
  s_waitcnt lgkmcnt(8)
  v_mfma_f32_16x16x32_bf16 v[48:51], v[132:135], v[208:211], v[48:51]
  ds_read_b128 v[112:115], v10 offset:40960
  v_mfma_f32_16x16x32_bf16 v[76:79], v[132:135], v[212:215], v[76:79]
  ds_read_b128 v[116:119], v10 offset:41984
  buffer_load_dwordx4 v[200:203], v4, s[20:23], s10 offen offset:0 sc1
  s_waitcnt lgkmcnt(9)
  v_mfma_f32_16x16x32_bf16 v[52:55], v[136:139], v[208:211], v[52:55]
  ds_read_b128 v[120:123], v10 offset:43008
  v_lshlrev_b32 v217, 16, v217
  v_mfma_f32_16x16x32_bf16 v[80:83], v[136:139], v[212:215], v[80:83]
  buffer_load_dwordx4 v[204:207], v4, s[20:23], s10 offen offset:1024 sc1
  s_add_u32 s10, s10, 0x20000
  s_waitcnt lgkmcnt(9)
  v_mfma_f32_16x16x32_bf16 v[56:59], v[140:143], v[208:211], v[56:59]
  v_mfma_f32_16x16x32_bf16 v[84:87], v[140:143], v[212:215], v[84:87]
  s_waitcnt lgkmcnt(8)
  v_mfma_f32_16x16x32_bf16 v[60:63], v[144:147], v[208:211], v[60:63]
  v_rcp_f32 v217, v217
  v_mfma_f32_16x16x32_bf16 v[88:91], v[144:147], v[212:215], v[88:91]
  s_waitcnt lgkmcnt(7)
  v_mfma_f32_16x16x32_bf16 v[64:67], v[148:151], v[208:211], v[64:67]
  v_mfma_f32_16x16x32_bf16 v[92:95], v[148:151], v[212:215], v[92:95]
  v_rcp_f32 v228, v217
  s_barrier
  s_waitcnt vmcnt(13) lgkmcnt(6)
  v_mfma_f32_16x16x32_bf16 v[40:43], v[96:99], v[152:155], v[40:43]
  ds_read_b128 v[124:127], v10 offset:44032
  s_waitcnt vmcnt(12)
  v_mfma_f32_16x16x32_bf16 v[68:71], v[96:99], v[156:159], v[68:71]
  ds_read_b128 v[128:131], v10 offset:45056
  s_waitcnt lgkmcnt(7)
  v_mfma_f32_16x16x32_bf16 v[44:47], v[100:103], v[152:155], v[44:47]
  ds_read_b128 v[132:135], v10 offset:46080
  v_mfma_f32_16x16x32_bf16 v[72:75], v[100:103], v[156:159], v[72:75]
  ds_read_b128 v[136:139], v10 offset:47104
  v_mul_f32 v226, 0xc0135761, v217
  s_waitcnt lgkmcnt(8)
  v_mfma_f32_16x16x32_bf16 v[48:51], v[104:107], v[152:155], v[48:51]
  ds_read_b128 v[140:143], v10 offset:48128
  v_mfma_f32_16x16x32_bf16 v[76:79], v[104:107], v[156:159], v[76:79]
  ds_read_b128 v[144:147], v10 offset:49152
  buffer_load_dwordx4 v[208:211], v4, s[20:23], s10 offen offset:0 sc1
  s_waitcnt lgkmcnt(9)
  v_mfma_f32_16x16x32_bf16 v[52:55], v[108:111], v[152:155], v[52:55]
  ds_read_b128 v[148:151], v10 offset:50176
  v_mul_f32 v224, v217, v217
  v_mfma_f32_16x16x32_bf16 v[80:83], v[108:111], v[156:159], v[80:83]
  buffer_load_dwordx4 v[212:215], v4, s[20:23], s10 offen offset:1024 sc1
  s_add_u32 s10, s10, 0x20000
  s_waitcnt lgkmcnt(9)
  v_mfma_f32_16x16x32_bf16 v[56:59], v[112:115], v[152:155], v[56:59]
  v_mfma_f32_16x16x32_bf16 v[84:87], v[112:115], v[156:159], v[84:87]
  s_waitcnt lgkmcnt(8)
  v_mfma_f32_16x16x32_bf16 v[60:63], v[116:119], v[152:155], v[60:63]
  v_mul_f32 v224, v224, v226
  v_mfma_f32_16x16x32_bf16 v[88:91], v[116:119], v[156:159], v[88:91]
  s_waitcnt lgkmcnt(7)
  v_mfma_f32_16x16x32_bf16 v[64:67], v[120:123], v[152:155], v[64:67]
  v_mfma_f32_16x16x32_bf16 v[92:95], v[120:123], v[156:159], v[92:95]
  v_mul_f32 v224, 0x3d372713, v224
  s_waitcnt vmcnt(13) lgkmcnt(6)
  v_mfma_f32_16x16x32_bf16 v[40:43], v[124:127], v[160:163], v[40:43]
  ds_read_b128 v[96:99], v10 offset:51200
  s_waitcnt vmcnt(12)
  v_mfma_f32_16x16x32_bf16 v[68:71], v[124:127], v[164:167], v[68:71]
  ds_read_b128 v[100:103], v10 offset:52224
  s_waitcnt lgkmcnt(7)
  v_mfma_f32_16x16x32_bf16 v[44:47], v[128:131], v[160:163], v[44:47]
  ds_read_b128 v[104:107], v10 offset:53248
  v_mfma_f32_16x16x32_bf16 v[72:75], v[128:131], v[164:167], v[72:75]
  ds_read_b128 v[108:111], v10 offset:54272
  v_add_f32 v220, v220, v222
  s_waitcnt lgkmcnt(8)
  v_mfma_f32_16x16x32_bf16 v[48:51], v[132:135], v[160:163], v[48:51]
  ds_read_b128 v[112:115], v10 offset:55296
  v_mfma_f32_16x16x32_bf16 v[76:79], v[132:135], v[164:167], v[76:79]
  ds_read_b128 v[116:119], v10 offset:56320
  buffer_load_dwordx4 v[152:155], v4, s[20:23], s10 offen offset:0 sc1
  s_waitcnt lgkmcnt(9)
  v_mfma_f32_16x16x32_bf16 v[52:55], v[136:139], v[160:163], v[52:55]
  ds_read_b128 v[120:123], v10 offset:57344
  v_add_f32 v221, v221, v223
  v_mfma_f32_16x16x32_bf16 v[80:83], v[136:139], v[164:167], v[80:83]
  buffer_load_dwordx4 v[156:159], v4, s[20:23], s10 offen offset:1024 sc1
  s_add_u32 s10, s10, 0x20000
  s_waitcnt lgkmcnt(9)
  v_mfma_f32_16x16x32_bf16 v[56:59], v[140:143], v[160:163], v[56:59]
  v_mfma_f32_16x16x32_bf16 v[84:87], v[140:143], v[164:167], v[84:87]
  s_waitcnt lgkmcnt(8)
  v_mfma_f32_16x16x32_bf16 v[60:63], v[144:147], v[160:163], v[60:63]
  v_permlane32_swap_b32 v220, v221
  v_mfma_f32_16x16x32_bf16 v[88:91], v[144:147], v[164:167], v[88:91]
  s_waitcnt lgkmcnt(7)
  v_mfma_f32_16x16x32_bf16 v[64:67], v[148:151], v[160:163], v[64:67]
  v_mfma_f32_16x16x32_bf16 v[92:95], v[148:151], v[164:167], v[92:95]
  v_add_f32 v220, v220, v221
  s_barrier
  s_waitcnt vmcnt(13) lgkmcnt(6)
  v_mfma_f32_16x16x32_bf16 v[40:43], v[96:99], v[168:171], v[40:43]
  ds_read_b128 v[124:127], v10 offset:58368
  s_waitcnt vmcnt(12)
  v_mfma_f32_16x16x32_bf16 v[68:71], v[96:99], v[172:175], v[68:71]
  ds_read_b128 v[128:131], v10 offset:59392
  s_waitcnt lgkmcnt(7)
  v_mfma_f32_16x16x32_bf16 v[44:47], v[100:103], v[168:171], v[44:47]
  ds_read_b128 v[132:135], v10 offset:60416
  v_mfma_f32_16x16x32_bf16 v[72:75], v[100:103], v[172:175], v[72:75]
  ds_read_b128 v[136:139], v10 offset:61440
  s_waitcnt lgkmcnt(8)
  v_mfma_f32_16x16x32_bf16 v[48:51], v[104:107], v[168:171], v[48:51]
  ds_read_b128 v[140:143], v10 offset:62464
  v_mov_b32 v221, v220
  v_mfma_f32_16x16x32_bf16 v[76:79], v[104:107], v[172:175], v[76:79]
  ds_read_b128 v[144:147], v10 offset:63488
  buffer_load_dwordx4 v[160:163], v4, s[20:23], s10 offen offset:0 sc1
  s_waitcnt lgkmcnt(9)
  v_mfma_f32_16x16x32_bf16 v[52:55], v[108:111], v[168:171], v[52:55]
  ds_read_b128 v[148:151], v10 offset:64512
  v_mfma_f32_16x16x32_bf16 v[80:83], v[108:111], v[172:175], v[80:83]
  buffer_load_dwordx4 v[164:167], v4, s[20:23], s10 offen offset:1024 sc1
  s_add_u32 s10, s10, 0x20000
  s_waitcnt lgkmcnt(9)
  v_mfma_f32_16x16x32_bf16 v[56:59], v[112:115], v[168:171], v[56:59]
  v_mfma_f32_16x16x32_bf16 v[84:87], v[112:115], v[172:175], v[84:87]
  v_permlane16_swap_b32 v220, v221
  s_waitcnt lgkmcnt(8)
  v_mfma_f32_16x16x32_bf16 v[60:63], v[116:119], v[168:171], v[60:63]
  v_mfma_f32_16x16x32_bf16 v[88:91], v[116:119], v[172:175], v[88:91]
  s_waitcnt lgkmcnt(7)
  v_mfma_f32_16x16x32_bf16 v[64:67], v[120:123], v[168:171], v[64:67]
  v_mfma_f32_16x16x32_bf16 v[92:95], v[120:123], v[172:175], v[92:95]
  v_add_f32 v220, v220, v221
  s_waitcnt vmcnt(13) lgkmcnt(6)
  v_mfma_f32_16x16x32_bf16 v[40:43], v[124:127], v[176:179], v[40:43]
  ds_read_b128 v[96:99], v11 offset:0
  s_waitcnt vmcnt(12)
  v_mfma_f32_16x16x32_bf16 v[68:71], v[124:127], v[180:183], v[68:71]
  ds_read_b128 v[100:103], v11 offset:1024
  s_waitcnt lgkmcnt(7)
  v_mfma_f32_16x16x32_bf16 v[44:47], v[128:131], v[176:179], v[44:47]
  ds_read_b128 v[104:107], v11 offset:2048
  v_mfma_f32_16x16x32_bf16 v[72:75], v[128:131], v[180:183], v[72:75]
  ds_read_b128 v[108:111], v11 offset:3072
  s_waitcnt lgkmcnt(8)
  v_mfma_f32_16x16x32_bf16 v[48:51], v[132:135], v[176:179], v[48:51]
  ds_read_b128 v[112:115], v11 offset:4096
  v_mov_b32 v221, v220
  v_mfma_f32_16x16x32_bf16 v[76:79], v[132:135], v[180:183], v[76:79]
  ds_read_b128 v[116:119], v11 offset:5120
  buffer_load_dwordx4 v[168:171], v4, s[20:23], s10 offen offset:0 sc1
  s_waitcnt lgkmcnt(9)
  v_mfma_f32_16x16x32_bf16 v[52:55], v[136:139], v[176:179], v[52:55]
  ds_read_b128 v[120:123], v11 offset:6144
  v_mfma_f32_16x16x32_bf16 v[80:83], v[136:139], v[180:183], v[80:83]
  buffer_load_dwordx4 v[172:175], v4, s[20:23], s10 offen offset:1024 sc1
  s_add_u32 s10, s10, 0x20000
  s_waitcnt lgkmcnt(9)
  v_mfma_f32_16x16x32_bf16 v[56:59], v[140:143], v[176:179], v[56:59]
  v_mfma_f32_16x16x32_bf16 v[84:87], v[140:143], v[180:183], v[84:87]
  v_permlane32_swap_b32 v220, v221
  s_waitcnt lgkmcnt(8)
  v_mfma_f32_16x16x32_bf16 v[60:63], v[144:147], v[176:179], v[60:63]
  v_mfma_f32_16x16x32_bf16 v[88:91], v[144:147], v[180:183], v[88:91]
  s_waitcnt lgkmcnt(7)
  v_mfma_f32_16x16x32_bf16 v[64:67], v[148:151], v[176:179], v[64:67]
  v_mfma_f32_16x16x32_bf16 v[92:95], v[148:151], v[180:183], v[92:95]
  v_mul_f32 v220, 0x3acccccd, v220
  s_barrier
  s_waitcnt vmcnt(13) lgkmcnt(6)
  v_mfma_f32_16x16x32_bf16 v[40:43], v[96:99], v[184:187], v[40:43]
  ds_read_b128 v[124:127], v11 offset:7168
  s_waitcnt vmcnt(12)
  v_mfma_f32_16x16x32_bf16 v[68:71], v[96:99], v[188:191], v[68:71]
  ds_read_b128 v[128:131], v11 offset:8192
  s_waitcnt lgkmcnt(7)
  v_mfma_f32_16x16x32_bf16 v[44:47], v[100:103], v[184:187], v[44:47]
  ds_read_b128 v[132:135], v11 offset:9216
  v_mfma_f32_16x16x32_bf16 v[72:75], v[100:103], v[188:191], v[72:75]
  ds_read_b128 v[136:139], v11 offset:10240
  s_waitcnt lgkmcnt(8)
  v_mfma_f32_16x16x32_bf16 v[48:51], v[104:107], v[184:187], v[48:51]
  ds_read_b128 v[140:143], v11 offset:11264
  v_mul_f32 v221, 0x3acccccd, v221
  v_mfma_f32_16x16x32_bf16 v[76:79], v[104:107], v[188:191], v[76:79]
  ds_read_b128 v[144:147], v11 offset:12288
  buffer_load_dwordx4 v[176:179], v4, s[20:23], s10 offen offset:0 sc1
  s_waitcnt lgkmcnt(9)
  v_mfma_f32_16x16x32_bf16 v[52:55], v[108:111], v[184:187], v[52:55]
  ds_read_b128 v[148:151], v11 offset:13312
  v_mfma_f32_16x16x32_bf16 v[80:83], v[108:111], v[188:191], v[80:83]
  buffer_load_dwordx4 v[180:183], v4, s[20:23], s10 offen offset:1024 sc1
  s_waitcnt lgkmcnt(9)
  v_mfma_f32_16x16x32_bf16 v[56:59], v[112:115], v[184:187], v[56:59]
  v_mfma_f32_16x16x32_bf16 v[84:87], v[112:115], v[188:191], v[84:87]
  v_fma_f32 v221, -v220, v220, v221
  s_waitcnt lgkmcnt(8)
  v_mfma_f32_16x16x32_bf16 v[60:63], v[116:119], v[184:187], v[60:63]
  v_mfma_f32_16x16x32_bf16 v[88:91], v[116:119], v[188:191], v[88:91]
  s_waitcnt lgkmcnt(7)
  v_mfma_f32_16x16x32_bf16 v[64:67], v[120:123], v[184:187], v[64:67]
  v_mfma_f32_16x16x32_bf16 v[92:95], v[120:123], v[188:191], v[92:95]
  v_max_f32 v221, 0, v221
  s_waitcnt vmcnt(13) lgkmcnt(6)
  v_mfma_f32_16x16x32_bf16 v[40:43], v[124:127], v[192:195], v[40:43]
  ds_read_b128 v[96:99], v11 offset:14336
  s_waitcnt vmcnt(12)
  v_mfma_f32_16x16x32_bf16 v[68:71], v[124:127], v[196:199], v[68:71]
  ds_read_b128 v[100:103], v11 offset:15360
  s_waitcnt lgkmcnt(7)
  v_mfma_f32_16x16x32_bf16 v[44:47], v[128:131], v[192:195], v[44:47]
  ds_read_b128 v[104:107], v11 offset:16384
  v_mfma_f32_16x16x32_bf16 v[72:75], v[128:131], v[196:199], v[72:75]
  ds_read_b128 v[108:111], v11 offset:17408
  s_waitcnt lgkmcnt(8)
  v_mfma_f32_16x16x32_bf16 v[48:51], v[132:135], v[192:195], v[48:51]
  ds_read_b128 v[112:115], v11 offset:18432
  v_cvt_pk_bf16_f32 v222, v220, v221
  v_mfma_f32_16x16x32_bf16 v[76:79], v[132:135], v[196:199], v[76:79]
  ds_read_b128 v[116:119], v11 offset:19456
  ds_read_b128 v[184:187], v12 offset:0
  s_waitcnt lgkmcnt(10)
  v_mfma_f32_16x16x32_bf16 v[52:55], v[136:139], v[192:195], v[52:55]
  ds_read_b128 v[120:123], v11 offset:20480
  v_mfma_f32_16x16x32_bf16 v[80:83], v[136:139], v[196:199], v[80:83]
  ds_read_b128 v[188:191], v12 offset:16
  s_waitcnt lgkmcnt(11)
  v_mfma_f32_16x16x32_bf16 v[56:59], v[140:143], v[192:195], v[56:59]
  v_mfma_f32_16x16x32_bf16 v[84:87], v[140:143], v[196:199], v[84:87]
  v_lshlrev_b32 v220, 16, v222
  s_waitcnt lgkmcnt(10)
  v_mfma_f32_16x16x32_bf16 v[60:63], v[144:147], v[192:195], v[60:63]
  v_mfma_f32_16x16x32_bf16 v[88:91], v[144:147], v[196:199], v[88:91]
  s_waitcnt lgkmcnt(9)
  v_mfma_f32_16x16x32_bf16 v[64:67], v[148:151], v[192:195], v[64:67]
  v_mfma_f32_16x16x32_bf16 v[92:95], v[148:151], v[196:199], v[92:95]
  v_and_b32 v221, 0xffff0000, v222
  s_barrier
  s_waitcnt vmcnt(11) lgkmcnt(8)
  v_mfma_f32_16x16x32_bf16 v[40:43], v[96:99], v[200:203], v[40:43]
  ds_read_b128 v[124:127], v11 offset:21504
  s_waitcnt vmcnt(10)
  v_mfma_f32_16x16x32_bf16 v[68:71], v[96:99], v[204:207], v[68:71]
  ds_read_b128 v[128:131], v11 offset:22528
  s_waitcnt lgkmcnt(9)
  v_mfma_f32_16x16x32_bf16 v[44:47], v[100:103], v[200:203], v[44:47]
  ds_read_b128 v[132:135], v11 offset:23552
  v_mfma_f32_16x16x32_bf16 v[72:75], v[100:103], v[204:207], v[72:75]
  ds_read_b128 v[136:139], v11 offset:24576
  s_waitcnt lgkmcnt(10)
  v_mfma_f32_16x16x32_bf16 v[48:51], v[104:107], v[200:203], v[48:51]
  ds_read_b128 v[140:143], v11 offset:25600
  v_add_f32 v221, 0x3727c5ac, v221
  v_mfma_f32_16x16x32_bf16 v[76:79], v[104:107], v[204:207], v[76:79]
  ds_read_b128 v[144:147], v11 offset:26624
  ds_read_b128 v[192:195], v12 offset:128
  s_waitcnt lgkmcnt(12)
  v_mfma_f32_16x16x32_bf16 v[52:55], v[108:111], v[200:203], v[52:55]
  ds_read_b128 v[148:151], v11 offset:27648
  v_mfma_f32_16x16x32_bf16 v[80:83], v[108:111], v[204:207], v[80:83]
  ds_read_b128 v[196:199], v12 offset:144
  s_waitcnt lgkmcnt(13)
  v_mfma_f32_16x16x32_bf16 v[56:59], v[112:115], v[200:203], v[56:59]
  v_mfma_f32_16x16x32_bf16 v[84:87], v[112:115], v[204:207], v[84:87]
  v_cvt_pk_bf16_f32 v221, v221, v221
  s_waitcnt lgkmcnt(12)
  v_mfma_f32_16x16x32_bf16 v[60:63], v[116:119], v[200:203], v[60:63]
  v_mfma_f32_16x16x32_bf16 v[88:91], v[116:119], v[204:207], v[88:91]
  s_waitcnt lgkmcnt(10)
  v_mfma_f32_16x16x32_bf16 v[64:67], v[120:123], v[200:203], v[64:67]
  v_mfma_f32_16x16x32_bf16 v[92:95], v[120:123], v[204:207], v[92:95]
  v_lshlrev_b32 v221, 16, v221
  s_waitcnt vmcnt(9) lgkmcnt(8)
  v_mfma_f32_16x16x32_bf16 v[40:43], v[124:127], v[208:211], v[40:43]
  ds_read_b128 v[96:99], v4 offset:0
  s_waitcnt vmcnt(8)
  v_mfma_f32_16x16x32_bf16 v[68:71], v[124:127], v[212:215], v[68:71]
  ds_read_b128 v[100:103], v4 offset:1024
  s_waitcnt lgkmcnt(9)
  v_mfma_f32_16x16x32_bf16 v[44:47], v[128:131], v[208:211], v[44:47]
  ds_read_b128 v[104:107], v4 offset:2048
  v_mfma_f32_16x16x32_bf16 v[72:75], v[128:131], v[212:215], v[72:75]
  ds_read_b128 v[108:111], v4 offset:3072
  s_waitcnt lgkmcnt(10)
  v_mfma_f32_16x16x32_bf16 v[48:51], v[132:135], v[208:211], v[48:51]
  ds_read_b128 v[112:115], v4 offset:4096
  v_sqrt_f32 v221, v221
  v_mfma_f32_16x16x32_bf16 v[76:79], v[132:135], v[212:215], v[76:79]
  ds_read_b128 v[116:119], v4 offset:5120
  ds_read_b128 v[200:203], v12 offset:256
  s_waitcnt lgkmcnt(12)
  v_mfma_f32_16x16x32_bf16 v[52:55], v[136:139], v[208:211], v[52:55]
  ds_read_b128 v[120:123], v4 offset:6144
  v_mfma_f32_16x16x32_bf16 v[80:83], v[136:139], v[212:215], v[80:83]
  ds_read_b128 v[204:207], v12 offset:272
  s_waitcnt lgkmcnt(13)
  v_mfma_f32_16x16x32_bf16 v[56:59], v[140:143], v[208:211], v[56:59]
  v_mfma_f32_16x16x32_bf16 v[84:87], v[140:143], v[212:215], v[84:87]
  v_cvt_pk_bf16_f32 v221, v221, v221
  s_waitcnt lgkmcnt(12)
  v_mfma_f32_16x16x32_bf16 v[60:63], v[144:147], v[208:211], v[60:63]
  v_mfma_f32_16x16x32_bf16 v[88:91], v[144:147], v[212:215], v[88:91]
  s_waitcnt lgkmcnt(10)
  v_mfma_f32_16x16x32_bf16 v[64:67], v[148:151], v[208:211], v[64:67]
  v_mfma_f32_16x16x32_bf16 v[92:95], v[148:151], v[212:215], v[92:95]
  v_lshlrev_b32 v221, 16, v221
  s_barrier
  s_waitcnt vmcnt(7) lgkmcnt(8)
  v_mfma_f32_16x16x32_bf16 v[40:43], v[96:99], v[152:155], v[40:43]
  ds_read_b128 v[124:127], v4 offset:7168
  s_waitcnt vmcnt(6)
  v_mfma_f32_16x16x32_bf16 v[68:71], v[96:99], v[156:159], v[68:71]
  ds_read_b128 v[128:131], v4 offset:8192
  s_waitcnt lgkmcnt(9)
  v_mfma_f32_16x16x32_bf16 v[44:47], v[100:103], v[152:155], v[44:47]
  ds_read_b128 v[132:135], v4 offset:9216
  v_mfma_f32_16x16x32_bf16 v[72:75], v[100:103], v[156:159], v[72:75]
  ds_read_b128 v[136:139], v4 offset:10240
  s_waitcnt lgkmcnt(10)
  v_mfma_f32_16x16x32_bf16 v[48:51], v[104:107], v[152:155], v[48:51]
  ds_read_b128 v[140:143], v4 offset:11264
  v_rcp_f32 v221, v221
  v_mfma_f32_16x16x32_bf16 v[76:79], v[104:107], v[156:159], v[76:79]
  ds_read_b128 v[144:147], v4 offset:12288
  ds_read_b128 v[208:211], v14 offset:0
  s_waitcnt lgkmcnt(12)
  v_mfma_f32_16x16x32_bf16 v[52:55], v[108:111], v[152:155], v[52:55]
  ds_read_b128 v[148:151], v4 offset:13312
  v_mfma_f32_16x16x32_bf16 v[80:83], v[108:111], v[156:159], v[80:83]
  s_waitcnt lgkmcnt(12)
  v_mfma_f32_16x16x32_bf16 v[56:59], v[112:115], v[152:155], v[56:59]
  v_mfma_f32_16x16x32_bf16 v[84:87], v[112:115], v[156:159], v[84:87]
  v_rcp_f32 v234, v221
  s_waitcnt lgkmcnt(11)
  v_mfma_f32_16x16x32_bf16 v[60:63], v[116:119], v[152:155], v[60:63]
  v_mfma_f32_16x16x32_bf16 v[88:91], v[116:119], v[156:159], v[88:91]
  s_waitcnt lgkmcnt(9)
  v_mfma_f32_16x16x32_bf16 v[64:67], v[120:123], v[152:155], v[64:67]
  v_mfma_f32_16x16x32_bf16 v[92:95], v[120:123], v[156:159], v[92:95]
  v_mul_f32 v232, 0xc0135761, v221
  s_waitcnt vmcnt(5) lgkmcnt(7)
  v_mfma_f32_16x16x32_bf16 v[40:43], v[124:127], v[160:163], v[40:43]
  ds_read_b128 v[96:99], v4 offset:14336
  s_waitcnt vmcnt(4)
  v_mfma_f32_16x16x32_bf16 v[68:71], v[124:127], v[164:167], v[68:71]
  ds_read_b128 v[100:103], v4 offset:15360
  s_waitcnt lgkmcnt(8)
  v_mfma_f32_16x16x32_bf16 v[44:47], v[128:131], v[160:163], v[44:47]
  ds_read_b128 v[104:107], v4 offset:16384
  v_mfma_f32_16x16x32_bf16 v[72:75], v[128:131], v[164:167], v[72:75]
  ds_read_b128 v[108:111], v4 offset:17408
  s_waitcnt lgkmcnt(9)
  v_mfma_f32_16x16x32_bf16 v[48:51], v[132:135], v[160:163], v[48:51]
  ds_read_b128 v[112:115], v4 offset:18432
  v_mul_f32 v230, v221, v221
  v_mfma_f32_16x16x32_bf16 v[76:79], v[132:135], v[164:167], v[76:79]
  ds_read_b128 v[116:119], v4 offset:19456
  s_waitcnt lgkmcnt(10)
  v_mfma_f32_16x16x32_bf16 v[52:55], v[136:139], v[160:163], v[52:55]
  ds_read_b128 v[120:123], v4 offset:20480
  v_mfma_f32_16x16x32_bf16 v[80:83], v[136:139], v[164:167], v[80:83]
  s_waitcnt lgkmcnt(10)
  v_mfma_f32_16x16x32_bf16 v[56:59], v[140:143], v[160:163], v[56:59]
  v_mfma_f32_16x16x32_bf16 v[84:87], v[140:143], v[164:167], v[84:87]
  v_mul_f32 v230, v230, v232
  s_waitcnt lgkmcnt(9)
  v_mfma_f32_16x16x32_bf16 v[60:63], v[144:147], v[160:163], v[60:63]
  v_mfma_f32_16x16x32_bf16 v[88:91], v[144:147], v[164:167], v[88:91]
  s_waitcnt lgkmcnt(7)
  v_mfma_f32_16x16x32_bf16 v[64:67], v[148:151], v[160:163], v[64:67]
  v_mfma_f32_16x16x32_bf16 v[92:95], v[148:151], v[164:167], v[92:95]
  v_mul_f32 v230, 0x3d372713, v230
  s_barrier
  s_waitcnt vmcnt(3) lgkmcnt(6)
  v_mfma_f32_16x16x32_bf16 v[40:43], v[96:99], v[168:171], v[40:43]
  ds_read_b128 v[124:127], v4 offset:21504
  s_waitcnt vmcnt(2)
  v_mfma_f32_16x16x32_bf16 v[68:71], v[96:99], v[172:175], v[68:71]
  ds_read_b128 v[128:131], v4 offset:22528
  s_waitcnt lgkmcnt(7)
  v_mfma_f32_16x16x32_bf16 v[44:47], v[100:103], v[168:171], v[44:47]
  ds_read_b128 v[132:135], v4 offset:23552
  s_nop 0
  v_pk_fma_f32 v[40:41], v[184:185], v[216:217], v[40:41] op_sel_hi:[1,0,1] neg_lo:[1,0,0] neg_hi:[1,0,0]
  v_pk_fma_f32 v[42:43], v[186:187], v[216:217], v[42:43] op_sel_hi:[1,0,1] neg_lo:[1,0,0] neg_hi:[1,0,0]
  v_mfma_f32_16x16x32_bf16 v[72:75], v[100:103], v[172:175], v[72:75]
  ds_read_b128 v[136:139], v4 offset:24576
  v_pk_fma_f32 v[68:69], v[184:185], v[220:221], v[68:69] op_sel_hi:[1,0,1] neg_lo:[1,0,0] neg_hi:[1,0,0]
  v_pk_fma_f32 v[70:71], v[186:187], v[220:221], v[70:71] op_sel_hi:[1,0,1] neg_lo:[1,0,0] neg_hi:[1,0,0]
  s_waitcnt lgkmcnt(8)
  v_mfma_f32_16x16x32_bf16 v[48:51], v[104:107], v[168:171], v[48:51]
  ds_read_b128 v[140:143], v4 offset:25600
  v_pk_fma_f32 v[44:45], v[188:189], v[216:217], v[44:45] op_sel_hi:[1,0,1] neg_lo:[1,0,0] neg_hi:[1,0,0]
  v_pk_fma_f32 v[46:47], v[190:191], v[216:217], v[46:47] op_sel_hi:[1,0,1] neg_lo:[1,0,0] neg_hi:[1,0,0]
  v_mfma_f32_16x16x32_bf16 v[76:79], v[104:107], v[172:175], v[76:79]
  ds_read_b128 v[144:147], v4 offset:26624
  v_pk_fma_f32 v[72:73], v[188:189], v[220:221], v[72:73] op_sel_hi:[1,0,1] neg_lo:[1,0,0] neg_hi:[1,0,0]
  v_pk_fma_f32 v[74:75], v[190:191], v[220:221], v[74:75] op_sel_hi:[1,0,1] neg_lo:[1,0,0] neg_hi:[1,0,0]
  s_waitcnt lgkmcnt(9)
  v_mfma_f32_16x16x32_bf16 v[52:55], v[108:111], v[168:171], v[52:55]
  ds_read_b128 v[148:151], v4 offset:27648
  v_pk_fma_f32 v[48:49], v[192:193], v[216:217], v[48:49] op_sel_hi:[1,0,1] neg_lo:[1,0,0] neg_hi:[1,0,0]
  v_pk_fma_f32 v[50:51], v[194:195], v[216:217], v[50:51] op_sel_hi:[1,0,1] neg_lo:[1,0,0] neg_hi:[1,0,0]
  v_mfma_f32_16x16x32_bf16 v[80:83], v[108:111], v[172:175], v[80:83]
  v_pk_fma_f32 v[76:77], v[192:193], v[220:221], v[76:77] op_sel_hi:[1,0,1] neg_lo:[1,0,0] neg_hi:[1,0,0]
  v_pk_fma_f32 v[78:79], v[194:195], v[220:221], v[78:79] op_sel_hi:[1,0,1] neg_lo:[1,0,0] neg_hi:[1,0,0]
  s_waitcnt lgkmcnt(9)
  v_mfma_f32_16x16x32_bf16 v[56:59], v[112:115], v[168:171], v[56:59]
  v_pk_fma_f32 v[52:53], v[196:197], v[216:217], v[52:53] op_sel_hi:[1,0,1] neg_lo:[1,0,0] neg_hi:[1,0,0]
  v_pk_fma_f32 v[54:55], v[198:199], v[216:217], v[54:55] op_sel_hi:[1,0,1] neg_lo:[1,0,0] neg_hi:[1,0,0]
  v_mfma_f32_16x16x32_bf16 v[84:87], v[112:115], v[172:175], v[84:87]
  s_nop 0
  v_pk_fma_f32 v[80:81], v[196:197], v[220:221], v[80:81] op_sel_hi:[1,0,1] neg_lo:[1,0,0] neg_hi:[1,0,0]
  v_pk_fma_f32 v[82:83], v[198:199], v[220:221], v[82:83] op_sel_hi:[1,0,1] neg_lo:[1,0,0] neg_hi:[1,0,0]
  s_waitcnt lgkmcnt(8)
  v_mfma_f32_16x16x32_bf16 v[60:63], v[116:119], v[168:171], v[60:63]
  v_pk_fma_f32 v[56:57], v[200:201], v[216:217], v[56:57] op_sel_hi:[1,0,1] neg_lo:[1,0,0] neg_hi:[1,0,0]
  v_pk_fma_f32 v[58:59], v[202:203], v[216:217], v[58:59] op_sel_hi:[1,0,1] neg_lo:[1,0,0] neg_hi:[1,0,0]
  v_mfma_f32_16x16x32_bf16 v[88:91], v[116:119], v[172:175], v[88:91]
  v_pk_fma_f32 v[84:85], v[200:201], v[220:221], v[84:85] op_sel_hi:[1,0,1] neg_lo:[1,0,0] neg_hi:[1,0,0]
  v_pk_fma_f32 v[86:87], v[202:203], v[220:221], v[86:87] op_sel_hi:[1,0,1] neg_lo:[1,0,0] neg_hi:[1,0,0]
  s_waitcnt lgkmcnt(7)
  v_mfma_f32_16x16x32_bf16 v[64:67], v[120:123], v[168:171], v[64:67]
  s_nop 0
  v_pk_fma_f32 v[60:61], v[204:205], v[216:217], v[60:61] op_sel_hi:[1,0,1] neg_lo:[1,0,0] neg_hi:[1,0,0]
  v_pk_fma_f32 v[62:63], v[206:207], v[216:217], v[62:63] op_sel_hi:[1,0,1] neg_lo:[1,0,0] neg_hi:[1,0,0]
  v_mfma_f32_16x16x32_bf16 v[92:95], v[120:123], v[172:175], v[92:95]
  v_pk_fma_f32 v[88:89], v[204:205], v[220:221], v[88:89] op_sel_hi:[1,0,1] neg_lo:[1,0,0] neg_hi:[1,0,0]
  v_pk_fma_f32 v[90:91], v[206:207], v[220:221], v[90:91] op_sel_hi:[1,0,1] neg_lo:[1,0,0] neg_hi:[1,0,0]
  s_waitcnt vmcnt(1) lgkmcnt(6)
  v_mfma_f32_16x16x32_bf16 v[40:43], v[124:127], v[176:179], v[40:43]
  v_pk_fma_f32 v[64:65], v[208:209], v[216:217], v[64:65] op_sel_hi:[1,0,1] neg_lo:[1,0,0] neg_hi:[1,0,0]
  v_pk_fma_f32 v[66:67], v[210:211], v[216:217], v[66:67] op_sel_hi:[1,0,1] neg_lo:[1,0,0] neg_hi:[1,0,0]
  s_waitcnt vmcnt(0)
  v_mfma_f32_16x16x32_bf16 v[68:71], v[124:127], v[180:183], v[68:71]
  v_pk_fma_f32 v[92:93], v[208:209], v[220:221], v[92:93] op_sel_hi:[1,0,1] neg_lo:[1,0,0] neg_hi:[1,0,0]
  v_pk_fma_f32 v[94:95], v[210:211], v[220:221], v[94:95] op_sel_hi:[1,0,1] neg_lo:[1,0,0] neg_hi:[1,0,0]
  s_waitcnt lgkmcnt(5)
  v_mfma_f32_16x16x32_bf16 v[44:47], v[128:131], v[176:179], v[44:47]
  v_mfma_f32_16x16x32_bf16 v[72:75], v[128:131], v[180:183], v[72:75]
  s_waitcnt lgkmcnt(4)
  v_mfma_f32_16x16x32_bf16 v[48:51], v[132:135], v[176:179], v[48:51]
  v_mfma_f32_16x16x32_bf16 v[76:79], v[132:135], v[180:183], v[76:79]
  s_waitcnt lgkmcnt(3)
  v_mfma_f32_16x16x32_bf16 v[52:55], v[136:139], v[176:179], v[52:55]
  v_mfma_f32_16x16x32_bf16 v[80:83], v[136:139], v[180:183], v[80:83]
  s_waitcnt lgkmcnt(2)
  v_mfma_f32_16x16x32_bf16 v[56:59], v[140:143], v[176:179], v[56:59]
  v_mfma_f32_16x16x32_bf16 v[84:87], v[140:143], v[180:183], v[84:87]
  s_waitcnt lgkmcnt(1)
  v_mfma_f32_16x16x32_bf16 v[60:63], v[144:147], v[176:179], v[60:63]
  v_mfma_f32_16x16x32_bf16 v[88:91], v[144:147], v[180:183], v[88:91]
  s_waitcnt lgkmcnt(0)
  v_mfma_f32_16x16x32_bf16 v[64:67], v[148:151], v[176:179], v[64:67]
  v_mfma_f32_16x16x32_bf16 v[92:95], v[148:151], v[180:183], v[92:95]
  s_barrier
  v_pk_mul_f32 v[124:125], v[40:41], v[40:41]
  v_pk_mul_f32 v[126:127], v[42:43], v[42:43]
  v_pk_mul_f32 v[128:129], v[44:45], v[44:45]
  v_pk_mul_f32 v[130:131], v[46:47], v[46:47]
  v_pk_fma_f32 v[124:125], v[124:125], v[224:225], v[226:227] op_sel_hi:[1,0,0]
  v_pk_fma_f32 v[126:127], v[126:127], v[224:225], v[226:227] op_sel_hi:[1,0,0]
  v_pk_fma_f32 v[128:129], v[128:129], v[224:225], v[226:227] op_sel_hi:[1,0,0]
  v_pk_fma_f32 v[130:131], v[130:131], v[224:225], v[226:227] op_sel_hi:[1,0,0]
  v_pk_mul_f32 v[124:125], v[124:125], v[40:41]
  v_pk_mul_f32 v[126:127], v[126:127], v[42:43]
  v_pk_mul_f32 v[128:129], v[128:129], v[44:45]
  v_pk_mul_f32 v[130:131], v[130:131], v[46:47]
  v_exp_f32 v124, v124
  v_exp_f32 v125, v125
  v_exp_f32 v126, v126
  v_exp_f32 v127, v127
  v_exp_f32 v128, v128
  v_exp_f32 v129, v129
  v_exp_f32 v130, v130
  v_exp_f32 v131, v131
  v_pk_fma_f32 v[124:125], v[124:125], v[228:229], v[228:229] op_sel_hi:[1,0,0]
  v_pk_fma_f32 v[126:127], v[126:127], v[228:229], v[228:229] op_sel_hi:[1,0,0]
  v_pk_fma_f32 v[128:129], v[128:129], v[228:229], v[228:229] op_sel_hi:[1,0,0]
  v_pk_fma_f32 v[130:131], v[130:131], v[228:229], v[228:229] op_sel_hi:[1,0,0]
  v_rcp_f32 v124, v124
  v_rcp_f32 v125, v125
  v_rcp_f32 v126, v126
  v_rcp_f32 v127, v127
  v_rcp_f32 v128, v128
  v_rcp_f32 v129, v129
  v_rcp_f32 v130, v130
  v_rcp_f32 v131, v131
  v_pk_mul_f32 v[40:41], v[40:41], v[124:125]
  v_pk_mul_f32 v[42:43], v[42:43], v[126:127]
  v_pk_mul_f32 v[44:45], v[44:45], v[128:129]
  v_pk_mul_f32 v[46:47], v[46:47], v[130:131]
  v_cvt_pk_bf16_f32 v152, v40, v41
  v_cvt_pk_bf16_f32 v153, v42, v43
  v_cvt_pk_bf16_f32 v154, v44, v45
  v_cvt_pk_bf16_f32 v155, v46, v47
  buffer_store_dwordx4 v[152:155], v4, s[24:27], s42 offen offset:0 sc1
  v_pk_mul_f32 v[132:133], v[48:49], v[48:49]
  v_pk_mul_f32 v[134:135], v[50:51], v[50:51]
  v_pk_mul_f32 v[136:137], v[52:53], v[52:53]
  v_pk_mul_f32 v[138:139], v[54:55], v[54:55]
  v_pk_fma_f32 v[132:133], v[132:133], v[224:225], v[226:227] op_sel_hi:[1,0,0]
  v_pk_fma_f32 v[134:135], v[134:135], v[224:225], v[226:227] op_sel_hi:[1,0,0]
  v_pk_fma_f32 v[136:137], v[136:137], v[224:225], v[226:227] op_sel_hi:[1,0,0]
  v_pk_fma_f32 v[138:139], v[138:139], v[224:225], v[226:227] op_sel_hi:[1,0,0]
  v_pk_mul_f32 v[132:133], v[132:133], v[48:49]
  v_pk_mul_f32 v[134:135], v[134:135], v[50:51]
  v_pk_mul_f32 v[136:137], v[136:137], v[52:53]
  v_pk_mul_f32 v[138:139], v[138:139], v[54:55]
  v_exp_f32 v132, v132
  v_exp_f32 v133, v133
  v_exp_f32 v134, v134
  v_exp_f32 v135, v135
  v_exp_f32 v136, v136
  v_exp_f32 v137, v137
  v_exp_f32 v138, v138
  v_exp_f32 v139, v139
  v_pk_fma_f32 v[132:133], v[132:133], v[228:229], v[228:229] op_sel_hi:[1,0,0]
  v_pk_fma_f32 v[134:135], v[134:135], v[228:229], v[228:229] op_sel_hi:[1,0,0]
  v_pk_fma_f32 v[136:137], v[136:137], v[228:229], v[228:229] op_sel_hi:[1,0,0]
  v_pk_fma_f32 v[138:139], v[138:139], v[228:229], v[228:229] op_sel_hi:[1,0,0]
  v_rcp_f32 v132, v132
  v_rcp_f32 v133, v133
  v_rcp_f32 v134, v134
  v_rcp_f32 v135, v135
  v_rcp_f32 v136, v136
  v_rcp_f32 v137, v137
  v_rcp_f32 v138, v138
  v_rcp_f32 v139, v139
  v_pk_mul_f32 v[48:49], v[48:49], v[132:133]
  v_pk_mul_f32 v[50:51], v[50:51], v[134:135]
  v_pk_mul_f32 v[52:53], v[52:53], v[136:137]
  v_pk_mul_f32 v[54:55], v[54:55], v[138:139]
  v_cvt_pk_bf16_f32 v156, v48, v49
  v_cvt_pk_bf16_f32 v157, v50, v51
  v_cvt_pk_bf16_f32 v158, v52, v53
  v_cvt_pk_bf16_f32 v159, v54, v55
  buffer_store_dwordx4 v[156:159], v4, s[24:27], s43 offen offset:0 sc1
  v_pk_mul_f32 v[124:125], v[56:57], v[56:57]
  v_pk_mul_f32 v[126:127], v[58:59], v[58:59]
  v_pk_mul_f32 v[128:129], v[60:61], v[60:61]
  v_pk_mul_f32 v[130:131], v[62:63], v[62:63]
  v_pk_fma_f32 v[124:125], v[124:125], v[224:225], v[226:227] op_sel_hi:[1,0,0]
  v_pk_fma_f32 v[126:127], v[126:127], v[224:225], v[226:227] op_sel_hi:[1,0,0]
  v_pk_fma_f32 v[128:129], v[128:129], v[224:225], v[226:227] op_sel_hi:[1,0,0]
  v_pk_fma_f32 v[130:131], v[130:131], v[224:225], v[226:227] op_sel_hi:[1,0,0]
  v_pk_mul_f32 v[124:125], v[124:125], v[56:57]
  v_pk_mul_f32 v[126:127], v[126:127], v[58:59]
  v_pk_mul_f32 v[128:129], v[128:129], v[60:61]
  v_pk_mul_f32 v[130:131], v[130:131], v[62:63]
  v_exp_f32 v124, v124
  v_exp_f32 v125, v125
  v_exp_f32 v126, v126
  v_exp_f32 v127, v127
  v_exp_f32 v128, v128
  v_exp_f32 v129, v129
  v_exp_f32 v130, v130
  v_exp_f32 v131, v131
  v_pk_fma_f32 v[124:125], v[124:125], v[228:229], v[228:229] op_sel_hi:[1,0,0]
  v_pk_fma_f32 v[126:127], v[126:127], v[228:229], v[228:229] op_sel_hi:[1,0,0]
  v_pk_fma_f32 v[128:129], v[128:129], v[228:229], v[228:229] op_sel_hi:[1,0,0]
  v_pk_fma_f32 v[130:131], v[130:131], v[228:229], v[228:229] op_sel_hi:[1,0,0]
  v_rcp_f32 v124, v124
  v_rcp_f32 v125, v125
  v_rcp_f32 v126, v126
  v_rcp_f32 v127, v127
  v_rcp_f32 v128, v128
  v_rcp_f32 v129, v129
  v_rcp_f32 v130, v130
  v_rcp_f32 v131, v131
  v_pk_mul_f32 v[56:57], v[56:57], v[124:125]
  v_pk_mul_f32 v[58:59], v[58:59], v[126:127]
  v_pk_mul_f32 v[60:61], v[60:61], v[128:129]
  v_pk_mul_f32 v[62:63], v[62:63], v[130:131]
  v_cvt_pk_bf16_f32 v160, v56, v57
  v_cvt_pk_bf16_f32 v161, v58, v59
  v_cvt_pk_bf16_f32 v162, v60, v61
  v_cvt_pk_bf16_f32 v163, v62, v63
  buffer_store_dwordx4 v[160:163], v4, s[24:27], s44 offen offset:0 sc1
  v_pk_mul_f32 v[132:133], v[64:65], v[64:65]
  v_pk_mul_f32 v[134:135], v[66:67], v[66:67]
  v_pk_fma_f32 v[132:133], v[132:133], v[224:225], v[226:227] op_sel_hi:[1,0,0]
  v_pk_fma_f32 v[134:135], v[134:135], v[224:225], v[226:227] op_sel_hi:[1,0,0]
  v_pk_mul_f32 v[132:133], v[132:133], v[64:65]
  v_pk_mul_f32 v[134:135], v[134:135], v[66:67]
  v_exp_f32 v132, v132
  v_exp_f32 v133, v133
  v_exp_f32 v134, v134
  v_exp_f32 v135, v135
  v_pk_fma_f32 v[132:133], v[132:133], v[228:229], v[228:229] op_sel_hi:[1,0,0]
  v_pk_fma_f32 v[134:135], v[134:135], v[228:229], v[228:229] op_sel_hi:[1,0,0]
  v_rcp_f32 v132, v132
  v_rcp_f32 v133, v133
  v_rcp_f32 v134, v134
  v_rcp_f32 v135, v135
  v_pk_mul_f32 v[64:65], v[64:65], v[132:133]
  v_pk_mul_f32 v[66:67], v[66:67], v[134:135]
  v_cvt_pk_bf16_f32 v164, v64, v65
  v_cvt_pk_bf16_f32 v165, v66, v67
  v_cvt_pk_bf16_f32 v166, v64, v65
  v_cvt_pk_bf16_f32 v167, v66, v67
  s_nop 0
  v_permlane16_swap_b32 v164, v166
  v_permlane16_swap_b32 v165, v167
  buffer_store_dwordx4 v[164:167], v13, s[24:27], s45 offen offset:0 sc1
  v_pk_mul_f32 v[124:125], v[68:69], v[68:69]
  v_pk_mul_f32 v[126:127], v[70:71], v[70:71]
  v_pk_mul_f32 v[128:129], v[72:73], v[72:73]
  v_pk_mul_f32 v[130:131], v[74:75], v[74:75]
  v_pk_fma_f32 v[124:125], v[124:125], v[230:231], v[232:233] op_sel_hi:[1,0,0]
  v_pk_fma_f32 v[126:127], v[126:127], v[230:231], v[232:233] op_sel_hi:[1,0,0]
  v_pk_fma_f32 v[128:129], v[128:129], v[230:231], v[232:233] op_sel_hi:[1,0,0]
  v_pk_fma_f32 v[130:131], v[130:131], v[230:231], v[232:233] op_sel_hi:[1,0,0]
  v_pk_mul_f32 v[124:125], v[124:125], v[68:69]
  v_pk_mul_f32 v[126:127], v[126:127], v[70:71]
  v_pk_mul_f32 v[128:129], v[128:129], v[72:73]
  v_pk_mul_f32 v[130:131], v[130:131], v[74:75]
  v_exp_f32 v124, v124
  v_exp_f32 v125, v125
  v_exp_f32 v126, v126
  v_exp_f32 v127, v127
  v_exp_f32 v128, v128
  v_exp_f32 v129, v129
  v_exp_f32 v130, v130
  v_exp_f32 v131, v131
  v_pk_fma_f32 v[124:125], v[124:125], v[234:235], v[234:235] op_sel_hi:[1,0,0]
  v_pk_fma_f32 v[126:127], v[126:127], v[234:235], v[234:235] op_sel_hi:[1,0,0]
  v_pk_fma_f32 v[128:129], v[128:129], v[234:235], v[234:235] op_sel_hi:[1,0,0]
  v_pk_fma_f32 v[130:131], v[130:131], v[234:235], v[234:235] op_sel_hi:[1,0,0]
  v_rcp_f32 v124, v124
  v_rcp_f32 v125, v125
  v_rcp_f32 v126, v126
  v_rcp_f32 v127, v127
  v_rcp_f32 v128, v128
  v_rcp_f32 v129, v129
  v_rcp_f32 v130, v130
  v_rcp_f32 v131, v131
  v_pk_mul_f32 v[68:69], v[68:69], v[124:125]
  v_pk_mul_f32 v[70:71], v[70:71], v[126:127]
  v_pk_mul_f32 v[72:73], v[72:73], v[128:129]
  v_pk_mul_f32 v[74:75], v[74:75], v[130:131]
  v_cvt_pk_bf16_f32 v168, v68, v69
  v_cvt_pk_bf16_f32 v169, v70, v71
  v_cvt_pk_bf16_f32 v170, v72, v73
  v_cvt_pk_bf16_f32 v171, v74, v75
  buffer_store_dwordx4 v[168:171], v4, s[24:27], s42 offen offset:1024 sc1
  v_pk_mul_f32 v[132:133], v[76:77], v[76:77]
  v_pk_mul_f32 v[134:135], v[78:79], v[78:79]
  v_pk_mul_f32 v[136:137], v[80:81], v[80:81]
  v_pk_mul_f32 v[138:139], v[82:83], v[82:83]
  v_pk_fma_f32 v[132:133], v[132:133], v[230:231], v[232:233] op_sel_hi:[1,0,0]
  v_pk_fma_f32 v[134:135], v[134:135], v[230:231], v[232:233] op_sel_hi:[1,0,0]
  v_pk_fma_f32 v[136:137], v[136:137], v[230:231], v[232:233] op_sel_hi:[1,0,0]
  v_pk_fma_f32 v[138:139], v[138:139], v[230:231], v[232:233] op_sel_hi:[1,0,0]
  v_pk_mul_f32 v[132:133], v[132:133], v[76:77]
  v_pk_mul_f32 v[134:135], v[134:135], v[78:79]
  v_pk_mul_f32 v[136:137], v[136:137], v[80:81]
  v_pk_mul_f32 v[138:139], v[138:139], v[82:83]
  v_exp_f32 v132, v132
  v_exp_f32 v133, v133
  v_exp_f32 v134, v134
  v_exp_f32 v135, v135
  v_exp_f32 v136, v136
  v_exp_f32 v137, v137
  v_exp_f32 v138, v138
  v_exp_f32 v139, v139
  v_pk_fma_f32 v[132:133], v[132:133], v[234:235], v[234:235] op_sel_hi:[1,0,0]
  v_pk_fma_f32 v[134:135], v[134:135], v[234:235], v[234:235] op_sel_hi:[1,0,0]
  v_pk_fma_f32 v[136:137], v[136:137], v[234:235], v[234:235] op_sel_hi:[1,0,0]
  v_pk_fma_f32 v[138:139], v[138:139], v[234:235], v[234:235] op_sel_hi:[1,0,0]
  v_rcp_f32 v132, v132
  v_rcp_f32 v133, v133
  v_rcp_f32 v134, v134
  v_rcp_f32 v135, v135
  v_rcp_f32 v136, v136
  v_rcp_f32 v137, v137
  v_rcp_f32 v138, v138
  v_rcp_f32 v139, v139
  v_pk_mul_f32 v[76:77], v[76:77], v[132:133]
  v_pk_mul_f32 v[78:79], v[78:79], v[134:135]
  v_pk_mul_f32 v[80:81], v[80:81], v[136:137]
  v_pk_mul_f32 v[82:83], v[82:83], v[138:139]
  v_cvt_pk_bf16_f32 v172, v76, v77
  v_cvt_pk_bf16_f32 v173, v78, v79
  v_cvt_pk_bf16_f32 v174, v80, v81
  v_cvt_pk_bf16_f32 v175, v82, v83
  buffer_store_dwordx4 v[172:175], v4, s[24:27], s43 offen offset:1024 sc1
  v_pk_mul_f32 v[124:125], v[84:85], v[84:85]
  v_pk_mul_f32 v[126:127], v[86:87], v[86:87]
  v_pk_mul_f32 v[128:129], v[88:89], v[88:89]
  v_pk_mul_f32 v[130:131], v[90:91], v[90:91]
  v_pk_fma_f32 v[124:125], v[124:125], v[230:231], v[232:233] op_sel_hi:[1,0,0]
  v_pk_fma_f32 v[126:127], v[126:127], v[230:231], v[232:233] op_sel_hi:[1,0,0]
  v_pk_fma_f32 v[128:129], v[128:129], v[230:231], v[232:233] op_sel_hi:[1,0,0]
  v_pk_fma_f32 v[130:131], v[130:131], v[230:231], v[232:233] op_sel_hi:[1,0,0]
  v_pk_mul_f32 v[124:125], v[124:125], v[84:85]
  v_pk_mul_f32 v[126:127], v[126:127], v[86:87]
  v_pk_mul_f32 v[128:129], v[128:129], v[88:89]
  v_pk_mul_f32 v[130:131], v[130:131], v[90:91]
  v_exp_f32 v124, v124
  v_exp_f32 v125, v125
  v_exp_f32 v126, v126
  v_exp_f32 v127, v127
  v_exp_f32 v128, v128
  v_exp_f32 v129, v129
  v_exp_f32 v130, v130
  v_exp_f32 v131, v131
  v_pk_fma_f32 v[124:125], v[124:125], v[234:235], v[234:235] op_sel_hi:[1,0,0]
  v_pk_fma_f32 v[126:127], v[126:127], v[234:235], v[234:235] op_sel_hi:[1,0,0]
  v_pk_fma_f32 v[128:129], v[128:129], v[234:235], v[234:235] op_sel_hi:[1,0,0]
  v_pk_fma_f32 v[130:131], v[130:131], v[234:235], v[234:235] op_sel_hi:[1,0,0]
  v_rcp_f32 v124, v124
  v_rcp_f32 v125, v125
  v_rcp_f32 v126, v126
  v_rcp_f32 v127, v127
  v_rcp_f32 v128, v128
  v_rcp_f32 v129, v129
  v_rcp_f32 v130, v130
  v_rcp_f32 v131, v131
  v_pk_mul_f32 v[84:85], v[84:85], v[124:125]
  v_pk_mul_f32 v[86:87], v[86:87], v[126:127]
  v_pk_mul_f32 v[88:89], v[88:89], v[128:129]
  v_pk_mul_f32 v[90:91], v[90:91], v[130:131]
  v_cvt_pk_bf16_f32 v176, v84, v85
  v_cvt_pk_bf16_f32 v177, v86, v87
  v_cvt_pk_bf16_f32 v178, v88, v89
  v_cvt_pk_bf16_f32 v179, v90, v91
  buffer_store_dwordx4 v[176:179], v4, s[24:27], s44 offen offset:1024 sc1
  v_pk_mul_f32 v[132:133], v[92:93], v[92:93]
  v_pk_mul_f32 v[134:135], v[94:95], v[94:95]
  v_pk_fma_f32 v[132:133], v[132:133], v[230:231], v[232:233] op_sel_hi:[1,0,0]
  v_pk_fma_f32 v[134:135], v[134:135], v[230:231], v[232:233] op_sel_hi:[1,0,0]
  v_pk_mul_f32 v[132:133], v[132:133], v[92:93]
  v_pk_mul_f32 v[134:135], v[134:135], v[94:95]
  v_exp_f32 v132, v132
  v_exp_f32 v133, v133
  v_exp_f32 v134, v134
  v_exp_f32 v135, v135
  v_pk_fma_f32 v[132:133], v[132:133], v[234:235], v[234:235] op_sel_hi:[1,0,0]
  v_pk_fma_f32 v[134:135], v[134:135], v[234:235], v[234:235] op_sel_hi:[1,0,0]
  v_rcp_f32 v132, v132
  v_rcp_f32 v133, v133
  v_rcp_f32 v134, v134
  v_rcp_f32 v135, v135
  v_pk_mul_f32 v[92:93], v[92:93], v[132:133]
  v_pk_mul_f32 v[94:95], v[94:95], v[134:135]
  v_cvt_pk_bf16_f32 v180, v92, v93
  v_cvt_pk_bf16_f32 v181, v94, v95
  v_cvt_pk_bf16_f32 v182, v92, v93
  v_cvt_pk_bf16_f32 v183, v94, v95
  s_nop 0
  v_permlane16_swap_b32 v180, v182
  v_permlane16_swap_b32 v181, v183
  buffer_store_dwordx4 v[180:183], v13, s[24:27], s45 offen offset:1024 sc1
  s_and_b32 s12, s2, 7
  s_lshl_b32 s12, s12, 2
  s_lshr_b32 s13, s2, 3
  s_and_b32 s8, s13, 3
  s_add_u32 s12, s12, s8
  s_lshr_b32 s13, s13, 2
  s_lshl_b32 s12, s12, 6
  s_lshl_b32 s8, s3, 4
  s_add_u32 s12, s12, s8
  s_lshl_b32 s11, s12, 6
  v_add_u32 v5, s12, v2
  s_mul_i32 s24, s13, 5
  s_add_u32 s25, s24, 1
  s_lshr_b32 s25, s25, 1
  s_and_b32 s26, s13, 1
  s_add_u32 s27, s25, 2
  s_sub_u32 s28, s25, 1
  s_cmp_eq_u32 s26, 0
  s_cselect_b32 s27, s27, s28
  s_lshl_b32 s26, s26, 3
  s_add_u32 s24, s25, 0
  s_lshl_b32 s42, s24, 6
  s_add_u32 s24, s25, 1
  s_lshl_b32 s43, s24, 6
  s_lshl_b32 s44, s27, 6
  s_add_u32 s44, s44, s26
  v_mul_u32_u24 v12, 1280, v5
  v_lshl_add_u32 v12, v3, 4, v12
  s_lshr_b32 s8, s12, 7
  s_lshl_b32 s8, s8, 12
  s_add_u32 s8, s8, 196608
  v_lshl_add_u32 v9, v1, 8, s8
  s_mov_b32 s10, 0
  s_lshl_b32 s10, s10, 17
  s_add_u32 s10, s10, s11
  s_add_u32 s20, s14, 0x2400000
  s_addc_u32 s21, s15, 0
  s_mov_b32 s22, 0x6c0000
  s_mov_b32 s23, 0x00020000
  s_waitcnt vmcnt(0)
  s_mov_b64 exec, 1
  ds_add_rtn_u32 v8, v6, v7
  s_waitcnt lgkmcnt(0)
  v_readfirstlane_b32 s41, v8
  s_nop 0
  s_cmp_lg_u32 s41, 15
  s_cbranch_scc1 kf_kernel_ns110
  buffer_store_dword v7, off, s[48:51], s53 sc1
kf_kernel_ns110:
  s_mov_b32 s24, s6
  s_mov_b32 s25, s7
  s_mov_b32 s26, 0x280000
  s_mov_b32 s27, 0x00020000
  s_mov_b64 exec, -1
  ds_read_b128 v[60:63], v4 offset:28672
  ds_read_b128 v[64:67], v4 offset:29696
  ds_read_b128 v[68:71], v4 offset:30720
  ds_read_b128 v[72:75], v4 offset:31744
  ds_read_b128 v[76:79], v4 offset:32768
  ds_read_b128 v[80:83], v4 offset:33792
  ds_read_b128 v[84:87], v4 offset:34816
  ds_read_b128 v[88:91], v4 offset:35840
  ds_read_b128 v[92:95], v4 offset:36864
  ds_read_b128 v[96:99], v4 offset:37888
  ds_read_b128 v[100:103], v4 offset:38912
  ds_read_b128 v[104:107], v4 offset:39936
  ds_read_b128 v[108:111], v4 offset:40960
  ds_read_b128 v[112:115], v4 offset:41984
  ds_read_b128 v[116:119], v4 offset:43008
  s_mov_b64 exec, 0xffff
  s_movk_i32 s40, 30000
kf_kernel_pl111:
  buffer_load_dword v8, v9, s[48:51], 0 offen sc1
  s_waitcnt vmcnt(0)
  v_cmp_eq_u32 vcc, 0, v8
  s_cbranch_vccz kf_kernel_pd112
  s_sub_u32 s40, s40, 1
  s_cbranch_scc0 kf_kernel_pl111
kf_kernel_pd112:
  s_mov_b64 exec, -1
  buffer_load_dwordx4 v[140:143], v4, s[20:23], s10 offen offset:0 sc1
  s_add_u32 s10, s10, 0x20000
  buffer_load_dwordx4 v[144:147], v4, s[20:23], s10 offen offset:0 sc1
  s_add_u32 s10, s10, 0x20000
  buffer_load_dwordx4 v[148:151], v4, s[20:23], s10 offen offset:0 sc1
  s_add_u32 s10, s10, 0x20000
  buffer_load_dwordx4 v[152:155], v4, s[20:23], s10 offen offset:0 sc1
  s_add_u32 s10, s10, 0x20000
  buffer_load_dwordx4 v[156:159], v4, s[20:23], s10 offen offset:0 sc1
  s_add_u32 s10, s10, 0x20000
  buffer_load_dwordx4 v[160:163], v4, s[20:23], s10 offen offset:0 sc1
  s_add_u32 s10, s10, 0x20000
  buffer_load_dwordx4 v[164:167], v4, s[20:23], s10 offen offset:0 sc1
  s_add_u32 s10, s10, 0x20000
  buffer_load_dwordx4 v[168:171], v4, s[20:23], s10 offen offset:0 sc1
  s_add_u32 s10, s10, 0x20000
  buffer_load_dwordx4 v[172:175], v4, s[20:23], s10 offen offset:0 sc1
  s_add_u32 s10, s10, 0x20000
  buffer_load_dwordx4 v[176:179], v4, s[20:23], s10 offen offset:0 sc1
  s_add_u32 s10, s10, 0x20000
  buffer_load_dwordx4 v[180:183], v4, s[20:23], s10 offen offset:0 sc1
  s_add_u32 s10, s10, 0x20000
  buffer_load_dwordx4 v[184:187], v4, s[20:23], s10 offen offset:0 sc1
  s_add_u32 s10, s10, 0x20000
  buffer_load_dwordx4 v[188:191], v4, s[20:23], s10 offen offset:0 sc1
  s_add_u32 s10, s10, 0x20000
  buffer_load_dwordx4 v[192:195], v4, s[20:23], s10 offen offset:0 sc1
  s_add_u32 s10, s10, 0x20000
  s_waitcnt vmcnt(13) lgkmcnt(14)
  v_mfma_f32_16x16x32_bf16 v[40:43], v[60:63], v[140:143], v[20:23]
  ds_read_b128 v[120:123], v4 offset:44032
  s_waitcnt lgkmcnt(14)
  v_mfma_f32_16x16x32_bf16 v[44:47], v[64:67], v[140:143], v[24:27]
  ds_read_b128 v[124:127], v4 offset:45056
  s_waitcnt lgkmcnt(14)
  v_mfma_f32_16x16x32_bf16 v[48:51], v[68:71], v[140:143], v[28:31]
  ds_read_b128 v[128:131], v4 offset:46080
  buffer_load_dwordx4 v[196:199], v4, s[20:23], s10 offen offset:0 sc1
  s_add_u32 s10, s10, 0x20000
  s_waitcnt lgkmcnt(14)
  v_mfma_f32_16x16x32_bf16 v[52:55], v[72:75], v[140:143], v[32:35]
  ds_read_b128 v[132:135], v4 offset:47104
  s_waitcnt lgkmcnt(14)
  v_mfma_f32_16x16x32_bf16 v[56:59], v[76:79], v[140:143], v[36:39]
  ds_read_b128 v[136:139], v4 offset:48128
  s_waitcnt vmcnt(13) lgkmcnt(14)
  v_mfma_f32_16x16x32_bf16 v[40:43], v[80:83], v[144:147], v[40:43]
  ds_read_b128 v[60:63], v4 offset:49152
  s_waitcnt lgkmcnt(14)
  v_mfma_f32_16x16x32_bf16 v[44:47], v[84:87], v[144:147], v[44:47]
  ds_read_b128 v[64:67], v4 offset:50176
  s_waitcnt lgkmcnt(14)
  v_mfma_f32_16x16x32_bf16 v[48:51], v[88:91], v[144:147], v[48:51]
  ds_read_b128 v[68:71], v4 offset:51200
  buffer_load_dwordx4 v[140:143], v4, s[20:23], s10 offen offset:0 sc1
  s_add_u32 s10, s10, 0x20000
  s_waitcnt lgkmcnt(14)
  v_mfma_f32_16x16x32_bf16 v[52:55], v[92:95], v[144:147], v[52:55]
  ds_read_b128 v[72:75], v4 offset:52224
  s_waitcnt lgkmcnt(14)
  v_mfma_f32_16x16x32_bf16 v[56:59], v[96:99], v[144:147], v[56:59]
  ds_read_b128 v[76:79], v4 offset:53248
  s_barrier
  s_waitcnt vmcnt(13) lgkmcnt(14)
  v_mfma_f32_16x16x32_bf16 v[40:43], v[100:103], v[148:151], v[40:43]
  ds_read_b128 v[80:83], v4 offset:54272
  s_waitcnt lgkmcnt(14)
  v_mfma_f32_16x16x32_bf16 v[44:47], v[104:107], v[148:151], v[44:47]
  ds_read_b128 v[84:87], v4 offset:55296
  s_waitcnt lgkmcnt(14)
  v_mfma_f32_16x16x32_bf16 v[48:51], v[108:111], v[148:151], v[48:51]
  ds_read_b128 v[88:91], v4 offset:56320
  buffer_load_dwordx4 v[144:147], v4, s[20:23], s10 offen offset:0 sc1
  s_add_u32 s10, s10, 0x20000
  s_waitcnt lgkmcnt(14)
  v_mfma_f32_16x16x32_bf16 v[52:55], v[112:115], v[148:151], v[52:55]
  ds_read_b128 v[92:95], v4 offset:57344
  s_waitcnt lgkmcnt(14)
  v_mfma_f32_16x16x32_bf16 v[56:59], v[116:119], v[148:151], v[56:59]
  ds_read_b128 v[96:99], v4 offset:58368
  s_waitcnt vmcnt(13) lgkmcnt(14)
  v_mfma_f32_16x16x32_bf16 v[40:43], v[120:123], v[152:155], v[40:43]
  ds_read_b128 v[100:103], v4 offset:59392
  s_waitcnt lgkmcnt(14)
  v_mfma_f32_16x16x32_bf16 v[44:47], v[124:127], v[152:155], v[44:47]
  ds_read_b128 v[104:107], v4 offset:60416
  s_waitcnt lgkmcnt(14)
  v_mfma_f32_16x16x32_bf16 v[48:51], v[128:131], v[152:155], v[48:51]
  ds_read_b128 v[108:111], v4 offset:61440
  buffer_load_dwordx4 v[148:151], v4, s[20:23], s10 offen offset:0 sc1
  s_add_u32 s10, s10, 0x20000
  s_waitcnt lgkmcnt(14)
  v_mfma_f32_16x16x32_bf16 v[52:55], v[132:135], v[152:155], v[52:55]
  ds_read_b128 v[112:115], v4 offset:62464
  s_waitcnt lgkmcnt(14)
  v_mfma_f32_16x16x32_bf16 v[56:59], v[136:139], v[152:155], v[56:59]
  ds_read_b128 v[116:119], v4 offset:63488
  s_barrier
  s_waitcnt vmcnt(13) lgkmcnt(14)
  v_mfma_f32_16x16x32_bf16 v[40:43], v[60:63], v[156:159], v[40:43]
  ds_read_b128 v[120:123], v4 offset:64512
  s_waitcnt lgkmcnt(14)
  v_mfma_f32_16x16x32_bf16 v[44:47], v[64:67], v[156:159], v[44:47]
  ds_read_b128 v[124:127], v10 offset:0
  s_waitcnt lgkmcnt(14)
  v_mfma_f32_16x16x32_bf16 v[48:51], v[68:71], v[156:159], v[48:51]
  ds_read_b128 v[128:131], v10 offset:1024
  buffer_load_dwordx4 v[152:155], v4, s[20:23], s10 offen offset:0 sc1
  s_add_u32 s10, s10, 0x20000
  s_waitcnt lgkmcnt(14)
  v_mfma_f32_16x16x32_bf16 v[52:55], v[72:75], v[156:159], v[52:55]
  ds_read_b128 v[132:135], v10 offset:2048
  s_waitcnt lgkmcnt(14)
  v_mfma_f32_16x16x32_bf16 v[56:59], v[76:79], v[156:159], v[56:59]
  ds_read_b128 v[136:139], v10 offset:3072
  s_waitcnt vmcnt(13) lgkmcnt(14)
  v_mfma_f32_16x16x32_bf16 v[40:43], v[80:83], v[160:163], v[40:43]
  ds_read_b128 v[60:63], v10 offset:4096
  s_waitcnt lgkmcnt(14)
  v_mfma_f32_16x16x32_bf16 v[44:47], v[84:87], v[160:163], v[44:47]
  ds_read_b128 v[64:67], v10 offset:5120
  s_waitcnt lgkmcnt(14)
  v_mfma_f32_16x16x32_bf16 v[48:51], v[88:91], v[160:163], v[48:51]
  ds_read_b128 v[68:71], v10 offset:6144
  buffer_load_dwordx4 v[156:159], v4, s[20:23], s10 offen offset:0 sc1
  s_add_u32 s10, s10, 0x20000
  s_waitcnt lgkmcnt(14)
  v_mfma_f32_16x16x32_bf16 v[52:55], v[92:95], v[160:163], v[52:55]
  ds_read_b128 v[72:75], v10 offset:7168
  s_waitcnt lgkmcnt(14)
  v_mfma_f32_16x16x32_bf16 v[56:59], v[96:99], v[160:163], v[56:59]
  ds_read_b128 v[76:79], v10 offset:8192
  s_barrier
  s_waitcnt vmcnt(13) lgkmcnt(14)
  v_mfma_f32_16x16x32_bf16 v[40:43], v[100:103], v[164:167], v[40:43]
  ds_read_b128 v[80:83], v10 offset:9216
  s_waitcnt lgkmcnt(14)
  v_mfma_f32_16x16x32_bf16 v[44:47], v[104:107], v[164:167], v[44:47]
  ds_read_b128 v[84:87], v10 offset:10240
  s_waitcnt lgkmcnt(14)
  v_mfma_f32_16x16x32_bf16 v[48:51], v[108:111], v[164:167], v[48:51]
  ds_read_b128 v[88:91], v10 offset:11264
  buffer_load_dwordx4 v[160:163], v4, s[20:23], s10 offen offset:0 sc1
  s_add_u32 s10, s10, 0x20000
  s_waitcnt lgkmcnt(14)
  v_mfma_f32_16x16x32_bf16 v[52:55], v[112:115], v[164:167], v[52:55]
  ds_read_b128 v[92:95], v10 offset:12288
  s_waitcnt lgkmcnt(14)
  v_mfma_f32_16x16x32_bf16 v[56:59], v[116:119], v[164:167], v[56:59]
  ds_read_b128 v[96:99], v10 offset:13312
  s_waitcnt vmcnt(13) lgkmcnt(14)
  v_mfma_f32_16x16x32_bf16 v[40:43], v[120:123], v[168:171], v[40:43]
  ds_read_b128 v[100:103], v10 offset:14336
  s_waitcnt lgkmcnt(14)
  v_mfma_f32_16x16x32_bf16 v[44:47], v[124:127], v[168:171], v[44:47]
  ds_read_b128 v[104:107], v10 offset:15360
  s_waitcnt lgkmcnt(14)
  v_mfma_f32_16x16x32_bf16 v[48:51], v[128:131], v[168:171], v[48:51]
  ds_read_b128 v[108:111], v10 offset:16384
  buffer_load_dwordx4 v[164:167], v4, s[20:23], s10 offen offset:0 sc1
  s_add_u32 s10, s10, 0x20000
  s_waitcnt lgkmcnt(14)
  v_mfma_f32_16x16x32_bf16 v[52:55], v[132:135], v[168:171], v[52:55]
  ds_read_b128 v[112:115], v10 offset:17408
  s_waitcnt lgkmcnt(14)
  v_mfma_f32_16x16x32_bf16 v[56:59], v[136:139], v[168:171], v[56:59]
  ds_read_b128 v[116:119], v10 offset:18432
  s_barrier
  s_waitcnt vmcnt(13) lgkmcnt(14)
  v_mfma_f32_16x16x32_bf16 v[40:43], v[60:63], v[172:175], v[40:43]
  ds_read_b128 v[120:123], v10 offset:19456
  s_waitcnt lgkmcnt(14)
  v_mfma_f32_16x16x32_bf16 v[44:47], v[64:67], v[172:175], v[44:47]
  ds_read_b128 v[124:127], v10 offset:20480
  s_waitcnt lgkmcnt(14)
  v_mfma_f32_16x16x32_bf16 v[48:51], v[68:71], v[172:175], v[48:51]
  ds_read_b128 v[128:131], v10 offset:21504
  buffer_load_dwordx4 v[168:171], v4, s[20:23], s10 offen offset:0 sc1
  s_add_u32 s10, s10, 0x20000
  s_waitcnt lgkmcnt(14)
  v_mfma_f32_16x16x32_bf16 v[52:55], v[72:75], v[172:175], v[52:55]
  ds_read_b128 v[132:135], v10 offset:22528
  s_waitcnt lgkmcnt(14)
  v_mfma_f32_16x16x32_bf16 v[56:59], v[76:79], v[172:175], v[56:59]
  ds_read_b128 v[136:139], v10 offset:23552
  s_waitcnt vmcnt(13) lgkmcnt(14)
  v_mfma_f32_16x16x32_bf16 v[40:43], v[80:83], v[176:179], v[40:43]
  ds_read_b128 v[60:63], v10 offset:24576
  s_waitcnt lgkmcnt(14)
  v_mfma_f32_16x16x32_bf16 v[44:47], v[84:87], v[176:179], v[44:47]
  ds_read_b128 v[64:67], v10 offset:25600
  s_waitcnt lgkmcnt(14)
  v_mfma_f32_16x16x32_bf16 v[48:51], v[88:91], v[176:179], v[48:51]
  ds_read_b128 v[68:71], v10 offset:26624
  buffer_load_dwordx4 v[172:175], v4, s[20:23], s10 offen offset:0 sc1
  s_add_u32 s10, s10, 0x20000
  s_waitcnt lgkmcnt(14)
  v_mfma_f32_16x16x32_bf16 v[52:55], v[92:95], v[176:179], v[52:55]
  ds_read_b128 v[72:75], v10 offset:27648
  s_waitcnt lgkmcnt(14)
  v_mfma_f32_16x16x32_bf16 v[56:59], v[96:99], v[176:179], v[56:59]
  ds_read_b128 v[76:79], v10 offset:28672
  s_barrier
  s_waitcnt vmcnt(13) lgkmcnt(14)
  v_mfma_f32_16x16x32_bf16 v[40:43], v[100:103], v[180:183], v[40:43]
  ds_read_b128 v[80:83], v10 offset:29696
  s_waitcnt lgkmcnt(14)
  v_mfma_f32_16x16x32_bf16 v[44:47], v[104:107], v[180:183], v[44:47]
  ds_read_b128 v[84:87], v10 offset:30720
  s_waitcnt lgkmcnt(14)
  v_mfma_f32_16x16x32_bf16 v[48:51], v[108:111], v[180:183], v[48:51]
  ds_read_b128 v[88:91], v10 offset:31744
  buffer_load_dwordx4 v[176:179], v4, s[20:23], s10 offen offset:0 sc1
  s_add_u32 s10, s10, 0x20000
  s_waitcnt lgkmcnt(14)
  v_mfma_f32_16x16x32_bf16 v[52:55], v[112:115], v[180:183], v[52:55]
  ds_read_b128 v[92:95], v10 offset:32768
  s_waitcnt lgkmcnt(14)
  v_mfma_f32_16x16x32_bf16 v[56:59], v[116:119], v[180:183], v[56:59]
  ds_read_b128 v[96:99], v10 offset:33792
  s_waitcnt vmcnt(13) lgkmcnt(14)
  v_mfma_f32_16x16x32_bf16 v[40:43], v[120:123], v[184:187], v[40:43]
  ds_read_b128 v[100:103], v10 offset:34816
  s_waitcnt lgkmcnt(14)
  v_mfma_f32_16x16x32_bf16 v[44:47], v[124:127], v[184:187], v[44:47]
  ds_read_b128 v[104:107], v10 offset:35840
  s_waitcnt lgkmcnt(14)
  v_mfma_f32_16x16x32_bf16 v[48:51], v[128:131], v[184:187], v[48:51]
  ds_read_b128 v[108:111], v10 offset:36864
  buffer_load_dwordx4 v[180:183], v4, s[20:23], s10 offen offset:0 sc1
  s_add_u32 s10, s10, 0x20000
  s_waitcnt lgkmcnt(14)
  v_mfma_f32_16x16x32_bf16 v[52:55], v[132:135], v[184:187], v[52:55]
  ds_read_b128 v[112:115], v10 offset:37888
  s_waitcnt lgkmcnt(14)
  v_mfma_f32_16x16x32_bf16 v[56:59], v[136:139], v[184:187], v[56:59]
  ds_read_b128 v[116:119], v10 offset:38912
  s_barrier
  s_waitcnt vmcnt(13) lgkmcnt(14)
  v_mfma_f32_16x16x32_bf16 v[40:43], v[60:63], v[188:191], v[40:43]
  ds_read_b128 v[120:123], v10 offset:39936
  s_waitcnt lgkmcnt(14)
  v_mfma_f32_16x16x32_bf16 v[44:47], v[64:67], v[188:191], v[44:47]
  ds_read_b128 v[124:127], v10 offset:40960
  s_waitcnt lgkmcnt(14)
  v_mfma_f32_16x16x32_bf16 v[48:51], v[68:71], v[188:191], v[48:51]
  ds_read_b128 v[128:131], v10 offset:41984
  buffer_load_dwordx4 v[184:187], v4, s[20:23], s10 offen offset:0 sc1
  s_add_u32 s10, s10, 0x20000
  s_waitcnt lgkmcnt(14)
  v_mfma_f32_16x16x32_bf16 v[52:55], v[72:75], v[188:191], v[52:55]
  ds_read_b128 v[132:135], v10 offset:43008
  s_waitcnt lgkmcnt(14)
  v_mfma_f32_16x16x32_bf16 v[56:59], v[76:79], v[188:191], v[56:59]
  ds_read_b128 v[136:139], v10 offset:44032
  s_waitcnt vmcnt(13) lgkmcnt(14)
  v_mfma_f32_16x16x32_bf16 v[40:43], v[80:83], v[192:195], v[40:43]
  ds_read_b128 v[60:63], v10 offset:45056
  s_waitcnt lgkmcnt(14)
  v_mfma_f32_16x16x32_bf16 v[44:47], v[84:87], v[192:195], v[44:47]
  ds_read_b128 v[64:67], v10 offset:46080
  s_waitcnt lgkmcnt(14)
  v_mfma_f32_16x16x32_bf16 v[48:51], v[88:91], v[192:195], v[48:51]
  ds_read_b128 v[68:71], v10 offset:47104
  buffer_load_dwordx4 v[188:191], v4, s[20:23], s10 offen offset:0 sc1
  s_add_u32 s10, s10, 0x20000
  s_waitcnt lgkmcnt(14)
  v_mfma_f32_16x16x32_bf16 v[52:55], v[92:95], v[192:195], v[52:55]
  ds_read_b128 v[72:75], v10 offset:48128
  s_waitcnt lgkmcnt(14)
  v_mfma_f32_16x16x32_bf16 v[56:59], v[96:99], v[192:195], v[56:59]
  ds_read_b128 v[76:79], v10 offset:49152
  s_barrier
  s_waitcnt vmcnt(13) lgkmcnt(14)
  v_mfma_f32_16x16x32_bf16 v[40:43], v[100:103], v[196:199], v[40:43]
  ds_read_b128 v[80:83], v10 offset:50176
  s_waitcnt lgkmcnt(14)
  v_mfma_f32_16x16x32_bf16 v[44:47], v[104:107], v[196:199], v[44:47]
  ds_read_b128 v[84:87], v10 offset:51200
  s_waitcnt lgkmcnt(14)
  v_mfma_f32_16x16x32_bf16 v[48:51], v[108:111], v[196:199], v[48:51]
  ds_read_b128 v[88:91], v10 offset:52224
  buffer_load_dwordx4 v[192:195], v4, s[20:23], s10 offen offset:0 sc1
  s_add_u32 s10, s10, 0x20000
  s_waitcnt lgkmcnt(14)
  v_mfma_f32_16x16x32_bf16 v[52:55], v[112:115], v[196:199], v[52:55]
  ds_read_b128 v[92:95], v10 offset:53248
  s_waitcnt lgkmcnt(14)
  v_mfma_f32_16x16x32_bf16 v[56:59], v[116:119], v[196:199], v[56:59]
  ds_read_b128 v[96:99], v10 offset:54272
  s_waitcnt vmcnt(13) lgkmcnt(14)
  v_mfma_f32_16x16x32_bf16 v[40:43], v[120:123], v[140:143], v[40:43]
  ds_read_b128 v[100:103], v10 offset:55296
  s_waitcnt lgkmcnt(14)
  v_mfma_f32_16x16x32_bf16 v[44:47], v[124:127], v[140:143], v[44:47]
  ds_read_b128 v[104:107], v10 offset:56320
  s_waitcnt lgkmcnt(14)
  v_mfma_f32_16x16x32_bf16 v[48:51], v[128:131], v[140:143], v[48:51]
  ds_read_b128 v[108:111], v10 offset:57344
  buffer_load_dwordx4 v[196:199], v4, s[20:23], s10 offen offset:0 sc1
  s_add_u32 s10, s10, 0x20000
  s_waitcnt lgkmcnt(14)
  v_mfma_f32_16x16x32_bf16 v[52:55], v[132:135], v[140:143], v[52:55]
  ds_read_b128 v[112:115], v10 offset:58368
  s_waitcnt lgkmcnt(14)
  v_mfma_f32_16x16x32_bf16 v[56:59], v[136:139], v[140:143], v[56:59]
  ds_read_b128 v[116:119], v10 offset:59392
  s_barrier
  s_waitcnt vmcnt(13) lgkmcnt(14)
  v_mfma_f32_16x16x32_bf16 v[40:43], v[60:63], v[144:147], v[40:43]
  ds_read_b128 v[120:123], v10 offset:60416
  s_waitcnt lgkmcnt(14)
  v_mfma_f32_16x16x32_bf16 v[44:47], v[64:67], v[144:147], v[44:47]
  ds_read_b128 v[124:127], v10 offset:61440
  s_waitcnt lgkmcnt(14)
  v_mfma_f32_16x16x32_bf16 v[48:51], v[68:71], v[144:147], v[48:51]
  ds_read_b128 v[128:131], v10 offset:62464
  buffer_load_dwordx4 v[140:143], v4, s[20:23], s10 offen offset:0 sc1
  s_add_u32 s10, s10, 0x20000
  s_waitcnt lgkmcnt(14)
  v_mfma_f32_16x16x32_bf16 v[52:55], v[72:75], v[144:147], v[52:55]
  ds_read_b128 v[132:135], v10 offset:63488
  s_waitcnt lgkmcnt(14)
  v_mfma_f32_16x16x32_bf16 v[56:59], v[76:79], v[144:147], v[56:59]
  ds_read_b128 v[136:139], v10 offset:64512
  s_waitcnt vmcnt(13) lgkmcnt(14)
  v_mfma_f32_16x16x32_bf16 v[40:43], v[80:83], v[148:151], v[40:43]
  ds_read_b128 v[60:63], v11 offset:0
  s_waitcnt lgkmcnt(14)
  v_mfma_f32_16x16x32_bf16 v[44:47], v[84:87], v[148:151], v[44:47]
  ds_read_b128 v[64:67], v11 offset:1024
  s_waitcnt lgkmcnt(14)
  v_mfma_f32_16x16x32_bf16 v[48:51], v[88:91], v[148:151], v[48:51]
  ds_read_b128 v[68:71], v11 offset:2048
  buffer_load_dwordx4 v[144:147], v4, s[20:23], s10 offen offset:0 sc1
  s_add_u32 s10, s10, 0x20000
  s_waitcnt lgkmcnt(14)
  v_mfma_f32_16x16x32_bf16 v[52:55], v[92:95], v[148:151], v[52:55]
  ds_read_b128 v[72:75], v11 offset:3072
  s_waitcnt lgkmcnt(14)
  v_mfma_f32_16x16x32_bf16 v[56:59], v[96:99], v[148:151], v[56:59]
  ds_read_b128 v[76:79], v11 offset:4096
  s_barrier
  s_waitcnt vmcnt(13) lgkmcnt(14)
  v_mfma_f32_16x16x32_bf16 v[40:43], v[100:103], v[152:155], v[40:43]
  ds_read_b128 v[80:83], v11 offset:5120
  s_waitcnt lgkmcnt(14)
  v_mfma_f32_16x16x32_bf16 v[44:47], v[104:107], v[152:155], v[44:47]
  ds_read_b128 v[84:87], v11 offset:6144
  s_waitcnt lgkmcnt(14)
  v_mfma_f32_16x16x32_bf16 v[48:51], v[108:111], v[152:155], v[48:51]
  ds_read_b128 v[88:91], v11 offset:7168
  buffer_load_dwordx4 v[148:151], v4, s[20:23], s10 offen offset:0 sc1
  s_add_u32 s10, s10, 0x20000
  s_waitcnt lgkmcnt(14)
  v_mfma_f32_16x16x32_bf16 v[52:55], v[112:115], v[152:155], v[52:55]
  ds_read_b128 v[92:95], v11 offset:8192
  s_waitcnt lgkmcnt(14)
  v_mfma_f32_16x16x32_bf16 v[56:59], v[116:119], v[152:155], v[56:59]
  ds_read_b128 v[96:99], v11 offset:9216
  s_waitcnt vmcnt(13) lgkmcnt(14)
  v_mfma_f32_16x16x32_bf16 v[40:43], v[120:123], v[156:159], v[40:43]
  ds_read_b128 v[100:103], v11 offset:10240
  s_waitcnt lgkmcnt(14)
  v_mfma_f32_16x16x32_bf16 v[44:47], v[124:127], v[156:159], v[44:47]
  ds_read_b128 v[104:107], v11 offset:11264
  s_waitcnt lgkmcnt(14)
  v_mfma_f32_16x16x32_bf16 v[48:51], v[128:131], v[156:159], v[48:51]
  ds_read_b128 v[108:111], v11 offset:12288
  buffer_load_dwordx4 v[152:155], v4, s[20:23], s10 offen offset:0 sc1
  s_add_u32 s10, s10, 0x20000
  s_waitcnt lgkmcnt(14)
  v_mfma_f32_16x16x32_bf16 v[52:55], v[132:135], v[156:159], v[52:55]
  ds_read_b128 v[112:115], v11 offset:13312
  s_waitcnt lgkmcnt(14)
  v_mfma_f32_16x16x32_bf16 v[56:59], v[136:139], v[156:159], v[56:59]
  ds_read_b128 v[116:119], v11 offset:14336
  s_barrier
  s_waitcnt vmcnt(13) lgkmcnt(14)
  v_mfma_f32_16x16x32_bf16 v[40:43], v[60:63], v[160:163], v[40:43]
  ds_read_b128 v[120:123], v11 offset:15360
  s_waitcnt lgkmcnt(14)
  v_mfma_f32_16x16x32_bf16 v[44:47], v[64:67], v[160:163], v[44:47]
  ds_read_b128 v[124:127], v11 offset:16384
  s_waitcnt lgkmcnt(14)
  v_mfma_f32_16x16x32_bf16 v[48:51], v[68:71], v[160:163], v[48:51]
  ds_read_b128 v[128:131], v11 offset:17408
  buffer_load_dwordx4 v[156:159], v4, s[20:23], s10 offen offset:0 sc1
  s_add_u32 s10, s10, 0x20000
  s_waitcnt lgkmcnt(14)
  v_mfma_f32_16x16x32_bf16 v[52:55], v[72:75], v[160:163], v[52:55]
  ds_read_b128 v[132:135], v11 offset:18432
  s_waitcnt lgkmcnt(14)
  v_mfma_f32_16x16x32_bf16 v[56:59], v[76:79], v[160:163], v[56:59]
  ds_read_b128 v[136:139], v11 offset:19456
  s_waitcnt vmcnt(13) lgkmcnt(14)
  v_mfma_f32_16x16x32_bf16 v[40:43], v[80:83], v[164:167], v[40:43]
  ds_read_b128 v[60:63], v11 offset:20480
  s_waitcnt lgkmcnt(14)
  v_mfma_f32_16x16x32_bf16 v[44:47], v[84:87], v[164:167], v[44:47]
  ds_read_b128 v[64:67], v11 offset:21504
  s_waitcnt lgkmcnt(14)
  v_mfma_f32_16x16x32_bf16 v[48:51], v[88:91], v[164:167], v[48:51]
  ds_read_b128 v[68:71], v11 offset:22528
  buffer_load_dwordx4 v[160:163], v4, s[20:23], s10 offen offset:0 sc1
  s_add_u32 s10, s10, 0x20000
  s_waitcnt lgkmcnt(14)
  v_mfma_f32_16x16x32_bf16 v[52:55], v[92:95], v[164:167], v[52:55]
  ds_read_b128 v[72:75], v11 offset:23552
  s_waitcnt lgkmcnt(14)
  v_mfma_f32_16x16x32_bf16 v[56:59], v[96:99], v[164:167], v[56:59]
  ds_read_b128 v[76:79], v11 offset:24576
  s_barrier
  s_waitcnt vmcnt(13) lgkmcnt(14)
  v_mfma_f32_16x16x32_bf16 v[40:43], v[100:103], v[168:171], v[40:43]
  ds_read_b128 v[80:83], v11 offset:25600
  s_waitcnt lgkmcnt(14)
  v_mfma_f32_16x16x32_bf16 v[44:47], v[104:107], v[168:171], v[44:47]
  ds_read_b128 v[84:87], v11 offset:26624
  s_waitcnt lgkmcnt(14)
  v_mfma_f32_16x16x32_bf16 v[48:51], v[108:111], v[168:171], v[48:51]
  ds_read_b128 v[88:91], v11 offset:27648
  buffer_load_dwordx4 v[164:167], v4, s[20:23], s10 offen offset:0 sc1
  s_add_u32 s10, s10, 0x20000
  s_waitcnt lgkmcnt(14)
  v_mfma_f32_16x16x32_bf16 v[52:55], v[112:115], v[168:171], v[52:55]
  ds_read_b128 v[92:95], v4 offset:0
  s_waitcnt lgkmcnt(14)
  v_mfma_f32_16x16x32_bf16 v[56:59], v[116:119], v[168:171], v[56:59]
  ds_read_b128 v[96:99], v4 offset:1024
  s_waitcnt vmcnt(13) lgkmcnt(14)
  v_mfma_f32_16x16x32_bf16 v[40:43], v[120:123], v[172:175], v[40:43]
  ds_read_b128 v[100:103], v4 offset:2048
  s_waitcnt lgkmcnt(14)
  v_mfma_f32_16x16x32_bf16 v[44:47], v[124:127], v[172:175], v[44:47]
  ds_read_b128 v[104:107], v4 offset:3072
  s_waitcnt lgkmcnt(14)
  v_mfma_f32_16x16x32_bf16 v[48:51], v[128:131], v[172:175], v[48:51]
  ds_read_b128 v[108:111], v4 offset:4096
  buffer_load_dwordx4 v[168:171], v4, s[20:23], s10 offen offset:0 sc1
  s_add_u32 s10, s10, 0x20000
  s_waitcnt lgkmcnt(14)
  v_mfma_f32_16x16x32_bf16 v[52:55], v[132:135], v[172:175], v[52:55]
  ds_read_b128 v[112:115], v4 offset:5120
  s_waitcnt lgkmcnt(14)
  v_mfma_f32_16x16x32_bf16 v[56:59], v[136:139], v[172:175], v[56:59]
  ds_read_b128 v[116:119], v4 offset:6144
  s_barrier
  s_waitcnt vmcnt(13) lgkmcnt(14)
  v_mfma_f32_16x16x32_bf16 v[40:43], v[60:63], v[176:179], v[40:43]
  ds_read_b128 v[120:123], v4 offset:7168
  s_waitcnt lgkmcnt(14)
  v_mfma_f32_16x16x32_bf16 v[44:47], v[64:67], v[176:179], v[44:47]
  ds_read_b128 v[124:127], v4 offset:8192
  s_waitcnt lgkmcnt(14)
  v_mfma_f32_16x16x32_bf16 v[48:51], v[68:71], v[176:179], v[48:51]
  ds_read_b128 v[128:131], v4 offset:9216
  buffer_load_dwordx4 v[172:175], v4, s[20:23], s10 offen offset:0 sc1
  s_add_u32 s10, s10, 0x20000
  s_waitcnt lgkmcnt(14)
  v_mfma_f32_16x16x32_bf16 v[52:55], v[72:75], v[176:179], v[52:55]
  ds_read_b128 v[132:135], v4 offset:10240
  s_waitcnt lgkmcnt(14)
  v_mfma_f32_16x16x32_bf16 v[56:59], v[76:79], v[176:179], v[56:59]
  ds_read_b128 v[136:139], v4 offset:11264
  s_waitcnt vmcnt(13) lgkmcnt(14)
  v_mfma_f32_16x16x32_bf16 v[40:43], v[80:83], v[180:183], v[40:43]
  ds_read_b128 v[60:63], v4 offset:12288
  s_waitcnt lgkmcnt(14)
  v_mfma_f32_16x16x32_bf16 v[44:47], v[84:87], v[180:183], v[44:47]
  ds_read_b128 v[64:67], v4 offset:13312
  s_waitcnt lgkmcnt(14)
  v_mfma_f32_16x16x32_bf16 v[48:51], v[88:91], v[180:183], v[48:51]
  ds_read_b128 v[68:71], v4 offset:14336
  buffer_load_dwordx4 v[176:179], v4, s[20:23], s10 offen offset:0 sc1
  s_add_u32 s10, s10, 0x20000
  s_waitcnt lgkmcnt(14)
  v_mfma_f32_16x16x32_bf16 v[52:55], v[92:95], v[180:183], v[52:55]
  ds_read_b128 v[72:75], v4 offset:15360
  s_waitcnt lgkmcnt(14)
  v_mfma_f32_16x16x32_bf16 v[56:59], v[96:99], v[180:183], v[56:59]
  ds_read_b128 v[76:79], v4 offset:16384
  s_barrier
  s_waitcnt vmcnt(13) lgkmcnt(14)
  v_mfma_f32_16x16x32_bf16 v[40:43], v[100:103], v[184:187], v[40:43]
  ds_read_b128 v[80:83], v4 offset:17408
  s_waitcnt lgkmcnt(14)
  v_mfma_f32_16x16x32_bf16 v[44:47], v[104:107], v[184:187], v[44:47]
  ds_read_b128 v[84:87], v4 offset:18432
  s_waitcnt lgkmcnt(14)
  v_mfma_f32_16x16x32_bf16 v[48:51], v[108:111], v[184:187], v[48:51]
  ds_read_b128 v[88:91], v4 offset:19456
  buffer_load_dwordx4 v[180:183], v4, s[20:23], s10 offen offset:0 sc1
  s_add_u32 s10, s10, 0x20000
  s_waitcnt lgkmcnt(14)
  v_mfma_f32_16x16x32_bf16 v[52:55], v[112:115], v[184:187], v[52:55]
  ds_read_b128 v[92:95], v4 offset:20480
  s_waitcnt lgkmcnt(14)
  v_mfma_f32_16x16x32_bf16 v[56:59], v[116:119], v[184:187], v[56:59]
  ds_read_b128 v[96:99], v4 offset:21504
  s_waitcnt vmcnt(13) lgkmcnt(14)
  v_mfma_f32_16x16x32_bf16 v[40:43], v[120:123], v[188:191], v[40:43]
  ds_read_b128 v[100:103], v4 offset:22528
  s_waitcnt lgkmcnt(14)
  v_mfma_f32_16x16x32_bf16 v[44:47], v[124:127], v[188:191], v[44:47]
  ds_read_b128 v[104:107], v4 offset:23552
  s_waitcnt lgkmcnt(14)
  v_mfma_f32_16x16x32_bf16 v[48:51], v[128:131], v[188:191], v[48:51]
  ds_read_b128 v[108:111], v4 offset:24576
  buffer_load_dwordx4 v[184:187], v4, s[20:23], s10 offen offset:0 sc1
  s_add_u32 s10, s10, 0x20000
  s_waitcnt lgkmcnt(14)
  v_mfma_f32_16x16x32_bf16 v[52:55], v[132:135], v[188:191], v[52:55]
  ds_read_b128 v[112:115], v4 offset:25600
  s_waitcnt lgkmcnt(14)
  v_mfma_f32_16x16x32_bf16 v[56:59], v[136:139], v[188:191], v[56:59]
  ds_read_b128 v[116:119], v4 offset:26624
  s_barrier
  s_waitcnt vmcnt(13) lgkmcnt(14)
  v_mfma_f32_16x16x32_bf16 v[40:43], v[60:63], v[192:195], v[40:43]
  ds_read_b128 v[120:123], v4 offset:27648
  s_waitcnt lgkmcnt(14)
  v_mfma_f32_16x16x32_bf16 v[44:47], v[64:67], v[192:195], v[44:47]
  ds_read_b128 v[124:127], v4 offset:28672
  s_waitcnt lgkmcnt(14)
  v_mfma_f32_16x16x32_bf16 v[48:51], v[68:71], v[192:195], v[48:51]
  ds_read_b128 v[128:131], v4 offset:29696
  buffer_load_dwordx4 v[188:191], v4, s[20:23], s10 offen offset:0 sc1
  s_add_u32 s10, s10, 0x20000
  s_waitcnt lgkmcnt(14)
  v_mfma_f32_16x16x32_bf16 v[52:55], v[72:75], v[192:195], v[52:55]
  ds_read_b128 v[132:135], v4 offset:30720
  s_waitcnt lgkmcnt(14)
  v_mfma_f32_16x16x32_bf16 v[56:59], v[76:79], v[192:195], v[56:59]
  ds_read_b128 v[136:139], v4 offset:31744
  s_waitcnt vmcnt(13) lgkmcnt(14)
  v_mfma_f32_16x16x32_bf16 v[40:43], v[80:83], v[196:199], v[40:43]
  ds_read_b128 v[60:63], v4 offset:32768
  s_waitcnt lgkmcnt(14)
  v_mfma_f32_16x16x32_bf16 v[44:47], v[84:87], v[196:199], v[44:47]
  ds_read_b128 v[64:67], v4 offset:33792
  s_waitcnt lgkmcnt(14)
  v_mfma_f32_16x16x32_bf16 v[48:51], v[88:91], v[196:199], v[48:51]
  ds_read_b128 v[68:71], v4 offset:34816
  buffer_load_dwordx4 v[192:195], v4, s[20:23], s10 offen offset:0 sc1
  s_add_u32 s10, s10, 0x20000
  s_waitcnt lgkmcnt(14)
  v_mfma_f32_16x16x32_bf16 v[52:55], v[92:95], v[196:199], v[52:55]
  ds_read_b128 v[72:75], v4 offset:35840
  s_waitcnt lgkmcnt(14)
  v_mfma_f32_16x16x32_bf16 v[56:59], v[96:99], v[196:199], v[56:59]
  ds_read_b128 v[76:79], v4 offset:36864
  s_waitcnt vmcnt(13) lgkmcnt(14)
  v_mfma_f32_16x16x32_bf16 v[40:43], v[100:103], v[140:143], v[40:43]
  ds_read_b128 v[80:83], v4 offset:37888
  s_waitcnt lgkmcnt(14)
  v_mfma_f32_16x16x32_bf16 v[44:47], v[104:107], v[140:143], v[44:47]
  ds_read_b128 v[84:87], v4 offset:38912
  s_waitcnt lgkmcnt(14)
  v_mfma_f32_16x16x32_bf16 v[48:51], v[108:111], v[140:143], v[48:51]
  ds_read_b128 v[88:91], v4 offset:39936
  buffer_load_dwordx4 v[196:199], v4, s[20:23], s10 offen offset:0 sc1
  s_add_u32 s10, s10, 0x20000
  s_waitcnt lgkmcnt(14)
  v_mfma_f32_16x16x32_bf16 v[52:55], v[112:115], v[140:143], v[52:55]
  ds_read_b128 v[92:95], v4 offset:40960
  s_waitcnt lgkmcnt(14)
  v_mfma_f32_16x16x32_bf16 v[56:59], v[116:119], v[140:143], v[56:59]
  ds_read_b128 v[96:99], v4 offset:41984
  s_waitcnt vmcnt(13) lgkmcnt(14)
  v_mfma_f32_16x16x32_bf16 v[40:43], v[120:123], v[144:147], v[40:43]
  ds_read_b128 v[100:103], v4 offset:43008
  s_waitcnt lgkmcnt(14)
  v_mfma_f32_16x16x32_bf16 v[44:47], v[124:127], v[144:147], v[44:47]
  ds_read_b128 v[104:107], v4 offset:44032
  s_waitcnt lgkmcnt(14)
  v_mfma_f32_16x16x32_bf16 v[48:51], v[128:131], v[144:147], v[48:51]
  ds_read_b128 v[108:111], v4 offset:45056
  buffer_load_dwordx4 v[140:143], v4, s[20:23], s10 offen offset:0 sc1
  s_add_u32 s10, s10, 0x20000
  s_waitcnt lgkmcnt(14)
  v_mfma_f32_16x16x32_bf16 v[52:55], v[132:135], v[144:147], v[52:55]
  ds_read_b128 v[112:115], v4 offset:46080
  s_waitcnt lgkmcnt(14)
  v_mfma_f32_16x16x32_bf16 v[56:59], v[136:139], v[144:147], v[56:59]
  ds_read_b128 v[116:119], v4 offset:47104
  s_waitcnt vmcnt(13) lgkmcnt(14)
  v_mfma_f32_16x16x32_bf16 v[40:43], v[60:63], v[148:151], v[40:43]
  ds_read_b128 v[120:123], v4 offset:48128
  s_waitcnt lgkmcnt(14)
  v_mfma_f32_16x16x32_bf16 v[44:47], v[64:67], v[148:151], v[44:47]
  ds_read_b128 v[124:127], v4 offset:49152
  s_waitcnt lgkmcnt(14)
  v_mfma_f32_16x16x32_bf16 v[48:51], v[68:71], v[148:151], v[48:51]
  ds_read_b128 v[128:131], v4 offset:50176
  buffer_load_dwordx4 v[144:147], v4, s[20:23], s10 offen offset:0 sc1
  s_add_u32 s10, s10, 0x20000
  s_waitcnt lgkmcnt(14)
  v_mfma_f32_16x16x32_bf16 v[52:55], v[72:75], v[148:151], v[52:55]
  ds_read_b128 v[132:135], v4 offset:51200
  s_waitcnt lgkmcnt(14)
  v_mfma_f32_16x16x32_bf16 v[56:59], v[76:79], v[148:151], v[56:59]
  ds_read_b128 v[136:139], v4 offset:52224
  s_waitcnt vmcnt(13) lgkmcnt(14)
  v_mfma_f32_16x16x32_bf16 v[40:43], v[80:83], v[152:155], v[40:43]
  ds_read_b128 v[60:63], v4 offset:53248
  s_waitcnt lgkmcnt(14)
  v_mfma_f32_16x16x32_bf16 v[44:47], v[84:87], v[152:155], v[44:47]
  ds_read_b128 v[64:67], v4 offset:54272
  s_waitcnt lgkmcnt(14)
  v_mfma_f32_16x16x32_bf16 v[48:51], v[88:91], v[152:155], v[48:51]
  ds_read_b128 v[68:71], v4 offset:55296
  buffer_load_dwordx4 v[148:151], v4, s[20:23], s10 offen offset:0 sc1
  s_add_u32 s10, s10, 0x20000
  s_waitcnt lgkmcnt(14)
  v_mfma_f32_16x16x32_bf16 v[52:55], v[92:95], v[152:155], v[52:55]
  ds_read_b128 v[72:75], v4 offset:56320
  s_waitcnt lgkmcnt(14)
  v_mfma_f32_16x16x32_bf16 v[56:59], v[96:99], v[152:155], v[56:59]
  ds_read_b128 v[76:79], v4 offset:57344
  s_barrier
  s_waitcnt vmcnt(13) lgkmcnt(14)
  v_mfma_f32_16x16x32_bf16 v[40:43], v[100:103], v[156:159], v[40:43]
  ds_read_b128 v[80:83], v4 offset:58368
  s_waitcnt lgkmcnt(14)
  v_mfma_f32_16x16x32_bf16 v[44:47], v[104:107], v[156:159], v[44:47]
  ds_read_b128 v[84:87], v4 offset:59392
  s_waitcnt lgkmcnt(14)
  v_mfma_f32_16x16x32_bf16 v[48:51], v[108:111], v[156:159], v[48:51]
  ds_read_b128 v[88:91], v4 offset:60416
  buffer_load_dwordx4 v[152:155], v4, s[20:23], s10 offen offset:0 sc1
  s_add_u32 s10, s10, 0x20000
  s_waitcnt lgkmcnt(14)
  v_mfma_f32_16x16x32_bf16 v[52:55], v[112:115], v[156:159], v[52:55]
  ds_read_b128 v[92:95], v4 offset:61440
  s_waitcnt lgkmcnt(14)
  v_mfma_f32_16x16x32_bf16 v[56:59], v[116:119], v[156:159], v[56:59]
  ds_read_b128 v[96:99], v4 offset:62464
  s_waitcnt vmcnt(13) lgkmcnt(14)
  v_mfma_f32_16x16x32_bf16 v[40:43], v[120:123], v[160:163], v[40:43]
  ds_read_b128 v[100:103], v4 offset:63488
  s_waitcnt lgkmcnt(14)
  v_mfma_f32_16x16x32_bf16 v[44:47], v[124:127], v[160:163], v[44:47]
  ds_read_b128 v[104:107], v4 offset:64512
  s_waitcnt lgkmcnt(14)
  v_mfma_f32_16x16x32_bf16 v[48:51], v[128:131], v[160:163], v[48:51]
  ds_read_b128 v[108:111], v10 offset:0
  buffer_load_dwordx4 v[156:159], v4, s[20:23], s10 offen offset:0 sc1
  s_add_u32 s10, s10, 0x20000
  s_waitcnt lgkmcnt(14)
  v_mfma_f32_16x16x32_bf16 v[52:55], v[132:135], v[160:163], v[52:55]
  ds_read_b128 v[112:115], v10 offset:1024
  s_waitcnt lgkmcnt(14)
  v_mfma_f32_16x16x32_bf16 v[56:59], v[136:139], v[160:163], v[56:59]
  ds_read_b128 v[116:119], v10 offset:2048
  s_waitcnt vmcnt(13) lgkmcnt(14)
  v_mfma_f32_16x16x32_bf16 v[40:43], v[60:63], v[164:167], v[40:43]
  ds_read_b128 v[120:123], v10 offset:3072
  s_waitcnt lgkmcnt(14)
  v_mfma_f32_16x16x32_bf16 v[44:47], v[64:67], v[164:167], v[44:47]
  ds_read_b128 v[124:127], v10 offset:4096
  s_waitcnt lgkmcnt(14)
  v_mfma_f32_16x16x32_bf16 v[48:51], v[68:71], v[164:167], v[48:51]
  ds_read_b128 v[128:131], v10 offset:5120
  buffer_load_dwordx4 v[160:163], v4, s[20:23], s10 offen offset:0 sc1
  s_add_u32 s10, s10, 0x20000
  s_waitcnt lgkmcnt(14)
  v_mfma_f32_16x16x32_bf16 v[52:55], v[72:75], v[164:167], v[52:55]
  ds_read_b128 v[132:135], v10 offset:6144
  s_waitcnt lgkmcnt(14)
  v_mfma_f32_16x16x32_bf16 v[56:59], v[76:79], v[164:167], v[56:59]
  ds_read_b128 v[136:139], v10 offset:7168
  s_waitcnt vmcnt(13) lgkmcnt(14)
  v_mfma_f32_16x16x32_bf16 v[40:43], v[80:83], v[168:171], v[40:43]
  ds_read_b128 v[60:63], v10 offset:8192
  s_waitcnt lgkmcnt(14)
  v_mfma_f32_16x16x32_bf16 v[44:47], v[84:87], v[168:171], v[44:47]
  ds_read_b128 v[64:67], v10 offset:9216
  s_waitcnt lgkmcnt(14)
  v_mfma_f32_16x16x32_bf16 v[48:51], v[88:91], v[168:171], v[48:51]
  ds_read_b128 v[68:71], v10 offset:10240
  buffer_load_dwordx4 v[164:167], v4, s[20:23], s10 offen offset:0 sc1
  s_add_u32 s10, s10, 0x20000
  s_waitcnt lgkmcnt(14)
  v_mfma_f32_16x16x32_bf16 v[52:55], v[92:95], v[168:171], v[52:55]
  ds_read_b128 v[72:75], v10 offset:11264
  s_waitcnt lgkmcnt(14)
  v_mfma_f32_16x16x32_bf16 v[56:59], v[96:99], v[168:171], v[56:59]
  ds_read_b128 v[76:79], v10 offset:12288
  s_barrier
  s_waitcnt vmcnt(13) lgkmcnt(14)
  v_mfma_f32_16x16x32_bf16 v[40:43], v[100:103], v[172:175], v[40:43]
  ds_read_b128 v[80:83], v10 offset:13312
  s_waitcnt lgkmcnt(14)
  v_mfma_f32_16x16x32_bf16 v[44:47], v[104:107], v[172:175], v[44:47]
  ds_read_b128 v[84:87], v10 offset:14336
  s_waitcnt lgkmcnt(14)
  v_mfma_f32_16x16x32_bf16 v[48:51], v[108:111], v[172:175], v[48:51]
  ds_read_b128 v[88:91], v10 offset:15360
  buffer_load_dwordx4 v[168:171], v4, s[20:23], s10 offen offset:0 sc1
  s_add_u32 s10, s10, 0x20000
  s_waitcnt lgkmcnt(14)
  v_mfma_f32_16x16x32_bf16 v[52:55], v[112:115], v[172:175], v[52:55]
  ds_read_b128 v[92:95], v10 offset:16384
  s_waitcnt lgkmcnt(14)
  v_mfma_f32_16x16x32_bf16 v[56:59], v[116:119], v[172:175], v[56:59]
  ds_read_b128 v[96:99], v10 offset:17408
  s_waitcnt vmcnt(13) lgkmcnt(14)
  v_mfma_f32_16x16x32_bf16 v[40:43], v[120:123], v[176:179], v[40:43]
  ds_read_b128 v[100:103], v10 offset:18432
  s_waitcnt lgkmcnt(14)
  v_mfma_f32_16x16x32_bf16 v[44:47], v[124:127], v[176:179], v[44:47]
  ds_read_b128 v[104:107], v10 offset:19456
  s_waitcnt lgkmcnt(14)
  v_mfma_f32_16x16x32_bf16 v[48:51], v[128:131], v[176:179], v[48:51]
  ds_read_b128 v[108:111], v10 offset:20480
  buffer_load_dwordx4 v[172:175], v4, s[20:23], s10 offen offset:0 sc1
  s_waitcnt lgkmcnt(14)
  v_mfma_f32_16x16x32_bf16 v[52:55], v[132:135], v[176:179], v[52:55]
  ds_read_b128 v[112:115], v10 offset:21504
  s_waitcnt lgkmcnt(14)
  v_mfma_f32_16x16x32_bf16 v[56:59], v[136:139], v[176:179], v[56:59]
  ds_read_b128 v[116:119], v10 offset:22528
  s_waitcnt vmcnt(13) lgkmcnt(14)
  v_mfma_f32_16x16x32_bf16 v[40:43], v[60:63], v[180:183], v[40:43]
  ds_read_b128 v[120:123], v10 offset:23552
  s_waitcnt lgkmcnt(14)
  v_mfma_f32_16x16x32_bf16 v[44:47], v[64:67], v[180:183], v[44:47]
  ds_read_b128 v[124:127], v10 offset:24576
  s_waitcnt lgkmcnt(14)
  v_mfma_f32_16x16x32_bf16 v[48:51], v[68:71], v[180:183], v[48:51]
  ds_read_b128 v[128:131], v10 offset:25600
  s_waitcnt lgkmcnt(14)
  v_mfma_f32_16x16x32_bf16 v[52:55], v[72:75], v[180:183], v[52:55]
  ds_read_b128 v[132:135], v10 offset:26624
  s_waitcnt lgkmcnt(14)
  v_mfma_f32_16x16x32_bf16 v[56:59], v[76:79], v[180:183], v[56:59]
  ds_read_b128 v[136:139], v10 offset:27648
  s_waitcnt vmcnt(12) lgkmcnt(14)
  v_mfma_f32_16x16x32_bf16 v[40:43], v[80:83], v[184:187], v[40:43]
  ds_read_b128 v[60:63], v10 offset:28672
  s_waitcnt lgkmcnt(14)
  v_mfma_f32_16x16x32_bf16 v[44:47], v[84:87], v[184:187], v[44:47]
  ds_read_b128 v[64:67], v10 offset:29696
  s_waitcnt lgkmcnt(14)
  v_mfma_f32_16x16x32_bf16 v[48:51], v[88:91], v[184:187], v[48:51]
  ds_read_b128 v[68:71], v10 offset:30720
  s_waitcnt lgkmcnt(14)
  v_mfma_f32_16x16x32_bf16 v[52:55], v[92:95], v[184:187], v[52:55]
  ds_read_b128 v[72:75], v10 offset:31744
  s_waitcnt lgkmcnt(14)
  v_mfma_f32_16x16x32_bf16 v[56:59], v[96:99], v[184:187], v[56:59]
  ds_read_b128 v[76:79], v10 offset:32768
  s_barrier
  s_waitcnt vmcnt(11) lgkmcnt(14)
  v_mfma_f32_16x16x32_bf16 v[40:43], v[100:103], v[188:191], v[40:43]
  ds_read_b128 v[80:83], v10 offset:33792
  s_waitcnt lgkmcnt(14)
  v_mfma_f32_16x16x32_bf16 v[44:47], v[104:107], v[188:191], v[44:47]
  ds_read_b128 v[84:87], v10 offset:34816
  s_waitcnt lgkmcnt(14)
  v_mfma_f32_16x16x32_bf16 v[48:51], v[108:111], v[188:191], v[48:51]
  ds_read_b128 v[88:91], v10 offset:35840
  s_waitcnt lgkmcnt(14)
  v_mfma_f32_16x16x32_bf16 v[52:55], v[112:115], v[188:191], v[52:55]
  ds_read_b128 v[92:95], v10 offset:36864
  s_waitcnt lgkmcnt(14)
  v_mfma_f32_16x16x32_bf16 v[56:59], v[116:119], v[188:191], v[56:59]
  ds_read_b128 v[96:99], v10 offset:37888
  s_waitcnt vmcnt(10) lgkmcnt(14)
  v_mfma_f32_16x16x32_bf16 v[40:43], v[120:123], v[192:195], v[40:43]
  ds_read_b128 v[100:103], v10 offset:38912
  s_waitcnt lgkmcnt(14)
  v_mfma_f32_16x16x32_bf16 v[44:47], v[124:127], v[192:195], v[44:47]
  ds_read_b128 v[104:107], v10 offset:39936
  s_waitcnt lgkmcnt(14)
  v_mfma_f32_16x16x32_bf16 v[48:51], v[128:131], v[192:195], v[48:51]
  ds_read_b128 v[108:111], v10 offset:40960
  s_waitcnt lgkmcnt(14)
  v_mfma_f32_16x16x32_bf16 v[52:55], v[132:135], v[192:195], v[52:55]
  ds_read_b128 v[112:115], v10 offset:41984
  s_waitcnt lgkmcnt(14)
  v_mfma_f32_16x16x32_bf16 v[56:59], v[136:139], v[192:195], v[56:59]
  ds_read_b128 v[116:119], v10 offset:43008
  s_waitcnt vmcnt(9) lgkmcnt(14)
  v_mfma_f32_16x16x32_bf16 v[40:43], v[60:63], v[196:199], v[40:43]
  ds_read_b128 v[120:123], v10 offset:44032
  s_waitcnt lgkmcnt(14)
  v_mfma_f32_16x16x32_bf16 v[44:47], v[64:67], v[196:199], v[44:47]
  ds_read_b128 v[124:127], v10 offset:45056
  s_waitcnt lgkmcnt(14)
  v_mfma_f32_16x16x32_bf16 v[48:51], v[68:71], v[196:199], v[48:51]
  ds_read_b128 v[128:131], v10 offset:46080
  s_waitcnt lgkmcnt(14)
  v_mfma_f32_16x16x32_bf16 v[52:55], v[72:75], v[196:199], v[52:55]
  ds_read_b128 v[132:135], v10 offset:47104
  s_waitcnt lgkmcnt(14)
  v_mfma_f32_16x16x32_bf16 v[56:59], v[76:79], v[196:199], v[56:59]
  ds_read_b128 v[136:139], v10 offset:48128
  s_waitcnt vmcnt(8) lgkmcnt(14)
  v_mfma_f32_16x16x32_bf16 v[40:43], v[80:83], v[140:143], v[40:43]
  ds_read_b128 v[60:63], v10 offset:49152
  s_waitcnt lgkmcnt(14)
  v_mfma_f32_16x16x32_bf16 v[44:47], v[84:87], v[140:143], v[44:47]
  ds_read_b128 v[64:67], v10 offset:50176
  s_waitcnt lgkmcnt(14)
  v_mfma_f32_16x16x32_bf16 v[48:51], v[88:91], v[140:143], v[48:51]
  ds_read_b128 v[68:71], v10 offset:51200
  s_waitcnt lgkmcnt(14)
  v_mfma_f32_16x16x32_bf16 v[52:55], v[92:95], v[140:143], v[52:55]
  ds_read_b128 v[72:75], v10 offset:52224
  s_waitcnt lgkmcnt(14)
  v_mfma_f32_16x16x32_bf16 v[56:59], v[96:99], v[140:143], v[56:59]
  ds_read_b128 v[76:79], v10 offset:53248
  s_barrier
  s_waitcnt vmcnt(7) lgkmcnt(14)
  v_mfma_f32_16x16x32_bf16 v[40:43], v[100:103], v[144:147], v[40:43]
  ds_read_b128 v[80:83], v10 offset:54272
  s_waitcnt lgkmcnt(14)
  v_mfma_f32_16x16x32_bf16 v[44:47], v[104:107], v[144:147], v[44:47]
  ds_read_b128 v[84:87], v10 offset:55296
  s_waitcnt lgkmcnt(14)
  v_mfma_f32_16x16x32_bf16 v[48:51], v[108:111], v[144:147], v[48:51]
  ds_read_b128 v[88:91], v10 offset:56320
  s_waitcnt lgkmcnt(14)
  v_mfma_f32_16x16x32_bf16 v[52:55], v[112:115], v[144:147], v[52:55]
  ds_read_b128 v[92:95], v10 offset:57344
  s_waitcnt lgkmcnt(14)
  v_mfma_f32_16x16x32_bf16 v[56:59], v[116:119], v[144:147], v[56:59]
  ds_read_b128 v[96:99], v10 offset:58368
  s_waitcnt vmcnt(6) lgkmcnt(14)
  v_mfma_f32_16x16x32_bf16 v[40:43], v[120:123], v[148:151], v[40:43]
  ds_read_b128 v[100:103], v10 offset:59392
  s_waitcnt lgkmcnt(14)
  v_mfma_f32_16x16x32_bf16 v[44:47], v[124:127], v[148:151], v[44:47]
  ds_read_b128 v[104:107], v10 offset:60416
  s_waitcnt lgkmcnt(14)
  v_mfma_f32_16x16x32_bf16 v[48:51], v[128:131], v[148:151], v[48:51]
  ds_read_b128 v[108:111], v10 offset:61440
  s_waitcnt lgkmcnt(14)
  v_mfma_f32_16x16x32_bf16 v[52:55], v[132:135], v[148:151], v[52:55]
  ds_read_b128 v[112:115], v10 offset:62464
  s_waitcnt lgkmcnt(14)
  v_mfma_f32_16x16x32_bf16 v[56:59], v[136:139], v[148:151], v[56:59]
  ds_read_b128 v[116:119], v10 offset:63488
  s_waitcnt vmcnt(5) lgkmcnt(14)
  v_mfma_f32_16x16x32_bf16 v[40:43], v[60:63], v[152:155], v[40:43]
  ds_read_b128 v[120:123], v10 offset:64512
  s_waitcnt lgkmcnt(14)
  v_mfma_f32_16x16x32_bf16 v[44:47], v[64:67], v[152:155], v[44:47]
  ds_read_b128 v[124:127], v11 offset:0
  s_waitcnt lgkmcnt(14)
  v_mfma_f32_16x16x32_bf16 v[48:51], v[68:71], v[152:155], v[48:51]
  ds_read_b128 v[128:131], v11 offset:1024
  s_waitcnt lgkmcnt(14)
  v_mfma_f32_16x16x32_bf16 v[52:55], v[72:75], v[152:155], v[52:55]
  ds_read_b128 v[132:135], v11 offset:2048
  s_waitcnt lgkmcnt(14)
  v_mfma_f32_16x16x32_bf16 v[56:59], v[76:79], v[152:155], v[56:59]
  ds_read_b128 v[136:139], v11 offset:3072
  s_waitcnt vmcnt(4) lgkmcnt(14)
  v_mfma_f32_16x16x32_bf16 v[40:43], v[80:83], v[156:159], v[40:43]
  ds_read_b128 v[60:63], v11 offset:4096
  s_waitcnt lgkmcnt(14)
  v_mfma_f32_16x16x32_bf16 v[44:47], v[84:87], v[156:159], v[44:47]
  ds_read_b128 v[64:67], v11 offset:5120
  s_waitcnt lgkmcnt(14)
  v_mfma_f32_16x16x32_bf16 v[48:51], v[88:91], v[156:159], v[48:51]
  ds_read_b128 v[68:71], v11 offset:6144
  s_waitcnt lgkmcnt(14)
  v_mfma_f32_16x16x32_bf16 v[52:55], v[92:95], v[156:159], v[52:55]
  ds_read_b128 v[72:75], v11 offset:7168
  s_waitcnt lgkmcnt(14)
  v_mfma_f32_16x16x32_bf16 v[56:59], v[96:99], v[156:159], v[56:59]
  ds_read_b128 v[76:79], v11 offset:8192
  s_waitcnt vmcnt(3) lgkmcnt(14)
  v_mfma_f32_16x16x32_bf16 v[40:43], v[100:103], v[160:163], v[40:43]
  ds_read_b128 v[80:83], v11 offset:9216
  s_waitcnt lgkmcnt(14)
  v_mfma_f32_16x16x32_bf16 v[44:47], v[104:107], v[160:163], v[44:47]
  ds_read_b128 v[84:87], v11 offset:10240
  s_waitcnt lgkmcnt(14)
  v_mfma_f32_16x16x32_bf16 v[48:51], v[108:111], v[160:163], v[48:51]
  ds_read_b128 v[88:91], v11 offset:11264
  s_waitcnt lgkmcnt(14)
  v_mfma_f32_16x16x32_bf16 v[52:55], v[112:115], v[160:163], v[52:55]
  ds_read_b128 v[92:95], v11 offset:12288
  s_waitcnt lgkmcnt(14)
  v_mfma_f32_16x16x32_bf16 v[56:59], v[116:119], v[160:163], v[56:59]
  ds_read_b128 v[96:99], v11 offset:13312
  s_waitcnt vmcnt(2) lgkmcnt(14)
  v_mfma_f32_16x16x32_bf16 v[40:43], v[120:123], v[164:167], v[40:43]
  s_waitcnt lgkmcnt(13)
  v_mfma_f32_16x16x32_bf16 v[44:47], v[124:127], v[164:167], v[44:47]
  s_waitcnt lgkmcnt(12)
  v_mfma_f32_16x16x32_bf16 v[48:51], v[128:131], v[164:167], v[48:51]
  s_waitcnt lgkmcnt(11)
  v_mfma_f32_16x16x32_bf16 v[52:55], v[132:135], v[164:167], v[52:55]
  s_waitcnt lgkmcnt(10)
  v_mfma_f32_16x16x32_bf16 v[56:59], v[136:139], v[164:167], v[56:59]
  s_waitcnt vmcnt(1) lgkmcnt(9)
  v_mfma_f32_16x16x32_bf16 v[40:43], v[60:63], v[168:171], v[40:43]
  s_waitcnt lgkmcnt(8)
  v_mfma_f32_16x16x32_bf16 v[44:47], v[64:67], v[168:171], v[44:47]
  s_waitcnt lgkmcnt(7)
  v_mfma_f32_16x16x32_bf16 v[48:51], v[68:71], v[168:171], v[48:51]
  s_waitcnt lgkmcnt(6)
  v_mfma_f32_16x16x32_bf16 v[52:55], v[72:75], v[168:171], v[52:55]
  s_waitcnt lgkmcnt(5)
  v_mfma_f32_16x16x32_bf16 v[56:59], v[76:79], v[168:171], v[56:59]
  s_waitcnt vmcnt(0) lgkmcnt(4)
  v_mfma_f32_16x16x32_bf16 v[40:43], v[80:83], v[172:175], v[40:43]
  s_waitcnt lgkmcnt(3)
  v_mfma_f32_16x16x32_bf16 v[44:47], v[84:87], v[172:175], v[44:47]
  s_waitcnt lgkmcnt(2)
  v_mfma_f32_16x16x32_bf16 v[48:51], v[88:91], v[172:175], v[48:51]
  s_waitcnt lgkmcnt(1)
  v_mfma_f32_16x16x32_bf16 v[52:55], v[92:95], v[172:175], v[52:55]
  s_waitcnt lgkmcnt(0)
  v_mfma_f32_16x16x32_bf16 v[56:59], v[96:99], v[172:175], v[56:59]
  v_cvt_pk_bf16_f32 v60, v40, v41
  v_cvt_pk_bf16_f32 v61, v42, v43
  v_cvt_pk_bf16_f32 v62, v44, v45
  v_cvt_pk_bf16_f32 v63, v46, v47
  buffer_store_dwordx4 v[60:63], v12, s[24:27], s42 offen offset:0
  v_cvt_pk_bf16_f32 v64, v48, v49
  v_cvt_pk_bf16_f32 v65, v50, v51
  v_cvt_pk_bf16_f32 v66, v52, v53
  v_cvt_pk_bf16_f32 v67, v54, v55
  buffer_store_dwordx4 v[64:67], v12, s[24:27], s43 offen offset:0
  v_cvt_pk_bf16_f32 v68, v56, v57
  v_cvt_pk_bf16_f32 v69, v58, v59
  buffer_store_dwordx2 v[68:69], v12, s[24:27], s44 offen offset:0
kf_end:
  s_endpgm
kf_ld:
  s_sub_u32 s3, s3, 4
  s_lshl_b32 s9, s3, 10
  s_lshr_b32 s12, s2, 5
  s_lshr_b32 s13, s2, 5
  s_lshl_b32 s13, s13, 1
  s_and_b32 s8, s2, 1
  s_add_u32 s13, s13, s8
  s_waitcnt lgkmcnt(0)
  s_add_u32 s16, s14, 0x3000000
  s_addc_u32 s17, s15, 0
  s_mov_b32 s18, 0x81c000
  s_mov_b32 s19, 0x00020000
  s_mul_i32 s28, s12, 102400
  s_add_u32 s28, s28, 1048576
  s_mul_i32 s29, s13, 143360
  s_add_u32 s29, s29, 2097152
  s_mul_i32 s30, s12, 276480
  s_add_u32 s30, s30, 6291456
  s_bfe_u32 s31, s2, 0x20003
  s_lshl_b32 s31, s31, 2
  s_add_u32 s31, s31, s3
  s_and_b32 s32, s31, 7
  v_lshlrev_b32 v11, 7, v1
  s_cmp_ge_u32 s13, 12
  s_cselect_b32 s34, s3, 99
  s_mov_b32 s10, 0
  s_mul_i32 s10, s10, 5
  s_add_u32 s10, s10, s3
  s_lshl_b32 s10, s10, 10
  s_mul_i32 s8, s12, 102400
  s_add_u32 s8, s8, 0
  s_add_u32 s35, s8, 102400
  s_add_u32 s8, s8, s10
  s_mov_b32 m0, s9
  s_add_u32 s9, s9, 4096
  buffer_load_dwordx4 v4, s[16:19], s8 offen lds
  s_add_u32 s8, s8, 4096
  s_mov_b32 m0, s9
  s_add_u32 s9, s9, 4096
  buffer_load_dwordx4 v4, s[16:19], s8 offen lds
  s_add_u32 s8, s8, 4096
  s_mov_b32 m0, s9
  s_add_u32 s9, s9, 4096
  buffer_load_dwordx4 v4, s[16:19], s8 offen lds
  s_add_u32 s8, s8, 4096
  s_barrier
  s_mov_b32 m0, s9
  s_add_u32 s9, s9, 4096
  buffer_load_dwordx4 v4, s[16:19], s8 offen lds
  s_add_u32 s8, s8, 4096
  s_mov_b32 m0, s9
  s_add_u32 s9, s9, 4096
  buffer_load_dwordx4 v4, s[16:19], s8 offen lds
  s_add_u32 s8, s8, 4096
  s_mov_b32 m0, s9
  s_add_u32 s9, s9, 4096
  buffer_load_dwordx4 v4, s[16:19], s8 offen lds
  s_add_u32 s8, s8, 4096
  s_mov_b32 m0, s9
  s_add_u32 s9, s9, 4096
  buffer_load_dwordx4 v4, s[16:19], s8 offen lds
  s_add_u32 s8, s8, 4096
  s_mov_b32 m0, s9
  s_add_u32 s9, s9, 4096
  buffer_load_dwordx4 v4, s[16:19], s8 offen lds
  s_add_u32 s8, s8, 4096
  s_mov_b32 m0, s9
  s_add_u32 s9, s9, 4096
  buffer_load_dwordx4 v4, s[16:19], s8 offen lds
  s_add_u32 s8, s8, 4096
  s_mov_b32 m0, s9
  s_add_u32 s9, s9, 4096
  buffer_load_dwordx4 v4, s[16:19], s8 offen lds
  s_add_u32 s8, s8, 4096
  s_mov_b32 m0, s9
  s_add_u32 s9, s9, 4096
  buffer_load_dwordx4 v4, s[16:19], s8 offen lds
  s_add_u32 s8, s8, 4096
  s_mov_b32 m0, s9
  s_add_u32 s9, s9, 4096
  buffer_load_dwordx4 v4, s[16:19], s8 offen lds
  s_add_u32 s8, s8, 4096
  s_mov_b32 m0, s9
  s_add_u32 s9, s9, 4096
  buffer_load_dwordx4 v4, s[16:19], s8 offen lds
  s_add_u32 s8, s8, 4096
  s_mov_b32 m0, s9
  s_add_u32 s9, s9, 4096
  buffer_load_dwordx4 v4, s[16:19], s8 offen lds
  s_add_u32 s8, s8, 4096
  s_mov_b32 m0, s9
  s_add_u32 s9, s9, 4096
  buffer_load_dwordx4 v4, s[16:19], s8 offen lds
  s_add_u32 s8, s8, 4096
  s_mov_b32 m0, s9
  s_add_u32 s9, s9, 4096
  buffer_load_dwordx4 v4, s[16:19], s8 offen lds
  s_add_u32 s8, s8, 4096
  s_mov_b32 m0, s9
  s_add_u32 s9, s9, 4096
  buffer_load_dwordx4 v4, s[16:19], s8 offen lds
  s_add_u32 s8, s8, 4096
  s_mov_b32 m0, s9
  s_add_u32 s9, s9, 4096
  buffer_load_dwordx4 v4, s[16:19], s8 offen lds
  s_add_u32 s8, s8, 4096
  s_mov_b32 m0, s9
  s_add_u32 s9, s9, 4096
  buffer_load_dwordx4 v4, s[16:19], s8 offen lds
  s_add_u32 s8, s8, 4096
  s_mov_b32 m0, s9
  s_add_u32 s9, s9, 4096
  buffer_load_dwordx4 v4, s[16:19], s8 offen lds
  s_add_u32 s8, s8, 4096
  s_mov_b32 m0, s9
  s_add_u32 s9, s9, 4096
  buffer_load_dwordx4 v4, s[16:19], s8 offen lds
  s_add_u32 s8, s8, 4096
  s_mov_b32 m0, s9
  s_add_u32 s9, s9, 4096
  buffer_load_dwordx4 v4, s[16:19], s8 offen lds
  s_add_u32 s8, s8, 4096
  s_mov_b32 m0, s9
  s_add_u32 s9, s9, 4096
  buffer_load_dwordx4 v4, s[16:19], s8 offen lds
  s_add_u32 s8, s8, 4096
  s_mov_b32 m0, s9
  s_add_u32 s9, s9, 4096
  buffer_load_dwordx4 v4, s[16:19], s8 offen lds
  s_add_u32 s8, s8, 4096
  s_mov_b32 m0, s9
  s_add_u32 s9, s9, 4096
  buffer_load_dwordx4 v4, s[16:19], s8 offen lds
  s_add_u32 s8, s8, 4096
  s_mov_b32 s10, 0
  s_mul_i32 s10, s10, 5
  s_add_u32 s10, s10, s3
  s_lshl_b32 s10, s10, 10
  s_mul_i32 s8, s12, 102400
  s_add_u32 s8, s8, 1048576
  s_add_u32 s35, s8, 102400
  s_add_u32 s8, s8, s10
  s_mov_b32 m0, s9
  s_add_u32 s9, s9, 4096
  buffer_load_dwordx4 v4, s[16:19], s8 offen lds
  s_add_u32 s8, s8, 4096
  s_mov_b32 m0, s9
  s_add_u32 s9, s9, 4096
  buffer_load_dwordx4 v4, s[16:19], s8 offen lds
  s_add_u32 s8, s8, 4096
  s_mov_b32 m0, s9
  s_add_u32 s9, s9, 4096
  buffer_load_dwordx4 v4, s[16:19], s8 offen lds
  s_add_u32 s8, s8, 4096
  s_mov_b32 m0, s9
  s_add_u32 s9, s9, 4096
  buffer_load_dwordx4 v4, s[16:19], s8 offen lds
  s_add_u32 s8, s8, 4096
  s_mov_b32 m0, s9
  s_add_u32 s9, s9, 4096
  buffer_load_dwordx4 v4, s[16:19], s8 offen lds
  s_add_u32 s8, s8, 4096
  s_mov_b32 m0, s9
  s_add_u32 s9, s9, 4096
  buffer_load_dwordx4 v4, s[16:19], s8 offen lds
  s_add_u32 s8, s8, 4096
  s_barrier
  s_waitcnt vmcnt(17)
  s_barrier
  s_add_u32 s20, s14, 0x3a00000
  s_addc_u32 s21, s15, 0
  s_mov_b32 s22, 0x10e00
  s_mov_b32 s23, 0x00020000
  s_mul_i32 s24, s13, 7
  s_lshr_b32 s24, s24, 1
  s_mul_i32 s25, s13, 3
  s_add_u32 s25, s25, 6
  s_cmp_ge_u32 s13, 12
  s_cselect_b32 s24, s25, s24
  s_lshl_b32 s24, s24, 7
  v_and_b32 v8, 31, v1
  v_lshlrev_b32 v8, 4, v8
  v_lshrrev_b32 v9, 5, v1
  v_mul_u32_u24 v9, 34560, v9
  v_add_u32 v9, v8, v9
  v_add_u32 v8, 159808, v8
  buffer_load_dwordx4 v[236:239], v9, s[20:23], s24 offen
  s_add_u32 s24, s24, 6912
  buffer_load_dwordx4 v[240:243], v9, s[20:23], s24 offen
  s_add_u32 s24, s24, 6912
  buffer_load_dwordx4 v[244:247], v9, s[20:23], s24 offen
  s_add_u32 s24, s24, 6912
  buffer_load_dwordx4 v[248:251], v9, s[20:23], s24 offen
  s_add_u32 s24, s24, 6912
  buffer_load_dwordx4 v[252:255], v9, s[20:23], s24 offen
  s_add_u32 s24, s24, 6912
  s_waitcnt vmcnt(14)
  s_barrier
  s_mov_b32 m0, s9
  s_add_u32 s9, s9, 4096
  buffer_load_dwordx4 v4, s[16:19], s8 offen lds
  s_add_u32 s8, s8, 4096
  s_mov_b32 m0, s9
  s_add_u32 s9, s9, 4096
  buffer_load_dwordx4 v4, s[16:19], s8 offen lds
  s_add_u32 s8, s8, 4096
  s_mov_b32 m0, s9
  s_add_u32 s9, s9, 4096
  buffer_load_dwordx4 v4, s[16:19], s8 offen lds
  s_add_u32 s8, s8, 4096
  s_mov_b32 m0, s9
  s_add_u32 s9, s9, 4096
  buffer_load_dwordx4 v4, s[16:19], s8 offen lds
  s_add_u32 s8, s8, 4096
  s_mov_b32 m0, s9
  s_add_u32 s9, s9, 4096
  buffer_load_dwordx4 v4, s[16:19], s8 offen lds
  s_add_u32 s8, s8, 4096
  s_mov_b32 m0, s9
  s_add_u32 s9, s9, 4096
  buffer_load_dwordx4 v4, s[16:19], s8 offen lds
  s_add_u32 s8, s8, 4096
  s_mov_b32 m0, s9
  s_add_u32 s9, s9, 4096
  buffer_load_dwordx4 v4, s[16:19], s8 offen lds
  s_add_u32 s8, s8, 4096
  s_mov_b32 m0, s9
  s_add_u32 s9, s9, 4096
  buffer_load_dwordx4 v4, s[16:19], s8 offen lds
  s_add_u32 s8, s8, 4096
  s_lshl_b32 s9, s3, 10
  s_mov_b32 m0, s9
  s_add_u32 s9, s9, 4096
  buffer_load_dwordx4 v4, s[16:19], s8 offen lds
  s_add_u32 s8, s8, 4096
  s_waitcnt vmcnt(12)
  v_pk_add_f32 v[236:237], v[236:237], v[240:241]
  v_pk_add_f32 v[238:239], v[238:239], v[242:243]
  s_waitcnt vmcnt(11)
  v_pk_add_f32 v[236:237], v[236:237], v[244:245]
  v_pk_add_f32 v[238:239], v[238:239], v[246:247]
  s_waitcnt vmcnt(10)
  v_pk_add_f32 v[236:237], v[236:237], v[248:249]
  v_pk_add_f32 v[238:239], v[238:239], v[250:251]
  s_waitcnt vmcnt(9)
  v_pk_add_f32 v[236:237], v[236:237], v[252:253]
  v_pk_add_f32 v[238:239], v[238:239], v[254:255]
  v_mov_b32 v240, v236
  v_mov_b32 v241, v237
  v_mov_b32 v242, v238
  v_mov_b32 v243, v239
  v_permlane32_swap_b32 v236, v240
  v_permlane32_swap_b32 v237, v241
  v_permlane32_swap_b32 v238, v242
  v_permlane32_swap_b32 v239, v243
  v_pk_add_f32 v[236:237], v[236:237], v[240:241]
  v_pk_add_f32 v[238:239], v[238:239], v[242:243]
  ds_write_b128 v8, v[236:239]
  s_waitcnt lgkmcnt(0)
  s_barrier
  s_mov_b32 m0, s9
  s_add_u32 s9, s9, 4096
  buffer_load_dwordx4 v4, s[16:19], s8 offen lds
  s_add_u32 s8, s8, 4096
  s_mov_b32 m0, s9
  s_add_u32 s9, s9, 4096
  buffer_load_dwordx4 v4, s[16:19], s8 offen lds
  s_add_u32 s8, s8, 4096
  s_mov_b32 m0, s9
  s_add_u32 s9, s9, 4096
  buffer_load_dwordx4 v4, s[16:19], s8 offen lds
  s_add_u32 s8, s8, 4096
  s_mov_b32 m0, s9
  s_add_u32 s9, s9, 4096
  buffer_load_dwordx4 v4, s[16:19], s8 offen lds
  s_add_u32 s8, s8, 4096
  s_mov_b32 m0, s9
  s_add_u32 s9, s9, 4096
  buffer_load_dwordx4 v4, s[16:19], s8 offen lds
  s_add_u32 s8, s8, 4096
  s_mov_b32 m0, s9
  s_add_u32 s9, s9, 4096
  buffer_load_dwordx4 v4, s[16:19], s8 offen lds
  s_add_u32 s8, s8, 4096
  s_mov_b32 m0, s9
  s_add_u32 s9, s9, 4096
  buffer_load_dwordx4 v4, s[16:19], s8 offen lds
  s_add_u32 s8, s8, 4096
  s_mov_b32 m0, s9
  s_add_u32 s9, s9, 4096
  buffer_load_dwordx4 v4, s[16:19], s8 offen lds
  s_add_u32 s8, s8, 4096
  s_waitcnt vmcnt(15)
  s_barrier
  s_mov_b32 m0, s9
  s_add_u32 s9, s9, 4096
  buffer_load_dwordx4 v4, s[16:19], s8 offen lds
  s_add_u32 s8, s8, 4096
  s_mov_b32 m0, s9
  s_add_u32 s9, s9, 4096
  buffer_load_dwordx4 v4, s[16:19], s8 offen lds
  s_add_u32 s8, s8, 4096
  s_mov_b32 s10, 0
  s_mul_i32 s10, s10, 7
  s_add_u32 s10, s10, s3
  s_lshl_b32 s10, s10, 10
  s_mul_i32 s8, s13, 143360
  s_add_u32 s8, s8, 2097152
  s_add_u32 s35, s8, 143360
  s_add_u32 s8, s8, s10
  s_mov_b32 m0, s9
  s_add_u32 s9, s9, 4096
  buffer_load_dwordx4 v4, s[16:19], s8 offen lds
  s_add_u32 s8, s8, 4096
  s_cmp_eq_u32 s34, 2
  s_cselect_b32 s10, 1024, 0
  s_sub_u32 s10, s8, s10
  s_mov_b32 m0, s9
  s_add_u32 s9, s9, 4096
  buffer_load_dwordx4 v4, s[16:19], s10 offen lds
  s_add_u32 s8, s8, 4096
  s_mov_b32 m0, s9
  s_add_u32 s9, s9, 4096
  buffer_load_dwordx4 v4, s[16:19], s8 offen lds
  s_add_u32 s8, s8, 4096
  s_cmp_eq_u32 s34, 1
  s_cselect_b32 s10, 1024, 0
  s_sub_u32 s10, s8, s10
  s_mov_b32 m0, s9
  s_add_u32 s9, s9, 4096
  buffer_load_dwordx4 v4, s[16:19], s10 offen lds
  s_add_u32 s8, s8, 4096
  s_mov_b32 m0, s9
  s_add_u32 s9, s9, 4096
  buffer_load_dwordx4 v4, s[16:19], s8 offen lds
  s_add_u32 s8, s8, 4096
  s_cmp_eq_u32 s34, 0
  s_cselect_b32 s10, 1024, 0
  s_sub_u32 s10, s8, s10
  s_mov_b32 m0, s9
  s_add_u32 s9, s9, 4096
  buffer_load_dwordx4 v4, s[16:19], s10 offen lds
  s_add_u32 s8, s8, 4096
  s_cmp_eq_u32 s34, 3
  s_cselect_b32 s10, 1024, 0
  s_sub_u32 s10, s8, s10
  s_mov_b32 m0, s9
  s_add_u32 s9, s9, 4096
  buffer_load_dwordx4 v4, s[16:19], s10 offen lds
  s_add_u32 s8, s8, 4096
  s_mov_b32 m0, s9
  s_add_u32 s9, s9, 4096
  buffer_load_dwordx4 v4, s[16:19], s8 offen lds
  s_add_u32 s8, s8, 4096
  s_cmp_eq_u32 s34, 2
  s_cselect_b32 s10, 1024, 0
  s_sub_u32 s10, s8, s10
  s_mov_b32 m0, s9
  s_add_u32 s9, s9, 4096
  buffer_load_dwordx4 v4, s[16:19], s10 offen lds
  s_add_u32 s8, s8, 4096
  s_mov_b32 m0, s9
  s_add_u32 s9, s9, 4096
  buffer_load_dwordx4 v4, s[16:19], s8 offen lds
  s_add_u32 s8, s8, 4096
  s_cmp_eq_u32 s34, 1
  s_cselect_b32 s10, 1024, 0
  s_sub_u32 s10, s8, s10
  s_mov_b32 m0, s9
  s_add_u32 s9, s9, 4096
  buffer_load_dwordx4 v4, s[16:19], s10 offen lds
  s_add_u32 s8, s8, 4096
  s_mov_b32 m0, s9
  s_add_u32 s9, s9, 4096
  buffer_load_dwordx4 v4, s[16:19], s8 offen lds
  s_add_u32 s8, s8, 4096
  s_cmp_eq_u32 s34, 0
  s_cselect_b32 s10, 1024, 0
  s_sub_u32 s10, s8, s10
  s_mov_b32 m0, s9
  s_add_u32 s9, s9, 4096
  buffer_load_dwordx4 v4, s[16:19], s10 offen lds
  s_add_u32 s8, s8, 4096
  s_cmp_eq_u32 s34, 3
  s_cselect_b32 s10, 1024, 0
  s_sub_u32 s10, s8, s10
  s_mov_b32 m0, s9
  s_add_u32 s9, s9, 4096
  buffer_load_dwordx4 v4, s[16:19], s10 offen lds
  s_add_u32 s8, s8, 4096
  s_waitcnt vmcnt(25)
  s_barrier
  s_waitcnt vmcnt(17)
  s_barrier
  s_mov_b32 m0, s9
  s_add_u32 s9, s9, 4096
  buffer_load_dwordx4 v4, s[16:19], s8 offen lds
  s_add_u32 s8, s8, 4096
  s_cmp_eq_u32 s34, 2
  s_cselect_b32 s10, 1024, 0
  s_sub_u32 s10, s8, s10
  s_mov_b32 m0, s9
  s_add_u32 s9, s9, 4096
  buffer_load_dwordx4 v4, s[16:19], s10 offen lds
  s_add_u32 s8, s8, 4096
  s_mov_b32 m0, s9
  s_add_u32 s9, s9, 4096
  buffer_load_dwordx4 v4, s[16:19], s8 offen lds
  s_add_u32 s8, s8, 4096
  s_cmp_eq_u32 s34, 1
  s_cselect_b32 s10, 1024, 0
  s_sub_u32 s10, s8, s10
  s_mov_b32 m0, s9
  s_add_u32 s9, s9, 4096
  buffer_load_dwordx4 v4, s[16:19], s10 offen lds
  s_add_u32 s8, s8, 4096
  s_mov_b32 m0, s9
  s_add_u32 s9, s9, 4096
  buffer_load_dwordx4 v4, s[16:19], s8 offen lds
  s_add_u32 s8, s8, 4096
  s_cmp_eq_u32 s34, 0
  s_cselect_b32 s10, 1024, 0
  s_sub_u32 s10, s8, s10
  s_mov_b32 m0, s9
  s_add_u32 s9, s9, 4096
  buffer_load_dwordx4 v4, s[16:19], s10 offen lds
  s_add_u32 s8, s8, 4096
  s_cmp_eq_u32 s34, 3
  s_cselect_b32 s10, 1024, 0
  s_sub_u32 s10, s8, s10
  s_mov_b32 m0, s9
  s_add_u32 s9, s9, 4096
  buffer_load_dwordx4 v4, s[16:19], s10 offen lds
  s_add_u32 s8, s8, 4096
  s_mov_b32 m0, s9
  s_add_u32 s9, s9, 4096
  buffer_load_dwordx4 v4, s[16:19], s8 offen lds
  s_add_u32 s8, s8, 4096
  s_waitcnt vmcnt(22)
  s_barrier
  s_cmp_eq_u32 s34, 2
  s_cselect_b32 s10, 1024, 0
  s_sub_u32 s10, s8, s10
  s_mov_b32 m0, s9
  s_add_u32 s9, s9, 4096
  buffer_load_dwordx4 v4, s[16:19], s10 offen lds
  s_add_u32 s8, s8, 4096
  s_mov_b32 m0, s9
  s_add_u32 s9, s9, 4096
  buffer_load_dwordx4 v4, s[16:19], s8 offen lds
  s_add_u32 s8, s8, 4096
  s_cmp_eq_u32 s34, 1
  s_cselect_b32 s10, 1024, 0
  s_sub_u32 s10, s8, s10
  s_mov_b32 m0, s9
  s_add_u32 s9, s9, 4096
  buffer_load_dwordx4 v4, s[16:19], s10 offen lds
  s_add_u32 s8, s8, 4096
  s_mov_b32 m0, s9
  s_add_u32 s9, s9, 4096
  buffer_load_dwordx4 v4, s[16:19], s8 offen lds
  s_add_u32 s8, s8, 4096
  s_cmp_eq_u32 s34, 0
  s_cselect_b32 s10, 1024, 0
  s_sub_u32 s10, s8, s10
  s_mov_b32 m0, s9
  s_add_u32 s9, s9, 4096
  buffer_load_dwordx4 v4, s[16:19], s10 offen lds
  s_add_u32 s8, s8, 4096
  s_cmp_eq_u32 s34, 3
  s_cselect_b32 s10, 1024, 0
  s_sub_u32 s10, s8, s10
  s_mov_b32 m0, s9
  s_add_u32 s9, s9, 4096
  buffer_load_dwordx4 v4, s[16:19], s10 offen lds
  s_add_u32 s8, s8, 4096
  s_lshl_b32 s9, s3, 10
  s_mov_b32 m0, s9
  s_add_u32 s9, s9, 4096
  buffer_load_dwordx4 v4, s[16:19], s8 offen lds
  s_add_u32 s8, s8, 4096
  s_cmp_eq_u32 s34, 2
  s_cselect_b32 s10, 1024, 0
  s_sub_u32 s10, s8, s10
  s_mov_b32 m0, s9
  s_add_u32 s9, s9, 4096
  buffer_load_dwordx4 v4, s[16:19], s10 offen lds
  s_add_u32 s8, s8, 4096
  s_waitcnt vmcnt(24)
  s_barrier
  s_mov_b32 m0, s9
  s_add_u32 s9, s9, 4096
  buffer_load_dwordx4 v4, s[16:19], s8 offen lds
  s_add_u32 s8, s8, 4096
  s_cmp_eq_u32 s34, 1
  s_cselect_b32 s10, 1024, 0
  s_sub_u32 s10, s8, s10
  s_mov_b32 m0, s9
  s_add_u32 s9, s9, 4096
  buffer_load_dwordx4 v4, s[16:19], s10 offen lds
  s_add_u32 s8, s8, 4096
  s_mov_b32 m0, s9
  s_add_u32 s9, s9, 4096
  buffer_load_dwordx4 v4, s[16:19], s8 offen lds
  s_add_u32 s8, s8, 4096
  s_cmp_eq_u32 s34, 0
  s_cselect_b32 s10, 1024, 0
  s_sub_u32 s10, s8, s10
  s_mov_b32 m0, s9
  s_add_u32 s9, s9, 4096
  buffer_load_dwordx4 v4, s[16:19], s10 offen lds
  s_add_u32 s8, s8, 4096
  s_cmp_eq_u32 s34, 3
  s_cselect_b32 s10, 1024, 0
  s_sub_u32 s10, s8, s10
  s_mov_b32 m0, s9
  s_add_u32 s9, s9, 4096
  buffer_load_dwordx4 v4, s[16:19], s10 offen lds
  s_add_u32 s8, s8, 4096
  s_mov_b32 s10, 0
  s_mul_i32 s10, s10, 5
  s_add_u32 s10, s10, s3
  s_lshl_b32 s10, s10, 10
  s_mul_i32 s8, s12, 276480
  s_add_u32 s8, s8, 6291456
  s_add_u32 s35, s8, 276480
  s_add_u32 s8, s8, s10
  s_mov_b32 m0, s9
  s_add_u32 s9, s9, 4096
  buffer_load_dwordx4 v4, s[16:19], s8 offen lds
  s_add_u32 s8, s8, 4096
  s_mov_b32 m0, s9
  s_add_u32 s9, s9, 4096
  buffer_load_dwordx4 v4, s[16:19], s8 offen lds
  s_add_u32 s8, s8, 4096
  s_mov_b32 m0, s9
  s_add_u32 s9, s9, 4096
  buffer_load_dwordx4 v4, s[16:19], s8 offen lds
  s_add_u32 s8, s8, 4096
  s_mov_b32 m0, s9
  s_add_u32 s9, s9, 4096
  buffer_load_dwordx4 v4, s[16:19], s8 offen lds
  s_add_u32 s8, s8, 4096
  s_waitcnt vmcnt(30)
  s_barrier
  s_mov_b32 m0, s9
  s_add_u32 s9, s9, 4096
  buffer_load_dwordx4 v4, s[16:19], s8 offen lds
  s_add_u32 s8, s8, 4096
  s_mov_b32 m0, s9
  s_add_u32 s9, s9, 4096
  buffer_load_dwordx4 v4, s[16:19], s8 offen lds
  s_add_u32 s8, s8, 4096
  s_mov_b32 m0, s9
  s_add_u32 s9, s9, 4096
  buffer_load_dwordx4 v4, s[16:19], s8 offen lds
  s_add_u32 s8, s8, 4096
  s_waitcnt vmcnt(29)
  s_barrier
  s_mov_b32 m0, s9
  s_add_u32 s9, s9, 4096
  buffer_load_dwordx4 v4, s[16:19], s8 offen lds
  s_add_u32 s8, s8, 4096
  s_mov_b32 m0, s9
  s_add_u32 s9, s9, 4096
  buffer_load_dwordx4 v4, s[16:19], s8 offen lds
  s_add_u32 s8, s8, 4096
  s_mov_b32 m0, s9
  s_add_u32 s9, s9, 4096
  buffer_load_dwordx4 v4, s[16:19], s8 offen lds
  s_add_u32 s8, s8, 4096
  s_mov_b32 m0, s9
  s_add_u32 s9, s9, 4096
  buffer_load_dwordx4 v4, s[16:19], s8 offen lds
  s_add_u32 s8, s8, 4096
  s_waitcnt vmcnt(30)
  s_barrier
  s_mov_b32 m0, s9
  s_add_u32 s9, s9, 4096
  buffer_load_dwordx4 v4, s[16:19], s8 offen lds
  s_add_u32 s8, s8, 4096
  s_mov_b32 m0, s9
  s_add_u32 s9, s9, 4096
  buffer_load_dwordx4 v4, s[16:19], s8 offen lds
  s_add_u32 s8, s8, 4096
  s_mov_b32 m0, s9
  s_add_u32 s9, s9, 4096
  buffer_load_dwordx4 v4, s[16:19], s8 offen lds
  s_add_u32 s8, s8, 4096
  s_waitcnt vmcnt(29)
  s_barrier
  s_mov_b32 m0, s9
  s_add_u32 s9, s9, 4096
  buffer_load_dwordx4 v4, s[16:19], s8 offen lds
  s_add_u32 s8, s8, 4096
  s_mov_b32 m0, s9
  s_add_u32 s9, s9, 4096
  buffer_load_dwordx4 v4, s[16:19], s8 offen lds
  s_add_u32 s8, s8, 4096
  s_mov_b32 m0, s9
  s_add_u32 s9, s9, 4096
  buffer_load_dwordx4 v4, s[16:19], s8 offen lds
  s_add_u32 s8, s8, 4096
  s_mov_b32 m0, s9
  s_add_u32 s9, s9, 4096
  buffer_load_dwordx4 v4, s[16:19], s8 offen lds
  s_add_u32 s8, s8, 4096
  s_waitcnt vmcnt(30)
  s_barrier
  s_mov_b32 m0, s9
  s_add_u32 s9, s9, 4096
  buffer_load_dwordx4 v4, s[16:19], s8 offen lds
  s_add_u32 s8, s8, 4096
  s_mov_b32 m0, s9
  s_add_u32 s9, s9, 4096
  buffer_load_dwordx4 v4, s[16:19], s8 offen lds
  s_add_u32 s8, s8, 4096
  s_mov_b32 m0, s9
  s_add_u32 s9, s9, 4096
  buffer_load_dwordx4 v4, s[16:19], s8 offen lds
  s_add_u32 s8, s8, 4096
  s_waitcnt vmcnt(29)
  s_barrier
  s_mov_b32 m0, s9
  s_add_u32 s9, s9, 4096
  buffer_load_dwordx4 v4, s[16:19], s8 offen lds
  s_add_u32 s8, s8, 4096
  s_mov_b32 m0, s9
  s_add_u32 s9, s9, 4096
  buffer_load_dwordx4 v4, s[16:19], s8 offen lds
  s_add_u32 s8, s8, 4096
  s_mov_b32 m0, s9
  s_add_u32 s9, s9, 4096
  buffer_load_dwordx4 v4, s[16:19], s8 offen lds
  s_add_u32 s8, s8, 4096
  s_mov_b32 m0, s9
  s_add_u32 s9, s9, 4096
  buffer_load_dwordx4 v4, s[16:19], s8 offen lds
  s_add_u32 s8, s8, 4096
  s_waitcnt vmcnt(30)
  s_barrier
  s_mov_b32 m0, s9
  s_add_u32 s9, s9, 4096
  buffer_load_dwordx4 v4, s[16:19], s8 offen lds
  s_add_u32 s8, s8, 4096
  s_mov_b32 m0, s9
  s_add_u32 s9, s9, 4096
  buffer_load_dwordx4 v4, s[16:19], s8 offen lds
  s_add_u32 s8, s8, 4096
  s_mov_b32 m0, s9
  s_add_u32 s9, s9, 4096
  buffer_load_dwordx4 v4, s[16:19], s8 offen lds
  s_add_u32 s8, s8, 4096
  s_waitcnt vmcnt(29)
  s_barrier
  s_mov_b32 m0, s9
  s_add_u32 s9, s9, 4096
  buffer_load_dwordx4 v4, s[16:19], s8 offen lds
  s_add_u32 s8, s8, 4096
  s_mov_b32 m0, s9
  s_add_u32 s9, s9, 4096
  buffer_load_dwordx4 v4, s[16:19], s8 offen lds
  s_add_u32 s8, s8, 4096
  s_mov_b32 m0, s9
  s_add_u32 s9, s9, 4096
  buffer_load_dwordx4 v4, s[16:19], s8 offen lds
  s_add_u32 s8, s8, 4096
  s_mov_b32 m0, s9
  s_add_u32 s9, s9, 4096
  buffer_load_dwordx4 v4, s[16:19], s8 offen lds
  s_add_u32 s8, s8, 4096
  s_waitcnt vmcnt(32)
  s_barrier
  s_lshl_b32 s9, s3, 10
  s_mov_b32 m0, s9
  s_add_u32 s9, s9, 4096
  buffer_load_dwordx4 v4, s[16:19], s8 offen lds
  s_add_u32 s8, s8, 4096
  s_mov_b32 m0, s9
  s_add_u32 s9, s9, 4096
  buffer_load_dwordx4 v4, s[16:19], s8 offen lds
  s_add_u32 s8, s8, 4096
  s_mov_b32 m0, s9
  s_add_u32 s9, s9, 4096
  buffer_load_dwordx4 v4, s[16:19], s8 offen lds
  s_add_u32 s8, s8, 4096
  s_waitcnt vmcnt(28)
  s_barrier
  s_mov_b32 m0, s9
  s_add_u32 s9, s9, 4096
  buffer_load_dwordx4 v4, s[16:19], s8 offen lds
  s_add_u32 s8, s8, 4096
  s_mov_b32 m0, s9
  s_add_u32 s9, s9, 4096
  buffer_load_dwordx4 v4, s[16:19], s8 offen lds
  s_add_u32 s8, s8, 4096
  s_mov_b32 m0, s9
  s_add_u32 s9, s9, 4096
  buffer_load_dwordx4 v4, s[16:19], s8 offen lds
  s_add_u32 s8, s8, 4096
  s_mov_b32 m0, s9
  s_add_u32 s9, s9, 4096
  buffer_load_dwordx4 v4, s[16:19], s8 offen lds
  s_add_u32 s8, s8, 4096
  s_waitcnt vmcnt(30)
  s_barrier
  s_mov_b32 m0, s9
  s_add_u32 s9, s9, 4096
  buffer_load_dwordx4 v4, s[16:19], s8 offen lds
  s_add_u32 s8, s8, 4096
  s_mov_b32 m0, s9
  s_add_u32 s9, s9, 4096
  buffer_load_dwordx4 v4, s[16:19], s8 offen lds
  s_add_u32 s8, s8, 4096
  s_waitcnt vmcnt(29)
  s_barrier
  s_mov_b32 m0, s9
  s_add_u32 s9, s9, 4096
  buffer_load_dwordx4 v4, s[16:19], s8 offen lds
  s_add_u32 s8, s8, 4096
  s_mov_b32 m0, s9
  s_add_u32 s9, s9, 4096
  buffer_load_dwordx4 v4, s[16:19], s8 offen lds
  s_add_u32 s8, s8, 4096
  s_mov_b32 m0, s9
  s_add_u32 s9, s9, 4096
  buffer_load_dwordx4 v4, s[16:19], s8 offen lds
  s_add_u32 s8, s8, 4096
  s_waitcnt vmcnt(30)
  s_barrier
  s_mov_b32 m0, s9
  s_add_u32 s9, s9, 4096
  buffer_load_dwordx4 v4, s[16:19], s8 offen lds
  s_add_u32 s8, s8, 4096
  s_mov_b32 m0, s9
  s_add_u32 s9, s9, 4096
  buffer_load_dwordx4 v4, s[16:19], s8 offen lds
  s_add_u32 s8, s8, 4096
  s_waitcnt vmcnt(29)
  s_barrier
  s_mov_b32 m0, s9
  s_add_u32 s9, s9, 4096
  buffer_load_dwordx4 v4, s[16:19], s8 offen lds
  s_add_u32 s8, s8, 4096
  s_mov_b32 m0, s9
  s_add_u32 s9, s9, 4096
  buffer_load_dwordx4 v4, s[16:19], s8 offen lds
  s_add_u32 s8, s8, 4096
  s_mov_b32 m0, s9
  s_add_u32 s9, s9, 4096
  buffer_load_dwordx4 v4, s[16:19], s8 offen lds
  s_add_u32 s8, s8, 4096
  s_waitcnt vmcnt(30)
  s_barrier
  s_mov_b32 m0, s9
  s_add_u32 s9, s9, 4096
  buffer_load_dwordx4 v4, s[16:19], s8 offen lds
  s_add_u32 s8, s8, 4096
  s_mov_b32 m0, s9
  s_add_u32 s9, s9, 4096
  buffer_load_dwordx4 v4, s[16:19], s8 offen lds
  s_add_u32 s8, s8, 4096
  s_waitcnt vmcnt(29)
  s_barrier
  s_mov_b32 m0, s9
  s_add_u32 s9, s9, 4096
  buffer_load_dwordx4 v4, s[16:19], s8 offen lds
  s_add_u32 s8, s8, 4096
  s_mov_b32 m0, s9
  s_add_u32 s9, s9, 4096
  buffer_load_dwordx4 v4, s[16:19], s8 offen lds
  s_add_u32 s8, s8, 4096
  s_mov_b32 m0, s9
  s_add_u32 s9, s9, 4096
  buffer_load_dwordx4 v4, s[16:19], s8 offen lds
  s_add_u32 s8, s8, 4096
  s_waitcnt vmcnt(30)
  s_barrier
  s_mov_b32 m0, s9
  s_add_u32 s9, s9, 4096
  buffer_load_dwordx4 v4, s[16:19], s8 offen lds
  s_add_u32 s8, s8, 4096
  s_mov_b32 m0, s9
  s_add_u32 s9, s9, 4096
  buffer_load_dwordx4 v4, s[16:19], s8 offen lds
  s_add_u32 s8, s8, 4096
  s_waitcnt vmcnt(29)
  s_barrier
  s_mov_b32 m0, s9
  s_add_u32 s9, s9, 4096
  buffer_load_dwordx4 v4, s[16:19], s8 offen lds
  s_add_u32 s8, s8, 4096
  s_mov_b32 m0, s9
  s_add_u32 s9, s9, 4096
  buffer_load_dwordx4 v4, s[16:19], s8 offen lds
  s_add_u32 s8, s8, 4096
  s_mov_b32 m0, s9
  s_add_u32 s9, s9, 4096
  buffer_load_dwordx4 v4, s[16:19], s8 offen lds
  s_add_u32 s8, s8, 4096
  s_waitcnt vmcnt(30)
  s_barrier
  s_mov_b32 m0, s9
  s_add_u32 s9, s9, 4096
  buffer_load_dwordx4 v4, s[16:19], s8 offen lds
  s_add_u32 s8, s8, 4096
  s_mov_b32 m0, s9
  s_add_u32 s9, s9, 4096
  buffer_load_dwordx4 v4, s[16:19], s8 offen lds
  s_add_u32 s8, s8, 4096
  s_waitcnt vmcnt(29)
  s_barrier
  s_mov_b32 m0, s9
  s_add_u32 s9, s9, 4096
  buffer_load_dwordx4 v4, s[16:19], s8 offen lds
  s_add_u32 s8, s8, 4096
  s_mov_b32 m0, s9
  s_add_u32 s9, s9, 4096
  buffer_load_dwordx4 v4, s[16:19], s8 offen lds
  s_add_u32 s8, s8, 4096
  s_mov_b32 m0, s9
  s_add_u32 s9, s9, 4096
  buffer_load_dwordx4 v4, s[16:19], s8 offen lds
  s_add_u32 s8, s8, 4096
  s_waitcnt vmcnt(30)
  s_barrier
  s_mov_b32 m0, s9
  s_add_u32 s9, s9, 4096
  buffer_load_dwordx4 v4, s[16:19], s8 offen lds
  s_add_u32 s8, s8, 4096
  s_mov_b32 m0, s9
  s_add_u32 s9, s9, 4096
  buffer_load_dwordx4 v4, s[16:19], s8 offen lds
  s_add_u32 s8, s8, 4096
  s_waitcnt vmcnt(29)
  s_barrier
  s_mov_b32 m0, s9
  s_add_u32 s9, s9, 4096
  buffer_load_dwordx4 v4, s[16:19], s8 offen lds
  s_add_u32 s8, s8, 4096
  s_mov_b32 m0, s9
  s_add_u32 s9, s9, 4096
  buffer_load_dwordx4 v4, s[16:19], s8 offen lds
  s_add_u32 s8, s8, 4096
  s_waitcnt vmcnt(29)
  s_barrier
  s_waitcnt vmcnt(21)
  s_barrier
  s_waitcnt vmcnt(16)
  s_barrier
  s_waitcnt vmcnt(11)
  s_barrier
  s_waitcnt vmcnt(6)
  s_barrier
  s_waitcnt vmcnt(0)
  s_barrier
  s_endpgm
code_end:
.section .rodata,"a"
.p2align 6
.amdhsa_kernel k1_kernel
  .amdhsa_next_free_vgpr 144
  .amdhsa_next_free_sgpr 96
  .amdhsa_accum_offset 144
  .amdhsa_group_segment_fixed_size 0
  .amdhsa_kernarg_size 88
  .amdhsa_user_sgpr_count 2
  .amdhsa_user_sgpr_kernarg_segment_ptr 1
  .amdhsa_system_sgpr_workgroup_id_x 1
.end_amdhsa_kernel
.p2align 6
.amdhsa_kernel k2_kernel
  .amdhsa_next_free_vgpr 188
  .amdhsa_next_free_sgpr 96
  .amdhsa_accum_offset 188
  .amdhsa_group_segment_fixed_size 0
  .amdhsa_kernarg_size 88
  .amdhsa_user_sgpr_count 2
  .amdhsa_user_sgpr_kernarg_segment_ptr 1
  .amdhsa_system_sgpr_workgroup_id_x 1
.end_amdhsa_kernel
.p2align 6
.amdhsa_kernel kf_kernel
  .amdhsa_next_free_vgpr 256
  .amdhsa_next_free_sgpr 96
  .amdhsa_accum_offset 256
  .amdhsa_group_segment_fixed_size 0
  .amdhsa_kernarg_size 88
  .amdhsa_user_sgpr_count 2
  .amdhsa_user_sgpr_kernarg_segment_ptr 1
  .amdhsa_system_sgpr_workgroup_id_x 1
.end_amdhsa_kernel
```
